```python
import torch

def _softmax(x, axis=-1):
    return torch.softmax(x, dim=axis)
def _gelu(x):
    return torch.nn.functional.gelu(x, approximate="tanh")
def _silu(x):
    return torch.nn.functional.silu(x)
def _sigmoid(x):
    return torch.sigmoid(x)
def _layernorm(x, axis=-1, eps=1e-5):
    m = x.mean(dim=axis, keepdim=True)
    v = x.var(dim=axis, keepdim=True, unbiased=False)
    return (x - m) / torch.sqrt(v + eps)
def _scatter_add(tgt, idx, src, axis=0):
    return tgt.clone().index_add_(axis, idx, src)
def _segment_sum(src, seg, n):
    out = torch.zeros((n,) + src.shape[1:], dtype=src.dtype)
    return out.index_add_(0, seg, src)
def _pad(x, pw):
    flat = tuple(v for pair in reversed(pw) for v in pair)
    return torch.nn.functional.pad(x, flat)

kernel_name = 'standalone__gqa_block_cached__near_ridge'

def setup_inputs():

    _w = (lambda a: (lambda t: t.to(torch.bfloat16) if t.is_floating_point() else t)(torch.as_tensor(a)))
    B, Sq, D = 8, 160, 448
    Hq, Hkv, Sk, Dh = 16, 8, 2048, 256
    assert Hq % Hkv == 0, (Hq, Hkv)
    return {
        "x": _w((lambda *s: torch.randn(*s, dtype=torch.bfloat16) * 0.8)(B, Sq, D)),
        "k_cache": _w((lambda *s: torch.randn(*s, dtype=torch.bfloat16) * 0.8)(B, Hkv, Sk, Dh)),
        "v_cache": _w((lambda *s: torch.randn(*s, dtype=torch.bfloat16) * 0.05)(B, Hkv, Sk, Dh)),
        "wq": _w((lambda *s: torch.randn(*s, dtype=torch.bfloat16) * 0.8)(D, Hq * Dh) * (D ** -0.5)),
        "wo": _w((lambda *s: torch.randn(*s, dtype=torch.bfloat16) * 0.05)(Hq * Dh, D) * ((Hq * Dh) ** -0.5)),
    }

def reference(x, k_cache, v_cache, wq, wo):
    B, Sq, D = x.shape
    Hq, Dh = 16, 256
    Hkv = k_cache.shape[1]
    rep = Hq // Hkv
    q = (lambda x, *d: x.permute(*d))((x @ wq).reshape(B, Sq, Hq, Dh), 0, 2, 1, 3)
    k = (lambda x, n, axis: torch.repeat_interleave(x, n, dim=axis))(k_cache, rep, axis=1)
    v = (lambda x, n, axis: torch.repeat_interleave(x, n, dim=axis))(v_cache, rep, axis=1)
    scores = torch.einsum("bhqd,bhkd->bhqk", q, k) * (Dh ** -0.5)
    p = _softmax(scores, axis=-1)
    o = torch.einsum("bhqk,bhkd->bhqd", p, v)
    return (lambda x, *d: x.permute(*d))(o, 0, 2, 1, 3).reshape(B, Sq, Hq * Dh) @ wo
```

```asm
; @launch grid=(256,1,1) block=(512,1,1) lds=163840
.amdgcn_target "amdgcn-amd-amdhsa--gfx950"
.text
.globl standalone__gqa_block_cached__near_ridge_kernel
.p2align 8
.type standalone__gqa_block_cached__near_ridge_kernel,@function
standalone__gqa_block_cached__near_ridge_kernel:
  s_cmp_ge_u32 s2, 256
  s_cbranch_scc1 L_end
  s_load_dwordx16 s[64:79], s[0:1], 0
  s_and_b32 s25, s2, 7
  s_lshr_b32 s32, s2, 3
  s_lshr_b32 s28, s32, 2
  s_and_b32 s33, s32, 1
  s_lshr_b32 s27, s32, 1
  s_and_b32 s27, s27, 1
  s_lshl_b32 s26, s28, 1
  s_add_u32 s26, s26, s33
  v_lshrrev_b32 v1, 6, v0
  v_and_b32 v0, 63, v0
  v_readfirstlane_b32 s24, v1
  s_mul_i32 s37, s25, 143360
  s_lshl_b32 s38, s26, 9
  v_and_b32 v40, 15, v0
  v_lshrrev_b32 v41, 4, v0
  s_lshl_b32 s36, s24, 10
  s_lshr_b32 s47, s24, 2
  s_and_b32 s44, s24, 1
  s_lshl_b32 s32, s44, 2
  v_add_u32 v5, s32, v41
  v_and_b32 v6, 7, v0
  v_xor_b32 v5, v5, v6
  v_lshlrev_b32 v5, 4, v5
  v_lshrrev_b32 v6, 3, v0
  v_mul_u32_u24 v6, 896, v6
  v_add_u32 v42, v5, v6
  s_mul_i32 s32, s27, 10
  s_add_u32 s32, s32, s24
  s_sub_u32 s33, s32, 20
  s_cmp_ge_u32 s32, 20
  s_cselect_b32 s33, s33, s32
  s_mul_i32 s33, s33, 7168
  s_add_u32 s50, s33, s37
  s_add_u32 s32, s32, 8
  s_sub_u32 s33, s32, 20
  s_cmp_ge_u32 s32, 20
  s_cselect_b32 s33, s33, s32
  s_mul_i32 s33, s33, 7168
  s_add_u32 s51, s33, s37
  s_add_u32 s32, s32, 8
  s_sub_u32 s33, s32, 20
  s_cmp_ge_u32 s32, 20
  s_cselect_b32 s33, s33, s32
  s_mul_i32 s33, s33, 7168
  s_add_u32 s52, s33, s37
  v_lshrrev_b32 v5, 5, v0
  s_lshl_b32 s32, s24, 1
  v_add_u32 v5, s32, v5
  v_and_b32 v6, 3, v5
  s_lshl_b32 s32, s47, 2
  v_or_b32 v6, s32, v6
  v_bfe_u32 v7, v0, 1, 4
  v_xor_b32 v6, v6, v7
  v_lshlrev_b32 v6, 5, v6
  v_and_b32 v7, 1, v0
  v_lshlrev_b32 v7, 4, v7
  v_lshlrev_b32 v5, 13, v5
  v_add3_u32 v43, v5, v6, v7
  s_mov_b32 s6, 1146880
  s_mov_b32 s7, 0x20000
  s_mov_b32 s10, 3670016
  s_mov_b32 s11, 0x20000
  s_waitcnt lgkmcnt(0)
  s_mov_b32 s4, s64
  s_mov_b32 s5, s65
  s_mov_b32 s8, s70
  s_mov_b32 s9, s71
  s_cmp_ge_u32 s24, 4
  s_cbranch_scc1 L_sk1
  s_add_u32 m0, s36, 49152
  s_add_u32 s32, s52, 0
  buffer_load_dwordx4 v42, s[4:7], s32 offen lds
L_sk1:
  s_add_u32 m0, s36, 0
  s_add_u32 s32, s38, 0
  buffer_load_dwordx4 v43, s[8:11], s32 offen lds
  s_add_u32 m0, s36, 8192
  s_add_u32 s32, s38, 131072
  buffer_load_dwordx4 v43, s[8:11], s32 offen lds
  s_add_u32 m0, s36, 16384
  s_add_u32 s32, s38, 262144
  buffer_load_dwordx4 v43, s[8:11], s32 offen lds
  s_add_u32 m0, s36, 24576
  s_add_u32 s32, s38, 393216
  buffer_load_dwordx4 v43, s[8:11], s32 offen lds
  s_add_u32 m0, s36, 32768
  s_add_u32 s32, s50, 0
  buffer_load_dwordx4 v42, s[4:7], s32 offen lds
  s_add_u32 m0, s36, 40960
  s_add_u32 s32, s51, 0
  buffer_load_dwordx4 v42, s[4:7], s32 offen lds
  s_cmp_lg_u32 s24, 5
  s_cbranch_scc1 L_cwa
  s_getpc_b64 s[54:55]
L_pca:
  s_lshr_b32 s32, s2, 3
  s_mul_i32 s32, s32, 1280
  s_min_u32 s32, s32, L_codeend - standalone__gqa_block_cached__near_ridge_kernel - 2048
  s_sub_u32 s32, s32, L_pca - standalone__gqa_block_cached__near_ridge_kernel
  s_ashr_i32 s33, s32, 31
  s_add_u32 s54, s54, s32
  s_addc_u32 s55, s55, s33
  v_lshlrev_b32 v8, 4, v0
  s_mov_b32 m0, 159744
  s_nop 0
  global_load_lds_dwordx4 v8, s[54:55]
  global_load_lds_dwordx4 v8, s[54:55] offset:1024
L_cwa:
  s_mov_b32 s16, s72
  s_mov_b32 s17, s73
  s_mov_b32 s18, 3670016
  s_mov_b32 s19, 0x20000
  s_mov_b32 s20, s78
  s_mov_b32 s21, s79
  s_mov_b32 s22, 0x10000000
  s_mov_b32 s23, 0x20000
  s_mov_b32 s12, s68
  s_mov_b32 s13, s69
  s_mov_b32 s14, 0x4000000
  s_mov_b32 s15, 0x20000
  s_mov_b32 s60, s66
  s_mov_b32 s61, s67
  s_mov_b32 s62, 0x4000000
  s_mov_b32 s63, 0x20000
  s_mov_b32 s31, 0
  s_mov_b32 s41, 0x3db8aa3b
  s_mov_b32 s48, 0x4e800000
  s_mul_i32 s42, s26, 229376
  s_lshl_b32 s32, s25, 3
  s_add_u32 s32, s32, s28
  s_lshl_b32 s32, s32, 1
  s_add_u32 s32, s32, s27
  s_lshl_b32 s40, s32, 19
  s_mov_b32 s78, s40
  s_mul_i32 s32, s32, 0
  s_and_b32 s32, s32, 31
  s_lshl_b32 s32, s32, 14
  s_add_u32 s40, s40, s32
  s_mov_b32 s68, s76
  s_mov_b32 s69, s77
  s_mov_b32 s70, 256
  s_mov_b32 s71, 0x20000
  s_mov_b32 s72, s74
  s_mov_b32 s73, s75
  s_mov_b32 s74, 1146880
  s_mov_b32 s75, 0x20000
  s_lshl_b32 s32, s25, 1
  s_add_u32 s32, s32, s27
  s_lshl_b32 s66, s32, 7
  s_add_u32 s66, s66, 37224448
  s_lshl_b32 s32, s32, 4
  s_add_u32 s32, s32, s26
  s_mul_i32 s43, s32, 71680
  s_mul_i32 s64, s32, 73728
  s_add_u32 s64, s64, 18350080
  s_xor_b32 s32, s32, 16
  s_mul_i32 s65, s32, 73728
  s_add_u32 s65, s65, 18350080
  s_and_b32 s46, s24, 3
  s_lshr_b32 s45, s46, 1
  v_lshrrev_b32 v30, 3, v40
  v_lshlrev_b32 v30, 10, v30
  v_and_b32 v31, 7, v40
  v_lshlrev_b32 v31, 7, v31
  v_lshrrev_b32 v32, 1, v40
  v_xor_b32 v33, v41, v32
  v_lshlrev_b32 v33, 4, v33
  v_add3_u32 v19, v30, v31, v33
  s_mul_i32 s32, s47, 10240
  s_add_u32 s32, s32, 32768
  v_add_u32 v48, s32, v19
  v_xor_b32 v49, 64, v48
  v_lshrrev_b32 v24, 2, v40
  v_and_b32 v25, 1, v41
  v_lshlrev_b32 v25, 2, v25
  v_or_b32 v25, v25, v24
  v_lshl_add_u32 v26, v41, 3, v24
  v_lshlrev_b32 v26, 9, v26
  v_and_b32 v27, 3, v0
  v_lshl_add_u32 v26, v27, 3, v26
  s_lshl_b32 s32, s46, 2
  v_xor_b32 v25, s32, v25
  v_xor_b32 v28, 0, v25
  v_lshl_add_u32 v44, v28, 5, v26
  v_xor_b32 v28, 1, v25
  v_lshl_add_u32 v45, v28, 5, v26
  v_xor_b32 v28, 2, v25
  v_lshl_add_u32 v46, v28, 5, v26
  v_xor_b32 v28, 3, v25
  v_lshl_add_u32 v47, v28, 5, v26
  s_barrier
  s_cmp_ge_u32 s24, 4
  s_cbranch_scc1 L_sk2
  s_add_u32 m0, s36, 102400
  s_add_u32 s32, s52, 128
  buffer_load_dwordx4 v42, s[4:7], s32 offen lds
L_sk2:
  s_add_u32 m0, s36, 53248
  s_add_u32 s32, s38, 524288
  buffer_load_dwordx4 v43, s[8:11], s32 offen lds
  s_add_u32 m0, s36, 61440
  s_add_u32 s32, s38, 655360
  buffer_load_dwordx4 v43, s[8:11], s32 offen lds
  s_add_u32 m0, s36, 69632
  s_add_u32 s32, s38, 786432
  buffer_load_dwordx4 v43, s[8:11], s32 offen lds
  s_add_u32 m0, s36, 77824
  s_add_u32 s32, s38, 917504
  buffer_load_dwordx4 v43, s[8:11], s32 offen lds
  s_add_u32 m0, s36, 86016
  s_add_u32 s32, s50, 128
  buffer_load_dwordx4 v42, s[4:7], s32 offen lds
  s_add_u32 m0, s36, 94208
  s_add_u32 s32, s51, 128
  buffer_load_dwordx4 v42, s[4:7], s32 offen lds
  v_lshrrev_b32 v24, 1, v41
  v_xor_b32 v24, v24, v32
  v_and_b32 v25, 1, v41
  v_lshlrev_b32 v25, 3, v25
  v_add3_u32 v25, v30, v31, v25
  s_mul_i32 s32, s47, 40960
  s_lshl_b32 s33, s46, 11
  s_add_u32 s32, s32, s33
  v_add_u32 v25, s32, v25
  v_xor_b32 v28, 0, v24
  v_lshl_add_u32 v50, v28, 4, v25
  v_xor_b32 v28, 2, v24
  v_lshl_add_u32 v51, v28, 4, v25
  v_xor_b32 v28, 4, v24
  v_lshl_add_u32 v52, v28, 4, v25
  v_xor_b32 v28, 6, v24
  v_lshl_add_u32 v53, v28, 4, v25
  s_mov_b32 s49, s40
  s_mov_b32 s29, s40
  s_lshl_b32 s32, s44, 2
  v_add_u32 v24, s32, v41
  v_and_b32 v25, 7, v0
  v_xor_b32 v24, v24, v25
  v_lshlrev_b32 v24, 4, v24
  v_lshrrev_b32 v25, 3, v0
  s_lshl_b32 s32, s45, 4
  s_lshl_b32 s33, s44, 3
  s_add_u32 s32, s32, s33
  v_add_u32 v25, s32, v25
  v_lshl_add_u32 v16, v25, 9, v24
  s_lshl_b32 s32, s45, 13
  s_lshl_b32 s33, s44, 10
  s_add_u32 s39, s32, s33
  s_add_u32 s39, s39, 98304
  v_bfe_u32 v24, v0, 4, 1
  v_lshlrev_b32 v24, 1, v24
  v_and_b32 v25, 7, v0
  v_xor_b32 v24, v24, v25
  v_lshlrev_b32 v24, 4, v24
  v_lshrrev_b32 v25, 3, v0
  v_lshl_add_u32 v24, v25, 9, v24
  s_lshl_b32 s32, s46, 7
  v_add_u32 v12, s32, v24
  v_xor_b32 v24, 64, v12
  v_add_u32 v13, 4096, v24
  v_add_u32 v14, 8192, v12
  v_add_u32 v15, 12288, v24
  s_cmp_lg_u32 s24, 4
  s_cbranch_scc1 L_noclr
  v_and_b32 v24, 1, v0
  v_lshlrev_b32 v24, 6, v24
  s_lshl_b32 s33, s26, 2
  v_add_u32 v24, s33, v24
  v_mov_b32 v25, 0
  buffer_store_dword v25, v24, s[20:23], s66 offen sc1
L_noclr:
  s_cmp_lg_u32 s24, 99
  s_cbranch_scc1 L_notlb
  v_and_b32 v24, 31, v0
  s_mov_b32 s33, 73728
  v_mul_lo_u32 v24, v24, s33
  s_lshl_b32 s32, s25, 5
  s_mul_i32 s32, s32, s33
  s_add_u32 s32, s32, 18350080
  s_mov_b32 m0, 161792
  s_nop 0
  buffer_load_dword v24, s[20:23], s32 offen sc1 lds
L_notlb:
  s_lshl_b32 s3, s46, 12
  s_add_u32 s3, s3, 32768
  s_mul_i32 s32, s44, 40960
  v_add_u32 v54, s32, v19
  v_xor_b32 v55, 64, v54
  v_lshrrev_b32 v24, 1, v41
  s_lshl_b32 s32, s45, 1
  v_add_u32 v24, s32, v24
  v_mul_u32_u24 v24, 2560, v24
  v_and_b32 v25, 1, v41
  v_lshl_add_u32 v24, v25, 3, v24
  s_mul_i32 s32, s44, 80
  v_add_u32 v25, s32, v40
  v_lshl_add_u32 v3, v25, 4, v24
  s_lshl_b32 s32, s45, 2
  s_add_u32 s32, s32, 147456
  v_lshlrev_b32 v25, 3, v25
  v_add_u32 v4, s32, v25
  s_lshl_b32 s32, s45, 13
  s_add_u32 s32, s32, 98304
  v_add_u32 v1, s32, v19
  v_xor_b32 v2, 64, v1
  v_lshrrev_b32 v30, 2, v40
  v_lshl_add_u32 v32, v41, 3, v30
  v_lshlrev_b32 v32, 7, v32
  v_and_b32 v33, 3, v0
  v_lshl_add_u32 v32, v33, 3, v32
  v_add_u32 v32, s3, v32
  v_lshrrev_b32 v30, 1, v30
  v_and_b32 v33, 1, v41
  v_lshl_add_u32 v30, v33, 1, v30
  v_lshl_add_u32 v56, v30, 5, v32
  v_xor_b32 v57, 32, v56
  v_xor_b32 v58, 64, v56
  v_xor_b32 v59, 96, v56
  v_mul_u32_u24 v31, 2560, v41
  v_lshl_add_u32 v60, v40, 4, v31
  v_mov_b32 v7, 0xff800000
  v_mov_b32 v8, 0xff800000
  v_mov_b32 v9, 0xff800000
  v_mov_b32 v10, 0xff800000
  v_mov_b32 v11, 0xff800000
  s_waitcnt vmcnt(6)
  s_barrier
  ds_read_b128 v[128:131], v48 offset:0
  ds_read_b128 v[132:135], v48 offset:2048
  ds_read_b128 v[136:139], v48 offset:4096
  ds_read_b128 v[140:143], v48 offset:6144
  ds_read_b128 v[144:147], v48 offset:8192
  ds_read_b64_tr_b16 v[96:97], v44 offset:0
  ds_read_b64_tr_b16 v[98:99], v44 offset:2048
  ds_read_b64_tr_b16 v[100:101], v45 offset:0
  ds_read_b64_tr_b16 v[102:103], v45 offset:2048
  ds_read_b64_tr_b16 v[104:105], v46 offset:0
  ds_read_b64_tr_b16 v[106:107], v46 offset:2048
  ds_read_b64_tr_b16 v[108:109], v47 offset:0
  ds_read_b64_tr_b16 v[110:111], v47 offset:2048
  s_waitcnt lgkmcnt(0)
  v_mfma_f32_16x16x32_bf16 v[176:179], v[96:99], v[128:131], 0
  ds_read_b128 v[148:151], v49 offset:0
  v_mfma_f32_16x16x32_bf16 v[180:183], v[96:99], v[132:135], 0
  ds_read_b128 v[152:155], v49 offset:2048
  s_cmp_ge_u32 s24, 4
  s_cbranch_scc1 L_sk3
  s_add_u32 m0, s36, 155648
  s_add_u32 s32, s52, 256
  buffer_load_dwordx4 v42, s[4:7], s32 offen lds
L_sk3:
  v_mfma_f32_16x16x32_bf16 v[184:187], v[96:99], v[136:139], 0
  ds_read_b128 v[156:159], v49 offset:4096
  v_mfma_f32_16x16x32_bf16 v[188:191], v[96:99], v[140:143], 0
  ds_read_b128 v[160:163], v49 offset:6144
  v_mfma_f32_16x16x32_bf16 v[192:195], v[96:99], v[144:147], 0
  ds_read_b128 v[164:167], v49 offset:8192
  s_add_u32 m0, s36, 106496
  s_add_u32 s32, s38, 1048576
  buffer_load_dwordx4 v43, s[8:11], s32 offen lds
  v_mfma_f32_16x16x32_bf16 v[196:199], v[100:103], v[128:131], 0
  ds_read_b64_tr_b16 v[112:113], v44 offset:16384
  v_mfma_f32_16x16x32_bf16 v[200:203], v[100:103], v[132:135], 0
  ds_read_b64_tr_b16 v[114:115], v44 offset:18432
  v_mfma_f32_16x16x32_bf16 v[204:207], v[100:103], v[136:139], 0
  ds_read_b64_tr_b16 v[116:117], v45 offset:16384
  s_add_u32 m0, s36, 114688
  s_add_u32 s32, s38, 1179648
  buffer_load_dwordx4 v43, s[8:11], s32 offen lds
  v_mfma_f32_16x16x32_bf16 v[208:211], v[100:103], v[140:143], 0
  ds_read_b64_tr_b16 v[118:119], v45 offset:18432
  v_mfma_f32_16x16x32_bf16 v[212:215], v[100:103], v[144:147], 0
  ds_read_b64_tr_b16 v[120:121], v46 offset:16384
  v_mfma_f32_16x16x32_bf16 v[216:219], v[104:107], v[128:131], 0
  ds_read_b64_tr_b16 v[122:123], v46 offset:18432
  s_add_u32 m0, s36, 122880
  s_add_u32 s32, s38, 1310720
  buffer_load_dwordx4 v43, s[8:11], s32 offen lds
  v_mfma_f32_16x16x32_bf16 v[220:223], v[104:107], v[132:135], 0
  ds_read_b64_tr_b16 v[124:125], v47 offset:16384
  v_mfma_f32_16x16x32_bf16 v[224:227], v[104:107], v[136:139], 0
  ds_read_b64_tr_b16 v[126:127], v47 offset:18432
  v_mfma_f32_16x16x32_bf16 v[228:231], v[104:107], v[140:143], 0
  s_mov_b32 s33, 53248
  v_add_u32 v44, s33, v44
  s_add_u32 m0, s36, 131072
  s_add_u32 s32, s38, 1441792
  buffer_load_dwordx4 v43, s[8:11], s32 offen lds
  v_mfma_f32_16x16x32_bf16 v[232:235], v[104:107], v[144:147], 0
  v_add_u32 v45, s33, v45
  v_mfma_f32_16x16x32_bf16 v[236:239], v[108:111], v[128:131], 0
  v_add_u32 v46, s33, v46
  v_mfma_f32_16x16x32_bf16 v[240:243], v[108:111], v[132:135], 0
  v_add_u32 v47, s33, v47
  s_add_u32 m0, s36, 139264
  s_add_u32 s32, s50, 256
  buffer_load_dwordx4 v42, s[4:7], s32 offen lds
  v_mfma_f32_16x16x32_bf16 v[244:247], v[108:111], v[136:139], 0
  v_add_u32 v48, s33, v48
  v_mfma_f32_16x16x32_bf16 v[248:251], v[108:111], v[140:143], 0
  v_add_u32 v49, s33, v49
  v_mfma_f32_16x16x32_bf16 v[252:255], v[108:111], v[144:147], 0
  s_add_u32 m0, s36, 147456
  s_add_u32 s32, s51, 256
  buffer_load_dwordx4 v42, s[4:7], s32 offen lds
  s_waitcnt lgkmcnt(0)
  s_waitcnt vmcnt(6)
  s_barrier
  v_mfma_f32_16x16x32_bf16 v[176:179], v[112:115], v[148:151], v[176:179]
  ds_read_b128 v[128:131], v48 offset:0
  v_mfma_f32_16x16x32_bf16 v[180:183], v[112:115], v[152:155], v[180:183]
  ds_read_b128 v[132:135], v48 offset:2048
  s_cmp_ge_u32 s24, 4
  s_cbranch_scc1 L_sk4
  s_add_u32 m0, s36, 49152
  s_add_u32 s32, s52, 384
  buffer_load_dwordx4 v42, s[4:7], s32 offen lds
L_sk4:
  v_mfma_f32_16x16x32_bf16 v[184:187], v[112:115], v[156:159], v[184:187]
  ds_read_b128 v[136:139], v48 offset:4096
  v_mfma_f32_16x16x32_bf16 v[188:191], v[112:115], v[160:163], v[188:191]
  ds_read_b128 v[140:143], v48 offset:6144
  v_mfma_f32_16x16x32_bf16 v[192:195], v[112:115], v[164:167], v[192:195]
  ds_read_b128 v[144:147], v48 offset:8192
  v_mfma_f32_16x16x32_bf16 v[196:199], v[116:119], v[148:151], v[196:199]
  ds_read_b64_tr_b16 v[96:97], v44 offset:0
  v_mfma_f32_16x16x32_bf16 v[200:203], v[116:119], v[152:155], v[200:203]
  ds_read_b64_tr_b16 v[98:99], v44 offset:2048
  s_add_u32 m0, s36, 0
  s_add_u32 s32, s38, 1572864
  buffer_load_dwordx4 v43, s[8:11], s32 offen lds
  v_mfma_f32_16x16x32_bf16 v[204:207], v[116:119], v[156:159], v[204:207]
  ds_read_b64_tr_b16 v[100:101], v45 offset:0
  v_mfma_f32_16x16x32_bf16 v[208:211], v[116:119], v[160:163], v[208:211]
  ds_read_b64_tr_b16 v[102:103], v45 offset:2048
  v_mfma_f32_16x16x32_bf16 v[212:215], v[116:119], v[164:167], v[212:215]
  ds_read_b64_tr_b16 v[104:105], v46 offset:0
  v_mfma_f32_16x16x32_bf16 v[216:219], v[120:123], v[148:151], v[216:219]
  ds_read_b64_tr_b16 v[106:107], v46 offset:2048
  v_mfma_f32_16x16x32_bf16 v[220:223], v[120:123], v[152:155], v[220:223]
  ds_read_b64_tr_b16 v[108:109], v47 offset:0
  s_add_u32 m0, s36, 8192
  s_add_u32 s32, s38, 1703936
  buffer_load_dwordx4 v43, s[8:11], s32 offen lds
  v_mfma_f32_16x16x32_bf16 v[224:227], v[120:123], v[156:159], v[224:227]
  ds_read_b64_tr_b16 v[110:111], v47 offset:2048
  v_mfma_f32_16x16x32_bf16 v[228:231], v[120:123], v[160:163], v[228:231]
  v_mfma_f32_16x16x32_bf16 v[232:235], v[120:123], v[164:167], v[232:235]
  v_mfma_f32_16x16x32_bf16 v[236:239], v[124:127], v[148:151], v[236:239]
  v_mfma_f32_16x16x32_bf16 v[240:243], v[124:127], v[152:155], v[240:243]
  s_add_u32 m0, s36, 16384
  s_add_u32 s32, s38, 1835008
  buffer_load_dwordx4 v43, s[8:11], s32 offen lds
  v_mfma_f32_16x16x32_bf16 v[244:247], v[124:127], v[156:159], v[244:247]
  v_mfma_f32_16x16x32_bf16 v[248:251], v[124:127], v[160:163], v[248:251]
  v_mfma_f32_16x16x32_bf16 v[252:255], v[124:127], v[164:167], v[252:255]
  s_waitcnt lgkmcnt(0)
  v_mfma_f32_16x16x32_bf16 v[176:179], v[96:99], v[128:131], v[176:179]
  v_mfma_f32_16x16x32_bf16 v[180:183], v[96:99], v[132:135], v[180:183]
  s_add_u32 m0, s36, 24576
  s_add_u32 s32, s38, 1966080
  buffer_load_dwordx4 v43, s[8:11], s32 offen lds
  v_mfma_f32_16x16x32_bf16 v[184:187], v[96:99], v[136:139], v[184:187]
  ds_read_b128 v[148:151], v49 offset:0
  v_mfma_f32_16x16x32_bf16 v[188:191], v[96:99], v[140:143], v[188:191]
  ds_read_b128 v[152:155], v49 offset:2048
  v_mfma_f32_16x16x32_bf16 v[192:195], v[96:99], v[144:147], v[192:195]
  ds_read_b128 v[156:159], v49 offset:4096
  v_mfma_f32_16x16x32_bf16 v[196:199], v[100:103], v[128:131], v[196:199]
  ds_read_b128 v[160:163], v49 offset:6144
  v_mfma_f32_16x16x32_bf16 v[200:203], v[100:103], v[132:135], v[200:203]
  ds_read_b128 v[164:167], v49 offset:8192
  s_add_u32 m0, s36, 32768
  s_add_u32 s32, s50, 384
  buffer_load_dwordx4 v42, s[4:7], s32 offen lds
  v_mfma_f32_16x16x32_bf16 v[204:207], v[100:103], v[136:139], v[204:207]
  ds_read_b64_tr_b16 v[112:113], v44 offset:16384
  v_mfma_f32_16x16x32_bf16 v[208:211], v[100:103], v[140:143], v[208:211]
  ds_read_b64_tr_b16 v[114:115], v44 offset:18432
  v_mfma_f32_16x16x32_bf16 v[212:215], v[100:103], v[144:147], v[212:215]
  ds_read_b64_tr_b16 v[116:117], v45 offset:16384
  v_mfma_f32_16x16x32_bf16 v[216:219], v[104:107], v[128:131], v[216:219]
  ds_read_b64_tr_b16 v[118:119], v45 offset:18432
  v_mfma_f32_16x16x32_bf16 v[220:223], v[104:107], v[132:135], v[220:223]
  ds_read_b64_tr_b16 v[120:121], v46 offset:16384
  s_add_u32 m0, s36, 40960
  s_add_u32 s32, s51, 384
  buffer_load_dwordx4 v42, s[4:7], s32 offen lds
  v_mfma_f32_16x16x32_bf16 v[224:227], v[104:107], v[136:139], v[224:227]
  ds_read_b64_tr_b16 v[122:123], v46 offset:18432
  v_mfma_f32_16x16x32_bf16 v[228:231], v[104:107], v[140:143], v[228:231]
  ds_read_b64_tr_b16 v[124:125], v47 offset:16384
  v_mfma_f32_16x16x32_bf16 v[232:235], v[104:107], v[144:147], v[232:235]
  ds_read_b64_tr_b16 v[126:127], v47 offset:18432
  v_mfma_f32_16x16x32_bf16 v[236:239], v[108:111], v[128:131], v[236:239]
  s_mov_b32 s33, 53248
  v_add_u32 v44, s33, v44
  v_mfma_f32_16x16x32_bf16 v[240:243], v[108:111], v[132:135], v[240:243]
  v_add_u32 v45, s33, v45
  v_mfma_f32_16x16x32_bf16 v[244:247], v[108:111], v[136:139], v[244:247]
  v_add_u32 v46, s33, v46
  v_mfma_f32_16x16x32_bf16 v[248:251], v[108:111], v[140:143], v[248:251]
  v_add_u32 v47, s33, v47
  v_mfma_f32_16x16x32_bf16 v[252:255], v[108:111], v[144:147], v[252:255]
  v_add_u32 v48, s33, v48
  v_add_u32 v49, s33, v49
  s_waitcnt lgkmcnt(0)
  s_waitcnt vmcnt(6)
  s_barrier
  v_mfma_f32_16x16x32_bf16 v[176:179], v[112:115], v[148:151], v[176:179]
  ds_read_b128 v[128:131], v48 offset:0
  v_mfma_f32_16x16x32_bf16 v[180:183], v[112:115], v[152:155], v[180:183]
  ds_read_b128 v[132:135], v48 offset:2048
  s_cmp_ge_u32 s24, 4
  s_cbranch_scc1 L_sk5
  s_add_u32 m0, s36, 102400
  s_add_u32 s32, s52, 512
  buffer_load_dwordx4 v42, s[4:7], s32 offen lds
L_sk5:
  v_mfma_f32_16x16x32_bf16 v[184:187], v[112:115], v[156:159], v[184:187]
  ds_read_b128 v[136:139], v48 offset:4096
  v_mfma_f32_16x16x32_bf16 v[188:191], v[112:115], v[160:163], v[188:191]
  ds_read_b128 v[140:143], v48 offset:6144
  v_mfma_f32_16x16x32_bf16 v[192:195], v[112:115], v[164:167], v[192:195]
  ds_read_b128 v[144:147], v48 offset:8192
  v_mfma_f32_16x16x32_bf16 v[196:199], v[116:119], v[148:151], v[196:199]
  ds_read_b64_tr_b16 v[96:97], v44 offset:0
  v_mfma_f32_16x16x32_bf16 v[200:203], v[116:119], v[152:155], v[200:203]
  ds_read_b64_tr_b16 v[98:99], v44 offset:2048
  s_add_u32 m0, s36, 53248
  s_add_u32 s32, s38, 2097152
  buffer_load_dwordx4 v43, s[8:11], s32 offen lds
  v_mfma_f32_16x16x32_bf16 v[204:207], v[116:119], v[156:159], v[204:207]
  ds_read_b64_tr_b16 v[100:101], v45 offset:0
  v_mfma_f32_16x16x32_bf16 v[208:211], v[116:119], v[160:163], v[208:211]
  ds_read_b64_tr_b16 v[102:103], v45 offset:2048
  v_mfma_f32_16x16x32_bf16 v[212:215], v[116:119], v[164:167], v[212:215]
  ds_read_b64_tr_b16 v[104:105], v46 offset:0
  v_mfma_f32_16x16x32_bf16 v[216:219], v[120:123], v[148:151], v[216:219]
  ds_read_b64_tr_b16 v[106:107], v46 offset:2048
  v_mfma_f32_16x16x32_bf16 v[220:223], v[120:123], v[152:155], v[220:223]
  ds_read_b64_tr_b16 v[108:109], v47 offset:0
  s_add_u32 m0, s36, 61440
  s_add_u32 s32, s38, 2228224
  buffer_load_dwordx4 v43, s[8:11], s32 offen lds
  v_mfma_f32_16x16x32_bf16 v[224:227], v[120:123], v[156:159], v[224:227]
  ds_read_b64_tr_b16 v[110:111], v47 offset:2048
  v_mfma_f32_16x16x32_bf16 v[228:231], v[120:123], v[160:163], v[228:231]
  v_mfma_f32_16x16x32_bf16 v[232:235], v[120:123], v[164:167], v[232:235]
  v_mfma_f32_16x16x32_bf16 v[236:239], v[124:127], v[148:151], v[236:239]
  v_mfma_f32_16x16x32_bf16 v[240:243], v[124:127], v[152:155], v[240:243]
  s_add_u32 m0, s36, 69632
  s_add_u32 s32, s38, 2359296
  buffer_load_dwordx4 v43, s[8:11], s32 offen lds
  v_mfma_f32_16x16x32_bf16 v[244:247], v[124:127], v[156:159], v[244:247]
  v_mfma_f32_16x16x32_bf16 v[248:251], v[124:127], v[160:163], v[248:251]
  v_mfma_f32_16x16x32_bf16 v[252:255], v[124:127], v[164:167], v[252:255]
  s_waitcnt lgkmcnt(0)
  v_mfma_f32_16x16x32_bf16 v[176:179], v[96:99], v[128:131], v[176:179]
  v_mfma_f32_16x16x32_bf16 v[180:183], v[96:99], v[132:135], v[180:183]
  s_add_u32 m0, s36, 77824
  s_add_u32 s32, s38, 2490368
  buffer_load_dwordx4 v43, s[8:11], s32 offen lds
  v_mfma_f32_16x16x32_bf16 v[184:187], v[96:99], v[136:139], v[184:187]
  ds_read_b128 v[148:151], v49 offset:0
  v_mfma_f32_16x16x32_bf16 v[188:191], v[96:99], v[140:143], v[188:191]
  ds_read_b128 v[152:155], v49 offset:2048
  v_mfma_f32_16x16x32_bf16 v[192:195], v[96:99], v[144:147], v[192:195]
  ds_read_b128 v[156:159], v49 offset:4096
  v_mfma_f32_16x16x32_bf16 v[196:199], v[100:103], v[128:131], v[196:199]
  ds_read_b128 v[160:163], v49 offset:6144
  v_mfma_f32_16x16x32_bf16 v[200:203], v[100:103], v[132:135], v[200:203]
  ds_read_b128 v[164:167], v49 offset:8192
  s_add_u32 m0, s36, 86016
  s_add_u32 s32, s50, 512
  buffer_load_dwordx4 v42, s[4:7], s32 offen lds
  v_mfma_f32_16x16x32_bf16 v[204:207], v[100:103], v[136:139], v[204:207]
  ds_read_b64_tr_b16 v[112:113], v44 offset:16384
  v_mfma_f32_16x16x32_bf16 v[208:211], v[100:103], v[140:143], v[208:211]
  ds_read_b64_tr_b16 v[114:115], v44 offset:18432
  v_mfma_f32_16x16x32_bf16 v[212:215], v[100:103], v[144:147], v[212:215]
  ds_read_b64_tr_b16 v[116:117], v45 offset:16384
  v_mfma_f32_16x16x32_bf16 v[216:219], v[104:107], v[128:131], v[216:219]
  ds_read_b64_tr_b16 v[118:119], v45 offset:18432
  v_mfma_f32_16x16x32_bf16 v[220:223], v[104:107], v[132:135], v[220:223]
  ds_read_b64_tr_b16 v[120:121], v46 offset:16384
  s_add_u32 m0, s36, 94208
  s_add_u32 s32, s51, 512
  buffer_load_dwordx4 v42, s[4:7], s32 offen lds
  v_mfma_f32_16x16x32_bf16 v[224:227], v[104:107], v[136:139], v[224:227]
  ds_read_b64_tr_b16 v[122:123], v46 offset:18432
  v_mfma_f32_16x16x32_bf16 v[228:231], v[104:107], v[140:143], v[228:231]
  ds_read_b64_tr_b16 v[124:125], v47 offset:16384
  v_mfma_f32_16x16x32_bf16 v[232:235], v[104:107], v[144:147], v[232:235]
  ds_read_b64_tr_b16 v[126:127], v47 offset:18432
  v_mfma_f32_16x16x32_bf16 v[236:239], v[108:111], v[128:131], v[236:239]
  s_mov_b32 s33, 4294860800
  v_add_u32 v44, s33, v44
  v_mfma_f32_16x16x32_bf16 v[240:243], v[108:111], v[132:135], v[240:243]
  v_add_u32 v45, s33, v45
  v_mfma_f32_16x16x32_bf16 v[244:247], v[108:111], v[136:139], v[244:247]
  v_add_u32 v46, s33, v46
  v_mfma_f32_16x16x32_bf16 v[248:251], v[108:111], v[140:143], v[248:251]
  v_add_u32 v47, s33, v47
  v_mfma_f32_16x16x32_bf16 v[252:255], v[108:111], v[144:147], v[252:255]
  v_add_u32 v48, s33, v48
  v_add_u32 v49, s33, v49
  s_waitcnt lgkmcnt(0)
  s_waitcnt vmcnt(6)
  s_barrier
  v_mfma_f32_16x16x32_bf16 v[176:179], v[112:115], v[148:151], v[176:179]
  ds_read_b128 v[128:131], v48 offset:0
  v_mfma_f32_16x16x32_bf16 v[180:183], v[112:115], v[152:155], v[180:183]
  ds_read_b128 v[132:135], v48 offset:2048
  s_cmp_ge_u32 s24, 4
  s_cbranch_scc1 L_sk6
  s_add_u32 m0, s36, 155648
  s_add_u32 s32, s52, 640
  buffer_load_dwordx4 v42, s[4:7], s32 offen lds
L_sk6:
  v_mfma_f32_16x16x32_bf16 v[184:187], v[112:115], v[156:159], v[184:187]
  ds_read_b128 v[136:139], v48 offset:4096
  v_mfma_f32_16x16x32_bf16 v[188:191], v[112:115], v[160:163], v[188:191]
  ds_read_b128 v[140:143], v48 offset:6144
  v_mfma_f32_16x16x32_bf16 v[192:195], v[112:115], v[164:167], v[192:195]
  ds_read_b128 v[144:147], v48 offset:8192
  v_mfma_f32_16x16x32_bf16 v[196:199], v[116:119], v[148:151], v[196:199]
  ds_read_b64_tr_b16 v[96:97], v44 offset:0
  v_mfma_f32_16x16x32_bf16 v[200:203], v[116:119], v[152:155], v[200:203]
  ds_read_b64_tr_b16 v[98:99], v44 offset:2048
  s_add_u32 m0, s36, 106496
  s_add_u32 s32, s38, 2621440
  buffer_load_dwordx4 v43, s[8:11], s32 offen lds
  v_mfma_f32_16x16x32_bf16 v[204:207], v[116:119], v[156:159], v[204:207]
  ds_read_b64_tr_b16 v[100:101], v45 offset:0
  v_mfma_f32_16x16x32_bf16 v[208:211], v[116:119], v[160:163], v[208:211]
  ds_read_b64_tr_b16 v[102:103], v45 offset:2048
  v_mfma_f32_16x16x32_bf16 v[212:215], v[116:119], v[164:167], v[212:215]
  ds_read_b64_tr_b16 v[104:105], v46 offset:0
  v_mfma_f32_16x16x32_bf16 v[216:219], v[120:123], v[148:151], v[216:219]
  ds_read_b64_tr_b16 v[106:107], v46 offset:2048
  v_mfma_f32_16x16x32_bf16 v[220:223], v[120:123], v[152:155], v[220:223]
  ds_read_b64_tr_b16 v[108:109], v47 offset:0
  s_add_u32 m0, s36, 114688
  s_add_u32 s32, s38, 2752512
  buffer_load_dwordx4 v43, s[8:11], s32 offen lds
  v_mfma_f32_16x16x32_bf16 v[224:227], v[120:123], v[156:159], v[224:227]
  ds_read_b64_tr_b16 v[110:111], v47 offset:2048
  v_mfma_f32_16x16x32_bf16 v[228:231], v[120:123], v[160:163], v[228:231]
  v_mfma_f32_16x16x32_bf16 v[232:235], v[120:123], v[164:167], v[232:235]
  v_mfma_f32_16x16x32_bf16 v[236:239], v[124:127], v[148:151], v[236:239]
  v_mfma_f32_16x16x32_bf16 v[240:243], v[124:127], v[152:155], v[240:243]
  s_add_u32 m0, s36, 122880
  s_add_u32 s32, s38, 2883584
  buffer_load_dwordx4 v43, s[8:11], s32 offen lds
  v_mfma_f32_16x16x32_bf16 v[244:247], v[124:127], v[156:159], v[244:247]
  v_mfma_f32_16x16x32_bf16 v[248:251], v[124:127], v[160:163], v[248:251]
  v_mfma_f32_16x16x32_bf16 v[252:255], v[124:127], v[164:167], v[252:255]
  s_waitcnt lgkmcnt(0)
  v_mfma_f32_16x16x32_bf16 v[176:179], v[96:99], v[128:131], v[176:179]
  v_mfma_f32_16x16x32_bf16 v[180:183], v[96:99], v[132:135], v[180:183]
  s_add_u32 m0, s36, 131072
  s_add_u32 s32, s38, 3014656
  buffer_load_dwordx4 v43, s[8:11], s32 offen lds
  v_mfma_f32_16x16x32_bf16 v[184:187], v[96:99], v[136:139], v[184:187]
  ds_read_b128 v[148:151], v49 offset:0
  v_mfma_f32_16x16x32_bf16 v[188:191], v[96:99], v[140:143], v[188:191]
  ds_read_b128 v[152:155], v49 offset:2048
  v_mfma_f32_16x16x32_bf16 v[192:195], v[96:99], v[144:147], v[192:195]
  ds_read_b128 v[156:159], v49 offset:4096
  v_mfma_f32_16x16x32_bf16 v[196:199], v[100:103], v[128:131], v[196:199]
  ds_read_b128 v[160:163], v49 offset:6144
  v_mfma_f32_16x16x32_bf16 v[200:203], v[100:103], v[132:135], v[200:203]
  ds_read_b128 v[164:167], v49 offset:8192
  s_add_u32 m0, s36, 139264
  s_add_u32 s32, s50, 640
  buffer_load_dwordx4 v42, s[4:7], s32 offen lds
  v_mfma_f32_16x16x32_bf16 v[204:207], v[100:103], v[136:139], v[204:207]
  ds_read_b64_tr_b16 v[112:113], v44 offset:16384
  v_mfma_f32_16x16x32_bf16 v[208:211], v[100:103], v[140:143], v[208:211]
  ds_read_b64_tr_b16 v[114:115], v44 offset:18432
  v_mfma_f32_16x16x32_bf16 v[212:215], v[100:103], v[144:147], v[212:215]
  ds_read_b64_tr_b16 v[116:117], v45 offset:16384
  v_mfma_f32_16x16x32_bf16 v[216:219], v[104:107], v[128:131], v[216:219]
  ds_read_b64_tr_b16 v[118:119], v45 offset:18432
  v_mfma_f32_16x16x32_bf16 v[220:223], v[104:107], v[132:135], v[220:223]
  ds_read_b64_tr_b16 v[120:121], v46 offset:16384
  s_add_u32 m0, s36, 147456
  s_add_u32 s32, s51, 640
  buffer_load_dwordx4 v42, s[4:7], s32 offen lds
  v_mfma_f32_16x16x32_bf16 v[224:227], v[104:107], v[136:139], v[224:227]
  ds_read_b64_tr_b16 v[122:123], v46 offset:18432
  v_mfma_f32_16x16x32_bf16 v[228:231], v[104:107], v[140:143], v[228:231]
  ds_read_b64_tr_b16 v[124:125], v47 offset:16384
  v_mfma_f32_16x16x32_bf16 v[232:235], v[104:107], v[144:147], v[232:235]
  ds_read_b64_tr_b16 v[126:127], v47 offset:18432
  v_mfma_f32_16x16x32_bf16 v[236:239], v[108:111], v[128:131], v[236:239]
  s_mov_b32 s33, 53248
  v_add_u32 v44, s33, v44
  v_mfma_f32_16x16x32_bf16 v[240:243], v[108:111], v[132:135], v[240:243]
  v_add_u32 v45, s33, v45
  v_mfma_f32_16x16x32_bf16 v[244:247], v[108:111], v[136:139], v[244:247]
  v_add_u32 v46, s33, v46
  v_mfma_f32_16x16x32_bf16 v[248:251], v[108:111], v[140:143], v[248:251]
  v_add_u32 v47, s33, v47
  v_mfma_f32_16x16x32_bf16 v[252:255], v[108:111], v[144:147], v[252:255]
  v_add_u32 v48, s33, v48
  v_add_u32 v49, s33, v49
  s_waitcnt lgkmcnt(0)
  s_waitcnt vmcnt(6)
  s_barrier
  v_mfma_f32_16x16x32_bf16 v[176:179], v[112:115], v[148:151], v[176:179]
  ds_read_b128 v[128:131], v48 offset:0
  v_mfma_f32_16x16x32_bf16 v[180:183], v[112:115], v[152:155], v[180:183]
  ds_read_b128 v[132:135], v48 offset:2048
  s_cmp_ge_u32 s24, 4
  s_cbranch_scc1 L_sk7
  s_add_u32 m0, s36, 49152
  s_add_u32 s32, s52, 768
  buffer_load_dwordx4 v42, s[4:7], s32 offen lds
L_sk7:
  v_mfma_f32_16x16x32_bf16 v[184:187], v[112:115], v[156:159], v[184:187]
  ds_read_b128 v[136:139], v48 offset:4096
  v_mfma_f32_16x16x32_bf16 v[188:191], v[112:115], v[160:163], v[188:191]
  ds_read_b128 v[140:143], v48 offset:6144
  v_mfma_f32_16x16x32_bf16 v[192:195], v[112:115], v[164:167], v[192:195]
  ds_read_b128 v[144:147], v48 offset:8192
  v_mfma_f32_16x16x32_bf16 v[196:199], v[116:119], v[148:151], v[196:199]
  ds_read_b64_tr_b16 v[96:97], v44 offset:0
  v_mfma_f32_16x16x32_bf16 v[200:203], v[116:119], v[152:155], v[200:203]
  ds_read_b64_tr_b16 v[98:99], v44 offset:2048
  s_add_u32 m0, s36, 0
  s_add_u32 s32, s38, 3145728
  buffer_load_dwordx4 v43, s[8:11], s32 offen lds
  v_mfma_f32_16x16x32_bf16 v[204:207], v[116:119], v[156:159], v[204:207]
  ds_read_b64_tr_b16 v[100:101], v45 offset:0
  v_mfma_f32_16x16x32_bf16 v[208:211], v[116:119], v[160:163], v[208:211]
  ds_read_b64_tr_b16 v[102:103], v45 offset:2048
  v_mfma_f32_16x16x32_bf16 v[212:215], v[116:119], v[164:167], v[212:215]
  ds_read_b64_tr_b16 v[104:105], v46 offset:0
  v_mfma_f32_16x16x32_bf16 v[216:219], v[120:123], v[148:151], v[216:219]
  ds_read_b64_tr_b16 v[106:107], v46 offset:2048
  v_mfma_f32_16x16x32_bf16 v[220:223], v[120:123], v[152:155], v[220:223]
  ds_read_b64_tr_b16 v[108:109], v47 offset:0
  s_add_u32 m0, s36, 8192
  s_add_u32 s32, s38, 3276800
  buffer_load_dwordx4 v43, s[8:11], s32 offen lds
  v_mfma_f32_16x16x32_bf16 v[224:227], v[120:123], v[156:159], v[224:227]
  ds_read_b64_tr_b16 v[110:111], v47 offset:2048
  v_mfma_f32_16x16x32_bf16 v[228:231], v[120:123], v[160:163], v[228:231]
  v_mfma_f32_16x16x32_bf16 v[232:235], v[120:123], v[164:167], v[232:235]
  v_mfma_f32_16x16x32_bf16 v[236:239], v[124:127], v[148:151], v[236:239]
  v_mfma_f32_16x16x32_bf16 v[240:243], v[124:127], v[152:155], v[240:243]
  s_add_u32 m0, s36, 16384
  s_add_u32 s32, s38, 3407872
  buffer_load_dwordx4 v43, s[8:11], s32 offen lds
  v_mfma_f32_16x16x32_bf16 v[244:247], v[124:127], v[156:159], v[244:247]
  v_mfma_f32_16x16x32_bf16 v[248:251], v[124:127], v[160:163], v[248:251]
  v_mfma_f32_16x16x32_bf16 v[252:255], v[124:127], v[164:167], v[252:255]
  s_waitcnt lgkmcnt(0)
  v_mfma_f32_16x16x32_bf16 v[176:179], v[96:99], v[128:131], v[176:179]
  v_mfma_f32_16x16x32_bf16 v[180:183], v[96:99], v[132:135], v[180:183]
  s_add_u32 m0, s36, 24576
  s_add_u32 s32, s38, 3538944
  buffer_load_dwordx4 v43, s[8:11], s32 offen lds
  v_mfma_f32_16x16x32_bf16 v[184:187], v[96:99], v[136:139], v[184:187]
  ds_read_b128 v[148:151], v49 offset:0
  v_mfma_f32_16x16x32_bf16 v[188:191], v[96:99], v[140:143], v[188:191]
  ds_read_b128 v[152:155], v49 offset:2048
  v_mfma_f32_16x16x32_bf16 v[192:195], v[96:99], v[144:147], v[192:195]
  ds_read_b128 v[156:159], v49 offset:4096
  v_mfma_f32_16x16x32_bf16 v[196:199], v[100:103], v[128:131], v[196:199]
  ds_read_b128 v[160:163], v49 offset:6144
  v_mfma_f32_16x16x32_bf16 v[200:203], v[100:103], v[132:135], v[200:203]
  ds_read_b128 v[164:167], v49 offset:8192
  s_add_u32 m0, s36, 32768
  s_add_u32 s32, s50, 768
  buffer_load_dwordx4 v42, s[4:7], s32 offen lds
  v_mfma_f32_16x16x32_bf16 v[204:207], v[100:103], v[136:139], v[204:207]
  ds_read_b64_tr_b16 v[112:113], v44 offset:16384
  v_mfma_f32_16x16x32_bf16 v[208:211], v[100:103], v[140:143], v[208:211]
  ds_read_b64_tr_b16 v[114:115], v44 offset:18432
  v_mfma_f32_16x16x32_bf16 v[212:215], v[100:103], v[144:147], v[212:215]
  ds_read_b64_tr_b16 v[116:117], v45 offset:16384
  v_mfma_f32_16x16x32_bf16 v[216:219], v[104:107], v[128:131], v[216:219]
  ds_read_b64_tr_b16 v[118:119], v45 offset:18432
  v_mfma_f32_16x16x32_bf16 v[220:223], v[104:107], v[132:135], v[220:223]
  ds_read_b64_tr_b16 v[120:121], v46 offset:16384
  s_add_u32 m0, s36, 40960
  s_add_u32 s32, s51, 768
  buffer_load_dwordx4 v42, s[4:7], s32 offen lds
  v_mfma_f32_16x16x32_bf16 v[224:227], v[104:107], v[136:139], v[224:227]
  ds_read_b64_tr_b16 v[122:123], v46 offset:18432
  v_mfma_f32_16x16x32_bf16 v[228:231], v[104:107], v[140:143], v[228:231]
  ds_read_b64_tr_b16 v[124:125], v47 offset:16384
  v_mfma_f32_16x16x32_bf16 v[232:235], v[104:107], v[144:147], v[232:235]
  ds_read_b64_tr_b16 v[126:127], v47 offset:18432
  v_mfma_f32_16x16x32_bf16 v[236:239], v[108:111], v[128:131], v[236:239]
  s_mov_b32 s33, 53248
  v_add_u32 v44, s33, v44
  v_mfma_f32_16x16x32_bf16 v[240:243], v[108:111], v[132:135], v[240:243]
  v_add_u32 v45, s33, v45
  v_mfma_f32_16x16x32_bf16 v[244:247], v[108:111], v[136:139], v[244:247]
  v_add_u32 v46, s33, v46
  v_mfma_f32_16x16x32_bf16 v[248:251], v[108:111], v[140:143], v[248:251]
  v_add_u32 v47, s33, v47
  v_mfma_f32_16x16x32_bf16 v[252:255], v[108:111], v[144:147], v[252:255]
  v_add_u32 v48, s33, v48
  v_add_u32 v49, s33, v49
  s_waitcnt lgkmcnt(0)
  s_waitcnt vmcnt(6)
  s_barrier
  v_mfma_f32_16x16x32_bf16 v[176:179], v[112:115], v[148:151], v[176:179]
  ds_read_b128 v[128:131], v48 offset:0
  v_mfma_f32_16x16x32_bf16 v[180:183], v[112:115], v[152:155], v[180:183]
  ds_read_b128 v[132:135], v48 offset:2048
  v_mfma_f32_16x16x32_bf16 v[184:187], v[112:115], v[156:159], v[184:187]
  ds_read_b128 v[136:139], v48 offset:4096
  v_mfma_f32_16x16x32_bf16 v[188:191], v[112:115], v[160:163], v[188:191]
  ds_read_b128 v[140:143], v48 offset:6144
  v_mfma_f32_16x16x32_bf16 v[192:195], v[112:115], v[164:167], v[192:195]
  ds_read_b128 v[144:147], v48 offset:8192
  v_mfma_f32_16x16x32_bf16 v[196:199], v[116:119], v[148:151], v[196:199]
  ds_read_b64_tr_b16 v[96:97], v44 offset:0
  v_mfma_f32_16x16x32_bf16 v[200:203], v[116:119], v[152:155], v[200:203]
  ds_read_b64_tr_b16 v[98:99], v44 offset:2048
  v_mfma_f32_16x16x32_bf16 v[204:207], v[116:119], v[156:159], v[204:207]
  ds_read_b64_tr_b16 v[100:101], v45 offset:0
  v_mfma_f32_16x16x32_bf16 v[208:211], v[116:119], v[160:163], v[208:211]
  ds_read_b64_tr_b16 v[102:103], v45 offset:2048
  v_mfma_f32_16x16x32_bf16 v[212:215], v[116:119], v[164:167], v[212:215]
  ds_read_b64_tr_b16 v[104:105], v46 offset:0
  v_mfma_f32_16x16x32_bf16 v[216:219], v[120:123], v[148:151], v[216:219]
  ds_read_b64_tr_b16 v[106:107], v46 offset:2048
  v_mfma_f32_16x16x32_bf16 v[220:223], v[120:123], v[152:155], v[220:223]
  ds_read_b64_tr_b16 v[108:109], v47 offset:0
  v_mfma_f32_16x16x32_bf16 v[224:227], v[120:123], v[156:159], v[224:227]
  ds_read_b64_tr_b16 v[110:111], v47 offset:2048
  v_mfma_f32_16x16x32_bf16 v[228:231], v[120:123], v[160:163], v[228:231]
  v_mfma_f32_16x16x32_bf16 v[232:235], v[120:123], v[164:167], v[232:235]
  v_mfma_f32_16x16x32_bf16 v[236:239], v[124:127], v[148:151], v[236:239]
  v_mfma_f32_16x16x32_bf16 v[240:243], v[124:127], v[152:155], v[240:243]
  v_mfma_f32_16x16x32_bf16 v[244:247], v[124:127], v[156:159], v[244:247]
  v_mfma_f32_16x16x32_bf16 v[248:251], v[124:127], v[160:163], v[248:251]
  v_mfma_f32_16x16x32_bf16 v[252:255], v[124:127], v[164:167], v[252:255]
  s_waitcnt lgkmcnt(0)
  v_mfma_f32_16x16x32_bf16 v[176:179], v[96:99], v[128:131], v[176:179]
  v_mfma_f32_16x16x32_bf16 v[180:183], v[96:99], v[132:135], v[180:183]
  v_mfma_f32_16x16x32_bf16 v[184:187], v[96:99], v[136:139], v[184:187]
  ds_read_b128 v[148:151], v49 offset:0
  v_mfma_f32_16x16x32_bf16 v[188:191], v[96:99], v[140:143], v[188:191]
  ds_read_b128 v[152:155], v49 offset:2048
  v_mfma_f32_16x16x32_bf16 v[192:195], v[96:99], v[144:147], v[192:195]
  ds_read_b128 v[156:159], v49 offset:4096
  v_mfma_f32_16x16x32_bf16 v[196:199], v[100:103], v[128:131], v[196:199]
  ds_read_b128 v[160:163], v49 offset:6144
  v_mfma_f32_16x16x32_bf16 v[200:203], v[100:103], v[132:135], v[200:203]
  ds_read_b128 v[164:167], v49 offset:8192
  v_mfma_f32_16x16x32_bf16 v[204:207], v[100:103], v[136:139], v[204:207]
  ds_read_b64_tr_b16 v[112:113], v44 offset:16384
  v_mfma_f32_16x16x32_bf16 v[208:211], v[100:103], v[140:143], v[208:211]
  ds_read_b64_tr_b16 v[114:115], v44 offset:18432
  v_mfma_f32_16x16x32_bf16 v[212:215], v[100:103], v[144:147], v[212:215]
  ds_read_b64_tr_b16 v[116:117], v45 offset:16384
  v_mfma_f32_16x16x32_bf16 v[216:219], v[104:107], v[128:131], v[216:219]
  ds_read_b64_tr_b16 v[118:119], v45 offset:18432
  v_mfma_f32_16x16x32_bf16 v[220:223], v[104:107], v[132:135], v[220:223]
  ds_read_b64_tr_b16 v[120:121], v46 offset:16384
  v_mfma_f32_16x16x32_bf16 v[224:227], v[104:107], v[136:139], v[224:227]
  ds_read_b64_tr_b16 v[122:123], v46 offset:18432
  v_mfma_f32_16x16x32_bf16 v[228:231], v[104:107], v[140:143], v[228:231]
  ds_read_b64_tr_b16 v[124:125], v47 offset:16384
  v_mfma_f32_16x16x32_bf16 v[232:235], v[104:107], v[144:147], v[232:235]
  ds_read_b64_tr_b16 v[126:127], v47 offset:18432
  v_mfma_f32_16x16x32_bf16 v[236:239], v[108:111], v[128:131], v[236:239]
  s_mov_b32 s33, 4294860800
  v_add_u32 v44, s33, v44
  v_mfma_f32_16x16x32_bf16 v[240:243], v[108:111], v[132:135], v[240:243]
  v_add_u32 v45, s33, v45
  v_mfma_f32_16x16x32_bf16 v[244:247], v[108:111], v[136:139], v[244:247]
  v_add_u32 v46, s33, v46
  v_mfma_f32_16x16x32_bf16 v[248:251], v[108:111], v[140:143], v[248:251]
  v_add_u32 v47, s33, v47
  v_mfma_f32_16x16x32_bf16 v[252:255], v[108:111], v[144:147], v[252:255]
  v_add_u32 v48, s33, v48
  v_add_u32 v49, s33, v49
  s_waitcnt lgkmcnt(0)
  s_waitcnt vmcnt(0)
  s_barrier
  v_mfma_f32_16x16x32_bf16 v[176:179], v[112:115], v[148:151], v[176:179]
  ds_read_b128 v[128:131], v48 offset:0
  v_mfma_f32_16x16x32_bf16 v[180:183], v[112:115], v[152:155], v[180:183]
  ds_read_b128 v[132:135], v48 offset:2048
  s_cmp_ge_u32 s24, 4
  s_cbranch_scc1 L_sk8
  s_add_u32 m0, s39, 0
  s_nop 0
  buffer_load_dwordx4 v16, s[60:63], s29 offen offset:0 nt lds
  s_add_u32 m0, s39, 1920
  s_nop 0
  buffer_load_dwordx4 v16, s[60:63], s29 offen offset:128 nt lds
L_sk8:
  v_mfma_f32_16x16x32_bf16 v[184:187], v[112:115], v[156:159], v[184:187]
  ds_read_b128 v[136:139], v48 offset:4096
  v_mfma_f32_16x16x32_bf16 v[188:191], v[112:115], v[160:163], v[188:191]
  ds_read_b128 v[140:143], v48 offset:6144
  s_cmp_ge_u32 s24, 4
  s_cbranch_scc1 L_sk9
  s_add_u32 m0, s39, 3840
  s_nop 0
  buffer_load_dwordx4 v16, s[60:63], s29 offen offset:256 nt lds
  s_add_u32 m0, s39, 5760
  s_nop 0
  buffer_load_dwordx4 v16, s[60:63], s29 offen offset:384 nt lds
  s_add_u32 s29, s29, 16384
L_sk9:
  v_mfma_f32_16x16x32_bf16 v[192:195], v[112:115], v[164:167], v[192:195]
  ds_read_b128 v[144:147], v48 offset:8192
  v_mfma_f32_16x16x32_bf16 v[196:199], v[116:119], v[148:151], v[196:199]
  ds_read_b64_tr_b16 v[96:97], v44 offset:0
  s_cmp_ge_u32 s24, 4
  s_cbranch_scc1 L_sk10
  s_add_u32 m0, s39, 16384
  s_nop 0
  buffer_load_dwordx4 v16, s[60:63], s29 offen offset:0 nt lds
  s_add_u32 m0, s39, 18304
  s_nop 0
  buffer_load_dwordx4 v16, s[60:63], s29 offen offset:128 nt lds
L_sk10:
  v_mfma_f32_16x16x32_bf16 v[200:203], v[116:119], v[152:155], v[200:203]
  ds_read_b64_tr_b16 v[98:99], v44 offset:2048
  v_mfma_f32_16x16x32_bf16 v[204:207], v[116:119], v[156:159], v[204:207]
  ds_read_b64_tr_b16 v[100:101], v45 offset:0
  s_cmp_ge_u32 s24, 4
  s_cbranch_scc1 L_sk11
  s_add_u32 m0, s39, 20224
  s_nop 0
  buffer_load_dwordx4 v16, s[60:63], s29 offen offset:256 nt lds
  s_add_u32 m0, s39, 22144
  s_nop 0
  buffer_load_dwordx4 v16, s[60:63], s29 offen offset:384 nt lds
  s_add_u32 s29, s29, 16384
L_sk11:
  v_mfma_f32_16x16x32_bf16 v[208:211], v[116:119], v[160:163], v[208:211]
  ds_read_b64_tr_b16 v[102:103], v45 offset:2048
  v_mfma_f32_16x16x32_bf16 v[212:215], v[116:119], v[164:167], v[212:215]
  ds_read_b64_tr_b16 v[104:105], v46 offset:0
  s_cmp_ge_u32 s24, 4
  s_cbranch_scc1 L_sk12
  s_add_u32 m0, s3, 49152
  s_nop 0
  buffer_load_dwordx4 v12, s[12:15], s49 offen nt lds
  s_add_u32 m0, s3, 50176
  s_nop 0
  buffer_load_dwordx4 v13, s[12:15], s49 offen nt lds
L_sk12:
  v_mfma_f32_16x16x32_bf16 v[216:219], v[120:123], v[148:151], v[216:219]
  ds_read_b64_tr_b16 v[106:107], v46 offset:2048
  v_mfma_f32_16x16x32_bf16 v[220:223], v[120:123], v[152:155], v[220:223]
  ds_read_b64_tr_b16 v[108:109], v47 offset:0
  s_cmp_ge_u32 s24, 4
  s_cbranch_scc1 L_sk13
  s_add_u32 m0, s3, 51200
  s_nop 0
  buffer_load_dwordx4 v14, s[12:15], s49 offen nt lds
  s_add_u32 m0, s3, 52224
  s_nop 0
  buffer_load_dwordx4 v15, s[12:15], s49 offen nt lds
  s_add_u32 s49, s49, 16384
L_sk13:
  v_mfma_f32_16x16x32_bf16 v[224:227], v[120:123], v[156:159], v[224:227]
  ds_read_b64_tr_b16 v[110:111], v47 offset:2048
  v_mfma_f32_16x16x32_bf16 v[228:231], v[120:123], v[160:163], v[228:231]
  s_cmp_ge_u32 s24, 4
  s_cbranch_scc1 L_sk14
  s_add_u32 m0, s39, 32768
  s_nop 0
  buffer_load_dwordx4 v16, s[60:63], s29 offen offset:0 nt lds
  s_add_u32 m0, s39, 34688
  s_nop 0
  buffer_load_dwordx4 v16, s[60:63], s29 offen offset:128 nt lds
L_sk14:
  v_mfma_f32_16x16x32_bf16 v[232:235], v[120:123], v[164:167], v[232:235]
  v_mfma_f32_16x16x32_bf16 v[236:239], v[124:127], v[148:151], v[236:239]
  s_cmp_ge_u32 s24, 4
  s_cbranch_scc1 L_sk15
  s_add_u32 m0, s39, 36608
  s_nop 0
  buffer_load_dwordx4 v16, s[60:63], s29 offen offset:256 nt lds
  s_add_u32 m0, s39, 38528
  s_nop 0
  buffer_load_dwordx4 v16, s[60:63], s29 offen offset:384 nt lds
  s_add_u32 s29, s29, 16384
L_sk15:
  v_mfma_f32_16x16x32_bf16 v[240:243], v[124:127], v[152:155], v[240:243]
  v_mfma_f32_16x16x32_bf16 v[244:247], v[124:127], v[156:159], v[244:247]
  v_mfma_f32_16x16x32_bf16 v[248:251], v[124:127], v[160:163], v[248:251]
  v_mfma_f32_16x16x32_bf16 v[252:255], v[124:127], v[164:167], v[252:255]
  s_waitcnt lgkmcnt(0)
  v_mfma_f32_16x16x32_bf16 v[176:179], v[96:99], v[128:131], v[176:179]
  v_mfma_f32_16x16x32_bf16 v[180:183], v[96:99], v[132:135], v[180:183]
  v_mfma_f32_16x16x32_bf16 v[184:187], v[96:99], v[136:139], v[184:187]
  ds_read_b128 v[148:151], v49 offset:0
  v_mfma_f32_16x16x32_bf16 v[188:191], v[96:99], v[140:143], v[188:191]
  ds_read_b128 v[152:155], v49 offset:2048
  v_mfma_f32_16x16x32_bf16 v[192:195], v[96:99], v[144:147], v[192:195]
  ds_read_b128 v[156:159], v49 offset:4096
  v_mfma_f32_16x16x32_bf16 v[196:199], v[100:103], v[128:131], v[196:199]
  ds_read_b128 v[160:163], v49 offset:6144
  v_mfma_f32_16x16x32_bf16 v[200:203], v[100:103], v[132:135], v[200:203]
  ds_read_b128 v[164:167], v49 offset:8192
  v_mfma_f32_16x16x32_bf16 v[204:207], v[100:103], v[136:139], v[204:207]
  ds_read_b64_tr_b16 v[112:113], v44 offset:16384
  v_mfma_f32_16x16x32_bf16 v[208:211], v[100:103], v[140:143], v[208:211]
  ds_read_b64_tr_b16 v[114:115], v44 offset:18432
  v_mfma_f32_16x16x32_bf16 v[212:215], v[100:103], v[144:147], v[212:215]
  ds_read_b64_tr_b16 v[116:117], v45 offset:16384
  v_mfma_f32_16x16x32_bf16 v[216:219], v[104:107], v[128:131], v[216:219]
  ds_read_b64_tr_b16 v[118:119], v45 offset:18432
  v_mfma_f32_16x16x32_bf16 v[220:223], v[104:107], v[132:135], v[220:223]
  ds_read_b64_tr_b16 v[120:121], v46 offset:16384
  v_mfma_f32_16x16x32_bf16 v[224:227], v[104:107], v[136:139], v[224:227]
  ds_read_b64_tr_b16 v[122:123], v46 offset:18432
  v_mfma_f32_16x16x32_bf16 v[228:231], v[104:107], v[140:143], v[228:231]
  ds_read_b64_tr_b16 v[124:125], v47 offset:16384
  v_mfma_f32_16x16x32_bf16 v[232:235], v[104:107], v[144:147], v[232:235]
  ds_read_b64_tr_b16 v[126:127], v47 offset:18432
  v_mfma_f32_16x16x32_bf16 v[236:239], v[108:111], v[128:131], v[236:239]
  v_mfma_f32_16x16x32_bf16 v[240:243], v[108:111], v[132:135], v[240:243]
  v_mfma_f32_16x16x32_bf16 v[244:247], v[108:111], v[136:139], v[244:247]
  v_mfma_f32_16x16x32_bf16 v[248:251], v[108:111], v[140:143], v[248:251]
  v_mfma_f32_16x16x32_bf16 v[252:255], v[108:111], v[144:147], v[252:255]
  s_waitcnt lgkmcnt(0)
  s_barrier
  v_mov_b32 v34, s41
  v_mfma_f32_16x16x32_bf16 v[176:179], v[112:115], v[148:151], v[176:179]
  v_mfma_f32_16x16x32_bf16 v[180:183], v[112:115], v[152:155], v[180:183]
  v_mfma_f32_16x16x32_bf16 v[184:187], v[112:115], v[156:159], v[184:187]
  v_mfma_f32_16x16x32_bf16 v[188:191], v[112:115], v[160:163], v[188:191]
  v_mfma_f32_16x16x32_bf16 v[192:195], v[112:115], v[164:167], v[192:195]
  v_mfma_f32_16x16x32_bf16 v[196:199], v[116:119], v[148:151], v[196:199]
  v_mfma_f32_16x16x32_bf16 v[200:203], v[116:119], v[152:155], v[200:203]
  v_mfma_f32_16x16x32_bf16 v[204:207], v[116:119], v[156:159], v[204:207]
  s_nop 0
  v_pk_mul_f32 v[176:177], v[34:35], v[176:177] op_sel_hi:[0,1]
  v_pk_mul_f32 v[178:179], v[34:35], v[178:179] op_sel_hi:[0,1]
  v_pk_mul_f32 v[180:181], v[34:35], v[180:181] op_sel_hi:[0,1]
  v_pk_mul_f32 v[182:183], v[34:35], v[182:183] op_sel_hi:[0,1]
  v_pk_mul_f32 v[184:185], v[34:35], v[184:185] op_sel_hi:[0,1]
  v_pk_mul_f32 v[186:187], v[34:35], v[186:187] op_sel_hi:[0,1]
  v_pk_mul_f32 v[188:189], v[34:35], v[188:189] op_sel_hi:[0,1]
  v_pk_mul_f32 v[190:191], v[34:35], v[190:191] op_sel_hi:[0,1]
  v_cvt_pk_bf16_f32 v176, v176, v177
  v_cvt_pk_bf16_f32 v177, v178, v179
  v_cvt_pk_bf16_f32 v180, v180, v181
  v_cvt_pk_bf16_f32 v181, v182, v183
  v_cvt_pk_bf16_f32 v184, v184, v185
  v_cvt_pk_bf16_f32 v185, v186, v187
  v_cvt_pk_bf16_f32 v188, v188, v189
  v_cvt_pk_bf16_f32 v189, v190, v191
  ds_write_b64 v50, v[176:177] offset:0
  ds_write_b64 v50, v[180:181] offset:8192
  ds_write_b64 v50, v[184:185] offset:16384
  ds_write_b64 v50, v[188:189] offset:24576
  v_mfma_f32_16x16x32_bf16 v[208:211], v[116:119], v[160:163], v[208:211]
  v_mfma_f32_16x16x32_bf16 v[212:215], v[116:119], v[164:167], v[212:215]
  v_mfma_f32_16x16x32_bf16 v[216:219], v[120:123], v[148:151], v[216:219]
  v_mfma_f32_16x16x32_bf16 v[220:223], v[120:123], v[152:155], v[220:223]
  v_pk_mul_f32 v[192:193], v[34:35], v[192:193] op_sel_hi:[0,1]
  v_pk_mul_f32 v[194:195], v[34:35], v[194:195] op_sel_hi:[0,1]
  v_pk_mul_f32 v[196:197], v[34:35], v[196:197] op_sel_hi:[0,1]
  v_pk_mul_f32 v[198:199], v[34:35], v[198:199] op_sel_hi:[0,1]
  v_pk_mul_f32 v[200:201], v[34:35], v[200:201] op_sel_hi:[0,1]
  v_pk_mul_f32 v[202:203], v[34:35], v[202:203] op_sel_hi:[0,1]
  v_pk_mul_f32 v[204:205], v[34:35], v[204:205] op_sel_hi:[0,1]
  v_pk_mul_f32 v[206:207], v[34:35], v[206:207] op_sel_hi:[0,1]
  v_cvt_pk_bf16_f32 v192, v192, v193
  v_cvt_pk_bf16_f32 v193, v194, v195
  v_cvt_pk_bf16_f32 v196, v196, v197
  v_cvt_pk_bf16_f32 v197, v198, v199
  v_cvt_pk_bf16_f32 v200, v200, v201
  v_cvt_pk_bf16_f32 v201, v202, v203
  v_cvt_pk_bf16_f32 v204, v204, v205
  v_cvt_pk_bf16_f32 v205, v206, v207
  ds_write_b64 v50, v[192:193] offset:32768
  ds_write_b64 v51, v[196:197] offset:0
  ds_write_b64 v51, v[200:201] offset:8192
  ds_write_b64 v51, v[204:205] offset:16384
  v_mfma_f32_16x16x32_bf16 v[224:227], v[120:123], v[156:159], v[224:227]
  v_mfma_f32_16x16x32_bf16 v[228:231], v[120:123], v[160:163], v[228:231]
  v_mfma_f32_16x16x32_bf16 v[232:235], v[120:123], v[164:167], v[232:235]
  v_mfma_f32_16x16x32_bf16 v[236:239], v[124:127], v[148:151], v[236:239]
  v_pk_mul_f32 v[208:209], v[34:35], v[208:209] op_sel_hi:[0,1]
  v_pk_mul_f32 v[210:211], v[34:35], v[210:211] op_sel_hi:[0,1]
  v_pk_mul_f32 v[212:213], v[34:35], v[212:213] op_sel_hi:[0,1]
  v_pk_mul_f32 v[214:215], v[34:35], v[214:215] op_sel_hi:[0,1]
  v_pk_mul_f32 v[216:217], v[34:35], v[216:217] op_sel_hi:[0,1]
  v_pk_mul_f32 v[218:219], v[34:35], v[218:219] op_sel_hi:[0,1]
  v_pk_mul_f32 v[220:221], v[34:35], v[220:221] op_sel_hi:[0,1]
  v_pk_mul_f32 v[222:223], v[34:35], v[222:223] op_sel_hi:[0,1]
  v_cvt_pk_bf16_f32 v208, v208, v209
  v_cvt_pk_bf16_f32 v209, v210, v211
  v_cvt_pk_bf16_f32 v212, v212, v213
  v_cvt_pk_bf16_f32 v213, v214, v215
  v_cvt_pk_bf16_f32 v216, v216, v217
  v_cvt_pk_bf16_f32 v217, v218, v219
  v_cvt_pk_bf16_f32 v220, v220, v221
  v_cvt_pk_bf16_f32 v221, v222, v223
  ds_write_b64 v51, v[208:209] offset:24576
  ds_write_b64 v51, v[212:213] offset:32768
  ds_write_b64 v52, v[216:217] offset:0
  ds_write_b64 v52, v[220:221] offset:8192
  v_mfma_f32_16x16x32_bf16 v[240:243], v[124:127], v[152:155], v[240:243]
  v_mfma_f32_16x16x32_bf16 v[244:247], v[124:127], v[156:159], v[244:247]
  v_mfma_f32_16x16x32_bf16 v[248:251], v[124:127], v[160:163], v[248:251]
  v_mfma_f32_16x16x32_bf16 v[252:255], v[124:127], v[164:167], v[252:255]
  v_pk_mul_f32 v[224:225], v[34:35], v[224:225] op_sel_hi:[0,1]
  v_pk_mul_f32 v[226:227], v[34:35], v[226:227] op_sel_hi:[0,1]
  v_pk_mul_f32 v[228:229], v[34:35], v[228:229] op_sel_hi:[0,1]
  v_pk_mul_f32 v[230:231], v[34:35], v[230:231] op_sel_hi:[0,1]
  v_pk_mul_f32 v[232:233], v[34:35], v[232:233] op_sel_hi:[0,1]
  v_pk_mul_f32 v[234:235], v[34:35], v[234:235] op_sel_hi:[0,1]
  v_pk_mul_f32 v[236:237], v[34:35], v[236:237] op_sel_hi:[0,1]
  v_pk_mul_f32 v[238:239], v[34:35], v[238:239] op_sel_hi:[0,1]
  v_cvt_pk_bf16_f32 v224, v224, v225
  v_cvt_pk_bf16_f32 v225, v226, v227
  v_cvt_pk_bf16_f32 v228, v228, v229
  v_cvt_pk_bf16_f32 v229, v230, v231
  v_cvt_pk_bf16_f32 v232, v232, v233
  v_cvt_pk_bf16_f32 v233, v234, v235
  v_cvt_pk_bf16_f32 v236, v236, v237
  v_cvt_pk_bf16_f32 v237, v238, v239
  ds_write_b64 v52, v[224:225] offset:16384
  ds_write_b64 v52, v[228:229] offset:24576
  ds_write_b64 v52, v[232:233] offset:32768
  ds_write_b64 v53, v[236:237] offset:0
  v_pk_mul_f32 v[240:241], v[34:35], v[240:241] op_sel_hi:[0,1]
  v_pk_mul_f32 v[242:243], v[34:35], v[242:243] op_sel_hi:[0,1]
  v_pk_mul_f32 v[244:245], v[34:35], v[244:245] op_sel_hi:[0,1]
  v_pk_mul_f32 v[246:247], v[34:35], v[246:247] op_sel_hi:[0,1]
  v_pk_mul_f32 v[248:249], v[34:35], v[248:249] op_sel_hi:[0,1]
  v_pk_mul_f32 v[250:251], v[34:35], v[250:251] op_sel_hi:[0,1]
  v_pk_mul_f32 v[252:253], v[34:35], v[252:253] op_sel_hi:[0,1]
  v_pk_mul_f32 v[254:255], v[34:35], v[254:255] op_sel_hi:[0,1]
  v_cvt_pk_bf16_f32 v240, v240, v241
  v_cvt_pk_bf16_f32 v241, v242, v243
  v_cvt_pk_bf16_f32 v244, v244, v245
  v_cvt_pk_bf16_f32 v245, v246, v247
  v_cvt_pk_bf16_f32 v248, v248, v249
  v_cvt_pk_bf16_f32 v249, v250, v251
  v_cvt_pk_bf16_f32 v252, v252, v253
  v_cvt_pk_bf16_f32 v253, v254, v255
  ds_write_b64 v53, v[240:241] offset:8192
  ds_write_b64 v53, v[244:245] offset:16384
  ds_write_b64 v53, v[248:249] offset:24576
  ds_write_b64 v53, v[252:253] offset:32768
  s_cmp_ge_u32 s24, 4
  s_cbranch_scc1 L_PV
  s_setprio 1
  s_waitcnt vmcnt(12) lgkmcnt(0)
  s_barrier
  ds_read_b128 v[20:23], v1 offset:0
  ds_read_b128 v[96:99], v54 offset:0
  ds_read_b128 v[128:131], v54 offset:8192
  ds_read_b128 v[160:163], v54 offset:16384
  ds_read_b128 v[192:195], v54 offset:24576
  ds_read_b128 v[224:227], v54 offset:32768
  ds_read_b128 v[24:27], v2 offset:0
  ds_read_b128 v[100:103], v55 offset:0
  ds_read_b128 v[132:135], v55 offset:8192
  ds_read_b128 v[164:167], v55 offset:16384
  ds_read_b128 v[196:199], v55 offset:24576
  ds_read_b128 v[228:231], v55 offset:32768
  s_waitcnt lgkmcnt(6)
  v_mfma_f32_16x16x32_bf16 v[56:59], v[20:23], v[96:99], 0
  ds_read_b128 v[28:31], v1 offset:2048
  ds_read_b128 v[104:107], v54 offset:2048
  v_mfma_f32_16x16x32_bf16 v[60:63], v[20:23], v[128:131], 0
  ds_read_b128 v[136:139], v54 offset:10240
  ds_read_b128 v[168:171], v54 offset:18432
  v_mfma_f32_16x16x32_bf16 v[64:67], v[20:23], v[160:163], 0
  ds_read_b128 v[200:203], v54 offset:26624
  ds_read_b128 v[232:235], v54 offset:34816
  v_mfma_f32_16x16x32_bf16 v[68:71], v[20:23], v[192:195], 0
  v_mfma_f32_16x16x32_bf16 v[72:75], v[20:23], v[224:227], 0
  s_waitcnt lgkmcnt(6)
  v_mfma_f32_16x16x32_bf16 v[56:59], v[24:27], v[100:103], v[56:59]
  ds_read_b128 v[32:35], v2 offset:2048
  ds_read_b128 v[108:111], v55 offset:2048
  v_mfma_f32_16x16x32_bf16 v[60:63], v[24:27], v[132:135], v[60:63]
  ds_read_b128 v[140:143], v55 offset:10240
  ds_read_b128 v[172:175], v55 offset:18432
  v_mfma_f32_16x16x32_bf16 v[64:67], v[24:27], v[164:167], v[64:67]
  ds_read_b128 v[204:207], v55 offset:26624
  ds_read_b128 v[236:239], v55 offset:34816
  v_mfma_f32_16x16x32_bf16 v[68:71], v[24:27], v[196:199], v[68:71]
  v_mfma_f32_16x16x32_bf16 v[72:75], v[24:27], v[228:231], v[72:75]
  s_waitcnt lgkmcnt(6)
  v_mfma_f32_16x16x32_bf16 v[56:59], v[28:31], v[104:107], v[56:59]
  ds_read_b128 v[20:23], v1 offset:4096
  ds_read_b128 v[112:115], v54 offset:4096
  v_mfma_f32_16x16x32_bf16 v[60:63], v[28:31], v[136:139], v[60:63]
  ds_read_b128 v[144:147], v54 offset:12288
  ds_read_b128 v[176:179], v54 offset:20480
  v_mfma_f32_16x16x32_bf16 v[64:67], v[28:31], v[168:171], v[64:67]
  ds_read_b128 v[208:211], v54 offset:28672
  ds_read_b128 v[240:243], v54 offset:36864
  v_mfma_f32_16x16x32_bf16 v[68:71], v[28:31], v[200:203], v[68:71]
  v_mfma_f32_16x16x32_bf16 v[72:75], v[28:31], v[232:235], v[72:75]
  s_waitcnt lgkmcnt(6)
  v_mfma_f32_16x16x32_bf16 v[56:59], v[32:35], v[108:111], v[56:59]
  ds_read_b128 v[24:27], v2 offset:4096
  ds_read_b128 v[116:119], v55 offset:4096
  v_mfma_f32_16x16x32_bf16 v[60:63], v[32:35], v[140:143], v[60:63]
  ds_read_b128 v[148:151], v55 offset:12288
  ds_read_b128 v[180:183], v55 offset:20480
  v_mfma_f32_16x16x32_bf16 v[64:67], v[32:35], v[172:175], v[64:67]
  ds_read_b128 v[212:215], v55 offset:28672
  ds_read_b128 v[244:247], v55 offset:36864
  v_mfma_f32_16x16x32_bf16 v[68:71], v[32:35], v[204:207], v[68:71]
  v_mfma_f32_16x16x32_bf16 v[72:75], v[32:35], v[236:239], v[72:75]
  s_waitcnt lgkmcnt(6)
  v_mfma_f32_16x16x32_bf16 v[56:59], v[20:23], v[112:115], v[56:59]
  ds_read_b128 v[28:31], v1 offset:6144
  ds_read_b128 v[120:123], v54 offset:6144
  v_mfma_f32_16x16x32_bf16 v[60:63], v[20:23], v[144:147], v[60:63]
  ds_read_b128 v[152:155], v54 offset:14336
  ds_read_b128 v[184:187], v54 offset:22528
  v_mfma_f32_16x16x32_bf16 v[64:67], v[20:23], v[176:179], v[64:67]
  ds_read_b128 v[216:219], v54 offset:30720
  ds_read_b128 v[248:251], v54 offset:38912
  v_mfma_f32_16x16x32_bf16 v[68:71], v[20:23], v[208:211], v[68:71]
  v_mfma_f32_16x16x32_bf16 v[72:75], v[20:23], v[240:243], v[72:75]
  s_waitcnt lgkmcnt(6)
  v_mfma_f32_16x16x32_bf16 v[56:59], v[24:27], v[116:119], v[56:59]
  ds_read_b128 v[32:35], v2 offset:6144
  ds_read_b128 v[124:127], v55 offset:6144
  v_mfma_f32_16x16x32_bf16 v[60:63], v[24:27], v[148:151], v[60:63]
  ds_read_b128 v[156:159], v55 offset:14336
  ds_read_b128 v[188:191], v55 offset:22528
  v_mfma_f32_16x16x32_bf16 v[64:67], v[24:27], v[180:183], v[64:67]
  ds_read_b128 v[220:223], v55 offset:30720
  ds_read_b128 v[252:255], v55 offset:38912
  v_mfma_f32_16x16x32_bf16 v[68:71], v[24:27], v[212:215], v[68:71]
  v_mfma_f32_16x16x32_bf16 v[72:75], v[24:27], v[244:247], v[72:75]
  s_waitcnt lgkmcnt(6)
  v_mfma_f32_16x16x32_bf16 v[56:59], v[28:31], v[120:123], v[56:59]
  v_mfma_f32_16x16x32_bf16 v[60:63], v[28:31], v[152:155], v[60:63]
  v_mfma_f32_16x16x32_bf16 v[64:67], v[28:31], v[184:187], v[64:67]
  v_mfma_f32_16x16x32_bf16 v[68:71], v[28:31], v[216:219], v[68:71]
  v_mfma_f32_16x16x32_bf16 v[72:75], v[28:31], v[248:251], v[72:75]
  s_waitcnt lgkmcnt(0)
  v_mfma_f32_16x16x32_bf16 v[56:59], v[32:35], v[124:127], v[56:59]
  v_mfma_f32_16x16x32_bf16 v[60:63], v[32:35], v[156:159], v[60:63]
  v_mfma_f32_16x16x32_bf16 v[64:67], v[32:35], v[188:191], v[64:67]
  v_mfma_f32_16x16x32_bf16 v[68:71], v[32:35], v[220:223], v[68:71]
  v_mfma_f32_16x16x32_bf16 v[72:75], v[32:35], v[252:255], v[72:75]
L_S_join:
  s_nop 3
  v_max3_f32 v20, v56, v57, v7
  v_max3_f32 v20, v58, v59, v20
  v_mov_b32 v21, v20
  v_max3_f32 v22, v60, v61, v8
  v_max3_f32 v22, v62, v63, v22
  v_mov_b32 v23, v22
  v_max3_f32 v24, v64, v65, v9
  v_max3_f32 v24, v66, v67, v24
  v_mov_b32 v25, v24
  v_max3_f32 v26, v68, v69, v10
  v_max3_f32 v26, v70, v71, v26
  v_mov_b32 v27, v26
  v_max3_f32 v28, v72, v73, v11
  v_max3_f32 v28, v74, v75, v28
  v_mov_b32 v29, v28
  v_permlane32_swap_b32 v20, v21
  v_permlane32_swap_b32 v22, v23
  v_permlane32_swap_b32 v24, v25
  v_permlane32_swap_b32 v26, v27
  v_permlane32_swap_b32 v28, v29
  v_max_f32 v20, v20, v21
  v_mov_b32 v21, v20
  v_max_f32 v22, v22, v23
  v_mov_b32 v23, v22
  v_max_f32 v24, v24, v25
  v_mov_b32 v25, v24
  v_max_f32 v26, v26, v27
  v_mov_b32 v27, v26
  v_max_f32 v28, v28, v29
  v_mov_b32 v29, v28
  v_permlane16_swap_b32 v20, v21
  v_permlane16_swap_b32 v22, v23
  v_permlane16_swap_b32 v24, v25
  v_permlane16_swap_b32 v26, v27
  v_permlane16_swap_b32 v28, v29
  v_max_f32 v20, v20, v21
  ds_write_b32 v4, v20 offset:0
  v_max_f32 v22, v22, v23
  ds_write_b32 v4, v22 offset:128
  v_max_f32 v24, v24, v25
  ds_write_b32 v4, v24 offset:256
  v_max_f32 v26, v26, v27
  ds_write_b32 v4, v26 offset:384
  v_max_f32 v28, v28, v29
  ds_write_b32 v4, v28 offset:512
  s_waitcnt lgkmcnt(0)
  s_barrier
  v_and_b32 v5, 0xfffffffb, v4
  ds_read_b64 v[20:21], v5 offset:0
  ds_read_b64 v[22:23], v5 offset:128
  ds_read_b64 v[24:25], v5 offset:256
  ds_read_b64 v[26:27], v5 offset:384
  ds_read_b64 v[28:29], v5 offset:512
  s_add_u32 m0, s3, 0
  s_nop 0
  buffer_load_dwordx4 v12, s[12:15], s49 offen nt lds
  s_add_u32 m0, s3, 1024
  s_nop 0
  buffer_load_dwordx4 v13, s[12:15], s49 offen nt lds
  s_add_u32 m0, s3, 2048
  s_nop 0
  buffer_load_dwordx4 v14, s[12:15], s49 offen nt lds
  s_add_u32 m0, s3, 3072
  s_nop 0
  buffer_load_dwordx4 v15, s[12:15], s49 offen nt lds
  s_add_u32 s49, s49, 16384
  s_add_u32 m0, s3, 16384
  s_nop 0
  buffer_load_dwordx4 v12, s[12:15], s49 offen nt lds
  s_add_u32 m0, s3, 17408
  s_nop 0
  buffer_load_dwordx4 v13, s[12:15], s49 offen nt lds
  s_add_u32 m0, s3, 18432
  s_nop 0
  buffer_load_dwordx4 v14, s[12:15], s49 offen nt lds
  s_add_u32 m0, s3, 19456
  s_nop 0
  buffer_load_dwordx4 v15, s[12:15], s49 offen nt lds
  s_add_u32 s49, s49, 16384
  s_waitcnt lgkmcnt(4)
  v_max_f32 v20, v20, v21
  v_sub_f32 v36, 0, v20
  v_sub_f32 v37, 0, v20
  v_sub_f32 v38, 0, v20
  v_sub_f32 v39, 0, v20
  v_sub_f32 v56, v56, v20
  v_sub_f32 v57, v57, v20
  v_sub_f32 v58, v58, v20
  v_sub_f32 v59, v59, v20
  s_waitcnt lgkmcnt(3)
  v_max_f32 v22, v22, v23
  v_sub_f32 v40, 0, v22
  v_sub_f32 v41, 0, v22
  v_sub_f32 v42, 0, v22
  v_sub_f32 v43, 0, v22
  v_sub_f32 v60, v60, v22
  v_sub_f32 v61, v61, v22
  v_sub_f32 v62, v62, v22
  v_sub_f32 v63, v63, v22
  s_waitcnt lgkmcnt(2)
  v_max_f32 v24, v24, v25
  v_sub_f32 v44, 0, v24
  v_sub_f32 v45, 0, v24
  v_sub_f32 v46, 0, v24
  v_sub_f32 v47, 0, v24
  v_sub_f32 v64, v64, v24
  v_sub_f32 v65, v65, v24
  v_sub_f32 v66, v66, v24
  v_sub_f32 v67, v67, v24
  s_waitcnt lgkmcnt(1)
  v_max_f32 v26, v26, v27
  v_sub_f32 v48, 0, v26
  v_sub_f32 v49, 0, v26
  v_sub_f32 v50, 0, v26
  v_sub_f32 v51, 0, v26
  v_sub_f32 v68, v68, v26
  v_sub_f32 v69, v69, v26
  v_sub_f32 v70, v70, v26
  v_sub_f32 v71, v71, v26
  s_waitcnt lgkmcnt(0)
  v_max_f32 v28, v28, v29
  v_sub_f32 v52, 0, v28
  v_sub_f32 v53, 0, v28
  v_sub_f32 v54, 0, v28
  v_sub_f32 v55, 0, v28
  v_sub_f32 v72, v72, v28
  v_sub_f32 v73, v73, v28
  v_sub_f32 v74, v74, v28
  v_sub_f32 v75, v75, v28
  s_waitcnt vmcnt(12) lgkmcnt(0)
  s_barrier
  ds_read_b128 v[20:23], v1 offset:16384
  ds_read_b128 v[24:27], v2 offset:16384
  ds_read_b128 v[28:31], v1 offset:18432
  ds_read_b128 v[32:35], v2 offset:18432
  s_add_u32 m0, s39, 49152
  s_nop 0
  buffer_load_dwordx4 v16, s[60:63], s29 offen offset:0 nt lds
  v_exp_f32 v56, v56
  v_exp_f32 v57, v57
  s_add_u32 m0, s39, 51072
  s_nop 0
  buffer_load_dwordx4 v16, s[60:63], s29 offen offset:128 nt lds
  v_exp_f32 v58, v58
  v_exp_f32 v59, v59
  s_add_u32 m0, s39, 52992
  s_nop 0
  buffer_load_dwordx4 v16, s[60:63], s29 offen offset:256 nt lds
  v_exp_f32 v60, v60
  v_add_f32 v5, v56, v57
  v_add_f32 v6, v58, v59
  s_add_u32 m0, s39, 54912
  s_nop 0
  buffer_load_dwordx4 v16, s[60:63], s29 offen offset:384 nt lds
  s_add_u32 s29, s29, 16384
  v_exp_f32 v61, v61
  v_cvt_pk_bf16_f32 v56, v56, v57
  v_cvt_pk_bf16_f32 v57, v58, v59
  s_add_u32 m0, s39, 0
  s_nop 0
  buffer_load_dwordx4 v16, s[60:63], s29 offen offset:0 nt lds
  v_exp_f32 v62, v62
  v_add_f32 v5, v5, v6
  ds_write_b64 v3, v[56:57] offset:0
  s_add_u32 m0, s39, 1920
  s_nop 0
  buffer_load_dwordx4 v16, s[60:63], s29 offen offset:128 nt lds
  v_exp_f32 v63, v63
  v_mov_b32 v7, v5
  s_add_u32 m0, s39, 3840
  s_nop 0
  buffer_load_dwordx4 v16, s[60:63], s29 offen offset:256 nt lds
  v_exp_f32 v64, v64
  v_add_f32 v17, v60, v61
  v_add_f32 v18, v62, v63
  s_add_u32 m0, s39, 5760
  s_nop 0
  buffer_load_dwordx4 v16, s[60:63], s29 offen offset:384 nt lds
  s_add_u32 s29, s29, 16384
  v_exp_f32 v65, v65
  v_cvt_pk_bf16_f32 v60, v60, v61
  v_cvt_pk_bf16_f32 v61, v62, v63
  s_waitcnt lgkmcnt(4)
  v_mfma_f32_16x16x32_bf16 v[76:79], v[20:23], v[96:99], v[36:39]
  v_exp_f32 v66, v66
  v_mfma_f32_16x16x32_bf16 v[80:83], v[20:23], v[128:131], v[40:43]
  v_add_f32 v17, v17, v18
  ds_write_b64 v3, v[60:61] offset:256
  v_mfma_f32_16x16x32_bf16 v[84:87], v[20:23], v[160:163], v[44:47]
  v_exp_f32 v67, v67
  v_mfma_f32_16x16x32_bf16 v[88:91], v[20:23], v[192:195], v[48:51]
  v_mov_b32 v8, v17
  v_mfma_f32_16x16x32_bf16 v[92:95], v[20:23], v[224:227], v[52:55]
  s_waitcnt lgkmcnt(4)
  v_mfma_f32_16x16x32_bf16 v[76:79], v[24:27], v[100:103], v[76:79]
  v_exp_f32 v68, v68
  v_mfma_f32_16x16x32_bf16 v[80:83], v[24:27], v[132:135], v[80:83]
  ds_read_b128 v[20:23], v1 offset:20480
  v_add_f32 v5, v64, v65
  v_mfma_f32_16x16x32_bf16 v[84:87], v[24:27], v[164:167], v[84:87]
  v_add_f32 v6, v66, v67
  v_mfma_f32_16x16x32_bf16 v[88:91], v[24:27], v[196:199], v[88:91]
  v_exp_f32 v69, v69
  v_mfma_f32_16x16x32_bf16 v[92:95], v[24:27], v[228:231], v[92:95]
  v_cvt_pk_bf16_f32 v64, v64, v65
  s_waitcnt lgkmcnt(4)
  v_mfma_f32_16x16x32_bf16 v[76:79], v[28:31], v[104:107], v[76:79]
  v_cvt_pk_bf16_f32 v65, v66, v67
  v_mfma_f32_16x16x32_bf16 v[80:83], v[28:31], v[136:139], v[80:83]
  ds_read_b128 v[24:27], v2 offset:20480
  v_mfma_f32_16x16x32_bf16 v[84:87], v[28:31], v[168:171], v[84:87]
  v_exp_f32 v70, v70
  v_mfma_f32_16x16x32_bf16 v[88:91], v[28:31], v[200:203], v[88:91]
  v_add_f32 v5, v5, v6
  ds_write_b64 v3, v[64:65] offset:512
  v_mfma_f32_16x16x32_bf16 v[92:95], v[28:31], v[232:235], v[92:95]
  s_waitcnt lgkmcnt(5)
  v_mfma_f32_16x16x32_bf16 v[76:79], v[32:35], v[108:111], v[76:79]
  v_exp_f32 v71, v71
  v_mfma_f32_16x16x32_bf16 v[80:83], v[32:35], v[140:143], v[80:83]
  ds_read_b128 v[28:31], v1 offset:22528
  v_mov_b32 v9, v5
  v_mfma_f32_16x16x32_bf16 v[84:87], v[32:35], v[172:175], v[84:87]
  v_exp_f32 v72, v72
  v_mfma_f32_16x16x32_bf16 v[88:91], v[32:35], v[204:207], v[88:91]
  v_add_f32 v17, v68, v69
  v_add_f32 v18, v70, v71
  v_mfma_f32_16x16x32_bf16 v[92:95], v[32:35], v[236:239], v[92:95]
  s_waitcnt lgkmcnt(3)
  v_mfma_f32_16x16x32_bf16 v[76:79], v[20:23], v[112:115], v[76:79]
  v_exp_f32 v73, v73
  v_mfma_f32_16x16x32_bf16 v[80:83], v[20:23], v[144:147], v[80:83]
  ds_read_b128 v[32:35], v2 offset:22528
  v_cvt_pk_bf16_f32 v68, v68, v69
  v_mfma_f32_16x16x32_bf16 v[84:87], v[20:23], v[176:179], v[84:87]
  v_cvt_pk_bf16_f32 v69, v70, v71
  v_mfma_f32_16x16x32_bf16 v[88:91], v[20:23], v[208:211], v[88:91]
  v_exp_f32 v74, v74
  v_mfma_f32_16x16x32_bf16 v[92:95], v[20:23], v[240:243], v[92:95]
  v_add_f32 v17, v17, v18
  s_waitcnt lgkmcnt(3)
  v_mfma_f32_16x16x32_bf16 v[76:79], v[24:27], v[116:119], v[76:79]
  ds_write_b64 v3, v[68:69] offset:768
  v_mfma_f32_16x16x32_bf16 v[80:83], v[24:27], v[148:151], v[80:83]
  v_exp_f32 v75, v75
  v_mfma_f32_16x16x32_bf16 v[84:87], v[24:27], v[180:183], v[84:87]
  v_mov_b32 v10, v17
  v_add_f32 v5, v72, v73
  v_mfma_f32_16x16x32_bf16 v[88:91], v[24:27], v[212:215], v[88:91]
  v_add_f32 v6, v74, v75
  v_cvt_pk_bf16_f32 v72, v72, v73
  v_mfma_f32_16x16x32_bf16 v[92:95], v[24:27], v[244:247], v[92:95]
  v_cvt_pk_bf16_f32 v73, v74, v75
  s_waitcnt lgkmcnt(2)
  v_mfma_f32_16x16x32_bf16 v[76:79], v[28:31], v[120:123], v[76:79]
  v_add_f32 v5, v5, v6
  ds_write_b64 v3, v[72:73] offset:1024
  v_mfma_f32_16x16x32_bf16 v[80:83], v[28:31], v[152:155], v[80:83]
  v_mov_b32 v11, v5
  v_mfma_f32_16x16x32_bf16 v[84:87], v[28:31], v[184:187], v[84:87]
  v_mfma_f32_16x16x32_bf16 v[88:91], v[28:31], v[216:219], v[88:91]
  v_mfma_f32_16x16x32_bf16 v[92:95], v[28:31], v[248:251], v[92:95]
  s_waitcnt lgkmcnt(2)
  v_mfma_f32_16x16x32_bf16 v[76:79], v[32:35], v[124:127], v[76:79]
  v_mfma_f32_16x16x32_bf16 v[80:83], v[32:35], v[156:159], v[80:83]
  v_mfma_f32_16x16x32_bf16 v[84:87], v[32:35], v[188:191], v[84:87]
  v_mfma_f32_16x16x32_bf16 v[88:91], v[32:35], v[220:223], v[88:91]
  v_mfma_f32_16x16x32_bf16 v[92:95], v[32:35], v[252:255], v[92:95]
  s_waitcnt vmcnt(16) lgkmcnt(0)
  s_barrier
  ds_read_b128 v[20:23], v1 offset:32768
  ds_read_b128 v[24:27], v2 offset:32768
  ds_read_b128 v[28:31], v1 offset:34816
  ds_read_b128 v[32:35], v2 offset:34816
  s_add_u32 m0, s39, 16384
  s_nop 0
  buffer_load_dwordx4 v16, s[60:63], s29 offen offset:0 nt lds
  v_exp_f32 v76, v76
  v_exp_f32 v77, v77
  s_add_u32 m0, s39, 18304
  s_nop 0
  buffer_load_dwordx4 v16, s[60:63], s29 offen offset:128 nt lds
  v_exp_f32 v78, v78
  v_exp_f32 v79, v79
  s_add_u32 m0, s39, 20224
  s_nop 0
  buffer_load_dwordx4 v16, s[60:63], s29 offen offset:256 nt lds
  v_exp_f32 v80, v80
  v_add_f32 v5, v76, v77
  v_add_f32 v6, v78, v79
  s_add_u32 m0, s39, 22144
  s_nop 0
  buffer_load_dwordx4 v16, s[60:63], s29 offen offset:384 nt lds
  s_add_u32 s29, s29, 16384
  v_exp_f32 v81, v81
  v_cvt_pk_bf16_f32 v76, v76, v77
  v_cvt_pk_bf16_f32 v77, v78, v79
  s_waitcnt lgkmcnt(3)
  v_mfma_f32_16x16x32_bf16 v[56:59], v[20:23], v[96:99], v[36:39]
  v_exp_f32 v82, v82
  v_mfma_f32_16x16x32_bf16 v[60:63], v[20:23], v[128:131], v[40:43]
  v_add_f32 v5, v5, v6
  ds_write_b64 v3, v[76:77] offset:10240
  v_mfma_f32_16x16x32_bf16 v[64:67], v[20:23], v[160:163], v[44:47]
  v_exp_f32 v83, v83
  v_mfma_f32_16x16x32_bf16 v[68:71], v[20:23], v[192:195], v[48:51]
  v_add_f32 v7, v7, v5
  v_mfma_f32_16x16x32_bf16 v[72:75], v[20:23], v[224:227], v[52:55]
  s_waitcnt lgkmcnt(3)
  v_mfma_f32_16x16x32_bf16 v[56:59], v[24:27], v[100:103], v[56:59]
  v_exp_f32 v84, v84
  v_mfma_f32_16x16x32_bf16 v[60:63], v[24:27], v[132:135], v[60:63]
  ds_read_b128 v[20:23], v1 offset:36864
  v_add_f32 v17, v80, v81
  v_mfma_f32_16x16x32_bf16 v[64:67], v[24:27], v[164:167], v[64:67]
  v_add_f32 v18, v82, v83
  v_mfma_f32_16x16x32_bf16 v[68:71], v[24:27], v[196:199], v[68:71]
  v_exp_f32 v85, v85
  v_mfma_f32_16x16x32_bf16 v[72:75], v[24:27], v[228:231], v[72:75]
  v_cvt_pk_bf16_f32 v80, v80, v81
  s_waitcnt lgkmcnt(3)
  v_mfma_f32_16x16x32_bf16 v[56:59], v[28:31], v[104:107], v[56:59]
  v_cvt_pk_bf16_f32 v81, v82, v83
  v_mfma_f32_16x16x32_bf16 v[60:63], v[28:31], v[136:139], v[60:63]
  ds_read_b128 v[24:27], v2 offset:36864
  v_mfma_f32_16x16x32_bf16 v[64:67], v[28:31], v[168:171], v[64:67]
  v_exp_f32 v86, v86
  v_mfma_f32_16x16x32_bf16 v[68:71], v[28:31], v[200:203], v[68:71]
  v_add_f32 v17, v17, v18
  ds_write_b64 v3, v[80:81] offset:10496
  v_mfma_f32_16x16x32_bf16 v[72:75], v[28:31], v[232:235], v[72:75]
  s_waitcnt lgkmcnt(4)
  v_mfma_f32_16x16x32_bf16 v[56:59], v[32:35], v[108:111], v[56:59]
  v_exp_f32 v87, v87
  v_mfma_f32_16x16x32_bf16 v[60:63], v[32:35], v[140:143], v[60:63]
  ds_read_b128 v[28:31], v1 offset:38912
  v_add_f32 v8, v8, v17
  v_mfma_f32_16x16x32_bf16 v[64:67], v[32:35], v[172:175], v[64:67]
  v_exp_f32 v88, v88
  v_mfma_f32_16x16x32_bf16 v[68:71], v[32:35], v[204:207], v[68:71]
  v_add_f32 v5, v84, v85
  v_add_f32 v6, v86, v87
  v_mfma_f32_16x16x32_bf16 v[72:75], v[32:35], v[236:239], v[72:75]
  s_waitcnt lgkmcnt(3)
  v_mfma_f32_16x16x32_bf16 v[56:59], v[20:23], v[112:115], v[56:59]
  v_exp_f32 v89, v89
  v_mfma_f32_16x16x32_bf16 v[60:63], v[20:23], v[144:147], v[60:63]
  ds_read_b128 v[32:35], v2 offset:38912
  v_cvt_pk_bf16_f32 v84, v84, v85
  v_mfma_f32_16x16x32_bf16 v[64:67], v[20:23], v[176:179], v[64:67]
  v_cvt_pk_bf16_f32 v85, v86, v87
  v_mfma_f32_16x16x32_bf16 v[68:71], v[20:23], v[208:211], v[68:71]
  v_exp_f32 v90, v90
  v_mfma_f32_16x16x32_bf16 v[72:75], v[20:23], v[240:243], v[72:75]
  v_add_f32 v5, v5, v6
  s_waitcnt lgkmcnt(3)
  v_mfma_f32_16x16x32_bf16 v[56:59], v[24:27], v[116:119], v[56:59]
  ds_write_b64 v3, v[84:85] offset:10752
  v_mfma_f32_16x16x32_bf16 v[60:63], v[24:27], v[148:151], v[60:63]
  v_exp_f32 v91, v91
  v_mfma_f32_16x16x32_bf16 v[64:67], v[24:27], v[180:183], v[64:67]
  v_add_f32 v9, v9, v5
  v_mfma_f32_16x16x32_bf16 v[68:71], v[24:27], v[212:215], v[68:71]
  v_exp_f32 v92, v92
  v_mfma_f32_16x16x32_bf16 v[72:75], v[24:27], v[244:247], v[72:75]
  v_add_f32 v17, v88, v89
  s_waitcnt lgkmcnt(2)
  v_mfma_f32_16x16x32_bf16 v[56:59], v[28:31], v[120:123], v[56:59]
  v_add_f32 v18, v90, v91
  v_mfma_f32_16x16x32_bf16 v[60:63], v[28:31], v[152:155], v[60:63]
  v_exp_f32 v93, v93
  v_mfma_f32_16x16x32_bf16 v[64:67], v[28:31], v[184:187], v[64:67]
  v_cvt_pk_bf16_f32 v88, v88, v89
  v_cvt_pk_bf16_f32 v89, v90, v91
  v_mfma_f32_16x16x32_bf16 v[68:71], v[28:31], v[216:219], v[68:71]
  v_exp_f32 v94, v94
  v_mfma_f32_16x16x32_bf16 v[72:75], v[28:31], v[248:251], v[72:75]
  v_add_f32 v17, v17, v18
  s_waitcnt lgkmcnt(1)
  v_mfma_f32_16x16x32_bf16 v[56:59], v[32:35], v[124:127], v[56:59]
  ds_write_b64 v3, v[88:89] offset:11008
  v_mfma_f32_16x16x32_bf16 v[60:63], v[32:35], v[156:159], v[60:63]
  v_exp_f32 v95, v95
  v_mfma_f32_16x16x32_bf16 v[64:67], v[32:35], v[188:191], v[64:67]
  v_add_f32 v10, v10, v17
  v_add_f32 v5, v92, v93
  v_mfma_f32_16x16x32_bf16 v[68:71], v[32:35], v[220:223], v[68:71]
  v_add_f32 v6, v94, v95
  v_cvt_pk_bf16_f32 v92, v92, v93
  v_mfma_f32_16x16x32_bf16 v[72:75], v[32:35], v[252:255], v[72:75]
  v_cvt_pk_bf16_f32 v93, v94, v95
  v_add_f32 v5, v5, v6
  ds_write_b64 v3, v[92:93] offset:11264
  v_add_f32 v11, v11, v5
  s_waitcnt vmcnt(8) lgkmcnt(0)
  s_barrier
  ds_read_b128 v[20:23], v1 offset:49152
  ds_read_b128 v[24:27], v2 offset:49152
  ds_read_b128 v[28:31], v1 offset:51200
  ds_read_b128 v[32:35], v2 offset:51200
  s_add_u32 m0, s39, 32768
  s_nop 0
  buffer_load_dwordx4 v16, s[60:63], s29 offen offset:0 nt lds
  v_exp_f32 v56, v56
  v_exp_f32 v57, v57
  s_add_u32 m0, s39, 34688
  s_nop 0
  buffer_load_dwordx4 v16, s[60:63], s29 offen offset:128 nt lds
  v_exp_f32 v58, v58
  v_exp_f32 v59, v59
  s_add_u32 m0, s39, 36608
  s_nop 0
  buffer_load_dwordx4 v16, s[60:63], s29 offen offset:256 nt lds
  v_exp_f32 v60, v60
  v_add_f32 v5, v56, v57
  v_add_f32 v6, v58, v59
  s_add_u32 m0, s39, 38528
  s_nop 0
  buffer_load_dwordx4 v16, s[60:63], s29 offen offset:384 nt lds
  s_add_u32 s29, s29, 16384
  v_exp_f32 v61, v61
  v_cvt_pk_bf16_f32 v56, v56, v57
  v_cvt_pk_bf16_f32 v57, v58, v59
  s_waitcnt lgkmcnt(3)
  v_mfma_f32_16x16x32_bf16 v[76:79], v[20:23], v[96:99], v[36:39]
  v_exp_f32 v62, v62
  v_mfma_f32_16x16x32_bf16 v[80:83], v[20:23], v[128:131], v[40:43]
  v_add_f32 v5, v5, v6
  ds_write_b64 v3, v[56:57] offset:0
  v_mfma_f32_16x16x32_bf16 v[84:87], v[20:23], v[160:163], v[44:47]
  v_exp_f32 v63, v63
  v_mfma_f32_16x16x32_bf16 v[88:91], v[20:23], v[192:195], v[48:51]
  v_add_f32 v7, v7, v5
  v_mfma_f32_16x16x32_bf16 v[92:95], v[20:23], v[224:227], v[52:55]
  s_waitcnt lgkmcnt(3)
  v_mfma_f32_16x16x32_bf16 v[76:79], v[24:27], v[100:103], v[76:79]
  v_exp_f32 v64, v64
  v_mfma_f32_16x16x32_bf16 v[80:83], v[24:27], v[132:135], v[80:83]
  ds_read_b128 v[20:23], v1 offset:53248
  v_add_f32 v17, v60, v61
  v_mfma_f32_16x16x32_bf16 v[84:87], v[24:27], v[164:167], v[84:87]
  v_add_f32 v18, v62, v63
  v_mfma_f32_16x16x32_bf16 v[88:91], v[24:27], v[196:199], v[88:91]
  v_exp_f32 v65, v65
  v_mfma_f32_16x16x32_bf16 v[92:95], v[24:27], v[228:231], v[92:95]
  v_cvt_pk_bf16_f32 v60, v60, v61
  s_waitcnt lgkmcnt(3)
  v_mfma_f32_16x16x32_bf16 v[76:79], v[28:31], v[104:107], v[76:79]
  v_cvt_pk_bf16_f32 v61, v62, v63
  v_mfma_f32_16x16x32_bf16 v[80:83], v[28:31], v[136:139], v[80:83]
  ds_read_b128 v[24:27], v2 offset:53248
  v_mfma_f32_16x16x32_bf16 v[84:87], v[28:31], v[168:171], v[84:87]
  v_exp_f32 v66, v66
  v_mfma_f32_16x16x32_bf16 v[88:91], v[28:31], v[200:203], v[88:91]
  v_add_f32 v17, v17, v18
  ds_write_b64 v3, v[60:61] offset:256
  v_mfma_f32_16x16x32_bf16 v[92:95], v[28:31], v[232:235], v[92:95]
  s_waitcnt lgkmcnt(4)
  v_mfma_f32_16x16x32_bf16 v[76:79], v[32:35], v[108:111], v[76:79]
  v_exp_f32 v67, v67
  v_mfma_f32_16x16x32_bf16 v[80:83], v[32:35], v[140:143], v[80:83]
  ds_read_b128 v[28:31], v1 offset:55296
  v_add_f32 v8, v8, v17
  v_mfma_f32_16x16x32_bf16 v[84:87], v[32:35], v[172:175], v[84:87]
  v_exp_f32 v68, v68
  v_mfma_f32_16x16x32_bf16 v[88:91], v[32:35], v[204:207], v[88:91]
  v_add_f32 v5, v64, v65
  v_add_f32 v6, v66, v67
  v_mfma_f32_16x16x32_bf16 v[92:95], v[32:35], v[236:239], v[92:95]
  s_waitcnt lgkmcnt(3)
  v_mfma_f32_16x16x32_bf16 v[76:79], v[20:23], v[112:115], v[76:79]
  v_exp_f32 v69, v69
  v_mfma_f32_16x16x32_bf16 v[80:83], v[20:23], v[144:147], v[80:83]
  ds_read_b128 v[32:35], v2 offset:55296
  v_cvt_pk_bf16_f32 v64, v64, v65
  v_mfma_f32_16x16x32_bf16 v[84:87], v[20:23], v[176:179], v[84:87]
  v_cvt_pk_bf16_f32 v65, v66, v67
  v_mfma_f32_16x16x32_bf16 v[88:91], v[20:23], v[208:211], v[88:91]
  v_exp_f32 v70, v70
  v_mfma_f32_16x16x32_bf16 v[92:95], v[20:23], v[240:243], v[92:95]
  v_add_f32 v5, v5, v6
  s_waitcnt lgkmcnt(3)
  v_mfma_f32_16x16x32_bf16 v[76:79], v[24:27], v[116:119], v[76:79]
  ds_write_b64 v3, v[64:65] offset:512
  v_mfma_f32_16x16x32_bf16 v[80:83], v[24:27], v[148:151], v[80:83]
  v_exp_f32 v71, v71
  v_mfma_f32_16x16x32_bf16 v[84:87], v[24:27], v[180:183], v[84:87]
  v_add_f32 v9, v9, v5
  v_mfma_f32_16x16x32_bf16 v[88:91], v[24:27], v[212:215], v[88:91]
  v_exp_f32 v72, v72
  v_mfma_f32_16x16x32_bf16 v[92:95], v[24:27], v[244:247], v[92:95]
  v_add_f32 v17, v68, v69
  s_waitcnt lgkmcnt(2)
  v_mfma_f32_16x16x32_bf16 v[76:79], v[28:31], v[120:123], v[76:79]
  v_add_f32 v18, v70, v71
  v_mfma_f32_16x16x32_bf16 v[80:83], v[28:31], v[152:155], v[80:83]
  v_exp_f32 v73, v73
  v_mfma_f32_16x16x32_bf16 v[84:87], v[28:31], v[184:187], v[84:87]
  v_cvt_pk_bf16_f32 v68, v68, v69
  v_cvt_pk_bf16_f32 v69, v70, v71
  v_mfma_f32_16x16x32_bf16 v[88:91], v[28:31], v[216:219], v[88:91]
  v_exp_f32 v74, v74
  v_mfma_f32_16x16x32_bf16 v[92:95], v[28:31], v[248:251], v[92:95]
  v_add_f32 v17, v17, v18
  s_waitcnt lgkmcnt(1)
  v_mfma_f32_16x16x32_bf16 v[76:79], v[32:35], v[124:127], v[76:79]
  ds_write_b64 v3, v[68:69] offset:768
  v_mfma_f32_16x16x32_bf16 v[80:83], v[32:35], v[156:159], v[80:83]
  v_exp_f32 v75, v75
  v_mfma_f32_16x16x32_bf16 v[84:87], v[32:35], v[188:191], v[84:87]
  v_add_f32 v10, v10, v17
  v_add_f32 v5, v72, v73
  v_mfma_f32_16x16x32_bf16 v[88:91], v[32:35], v[220:223], v[88:91]
  v_add_f32 v6, v74, v75
  v_cvt_pk_bf16_f32 v72, v72, v73
  v_mfma_f32_16x16x32_bf16 v[92:95], v[32:35], v[252:255], v[92:95]
  v_cvt_pk_bf16_f32 v73, v74, v75
  v_add_f32 v5, v5, v6
  ds_write_b64 v3, v[72:73] offset:1024
  v_add_f32 v11, v11, v5
  s_waitcnt vmcnt(8) lgkmcnt(0)
  s_barrier
  s_mov_b32 s30, 6
L_S_loop:
  ds_read_b128 v[20:23], v1 offset:0
  ds_read_b128 v[24:27], v2 offset:0
  ds_read_b128 v[28:31], v1 offset:2048
  ds_read_b128 v[32:35], v2 offset:2048
  s_add_u32 m0, s39, 49152
  s_nop 0
  buffer_load_dwordx4 v16, s[60:63], s29 offen offset:0 nt lds
  v_exp_f32 v76, v76
  v_exp_f32 v77, v77
  s_add_u32 m0, s39, 51072
  s_nop 0
  buffer_load_dwordx4 v16, s[60:63], s29 offen offset:128 nt lds
  v_exp_f32 v78, v78
  v_exp_f32 v79, v79
  s_add_u32 m0, s39, 52992
  s_nop 0
  buffer_load_dwordx4 v16, s[60:63], s29 offen offset:256 nt lds
  v_exp_f32 v80, v80
  v_add_f32 v5, v76, v77
  v_add_f32 v6, v78, v79
  s_add_u32 m0, s39, 54912
  s_nop 0
  buffer_load_dwordx4 v16, s[60:63], s29 offen offset:384 nt lds
  s_add_u32 s29, s29, 16384
  v_exp_f32 v81, v81
  v_cvt_pk_bf16_f32 v76, v76, v77
  v_cvt_pk_bf16_f32 v77, v78, v79
  s_waitcnt lgkmcnt(3)
  v_mfma_f32_16x16x32_bf16 v[56:59], v[20:23], v[96:99], v[36:39]
  v_exp_f32 v82, v82
  v_mfma_f32_16x16x32_bf16 v[60:63], v[20:23], v[128:131], v[40:43]
  v_add_f32 v5, v5, v6
  ds_write_b64 v3, v[76:77] offset:10240
  v_mfma_f32_16x16x32_bf16 v[64:67], v[20:23], v[160:163], v[44:47]
  v_exp_f32 v83, v83
  v_mfma_f32_16x16x32_bf16 v[68:71], v[20:23], v[192:195], v[48:51]
  v_add_f32 v7, v7, v5
  v_mfma_f32_16x16x32_bf16 v[72:75], v[20:23], v[224:227], v[52:55]
  s_waitcnt lgkmcnt(3)
  v_mfma_f32_16x16x32_bf16 v[56:59], v[24:27], v[100:103], v[56:59]
  v_exp_f32 v84, v84
  v_mfma_f32_16x16x32_bf16 v[60:63], v[24:27], v[132:135], v[60:63]
  ds_read_b128 v[20:23], v1 offset:4096
  v_add_f32 v17, v80, v81
  v_mfma_f32_16x16x32_bf16 v[64:67], v[24:27], v[164:167], v[64:67]
  v_add_f32 v18, v82, v83
  v_mfma_f32_16x16x32_bf16 v[68:71], v[24:27], v[196:199], v[68:71]
  v_exp_f32 v85, v85
  v_mfma_f32_16x16x32_bf16 v[72:75], v[24:27], v[228:231], v[72:75]
  v_cvt_pk_bf16_f32 v80, v80, v81
  s_waitcnt lgkmcnt(3)
  v_mfma_f32_16x16x32_bf16 v[56:59], v[28:31], v[104:107], v[56:59]
  v_cvt_pk_bf16_f32 v81, v82, v83
  v_mfma_f32_16x16x32_bf16 v[60:63], v[28:31], v[136:139], v[60:63]
  ds_read_b128 v[24:27], v2 offset:4096
  v_mfma_f32_16x16x32_bf16 v[64:67], v[28:31], v[168:171], v[64:67]
  v_exp_f32 v86, v86
  v_mfma_f32_16x16x32_bf16 v[68:71], v[28:31], v[200:203], v[68:71]
  v_add_f32 v17, v17, v18
  ds_write_b64 v3, v[80:81] offset:10496
  v_mfma_f32_16x16x32_bf16 v[72:75], v[28:31], v[232:235], v[72:75]
  s_waitcnt lgkmcnt(4)
  v_mfma_f32_16x16x32_bf16 v[56:59], v[32:35], v[108:111], v[56:59]
  v_exp_f32 v87, v87
  v_mfma_f32_16x16x32_bf16 v[60:63], v[32:35], v[140:143], v[60:63]
  ds_read_b128 v[28:31], v1 offset:6144
  v_add_f32 v8, v8, v17
  v_mfma_f32_16x16x32_bf16 v[64:67], v[32:35], v[172:175], v[64:67]
  v_exp_f32 v88, v88
  v_mfma_f32_16x16x32_bf16 v[68:71], v[32:35], v[204:207], v[68:71]
  v_add_f32 v5, v84, v85
  v_add_f32 v6, v86, v87
  v_mfma_f32_16x16x32_bf16 v[72:75], v[32:35], v[236:239], v[72:75]
  s_waitcnt lgkmcnt(3)
  v_mfma_f32_16x16x32_bf16 v[56:59], v[20:23], v[112:115], v[56:59]
  v_exp_f32 v89, v89
  v_mfma_f32_16x16x32_bf16 v[60:63], v[20:23], v[144:147], v[60:63]
  ds_read_b128 v[32:35], v2 offset:6144
  v_cvt_pk_bf16_f32 v84, v84, v85
  v_mfma_f32_16x16x32_bf16 v[64:67], v[20:23], v[176:179], v[64:67]
  v_cvt_pk_bf16_f32 v85, v86, v87
  v_mfma_f32_16x16x32_bf16 v[68:71], v[20:23], v[208:211], v[68:71]
  v_exp_f32 v90, v90
  v_mfma_f32_16x16x32_bf16 v[72:75], v[20:23], v[240:243], v[72:75]
  v_add_f32 v5, v5, v6
  s_waitcnt lgkmcnt(3)
  v_mfma_f32_16x16x32_bf16 v[56:59], v[24:27], v[116:119], v[56:59]
  ds_write_b64 v3, v[84:85] offset:10752
  v_mfma_f32_16x16x32_bf16 v[60:63], v[24:27], v[148:151], v[60:63]
  v_exp_f32 v91, v91
  v_mfma_f32_16x16x32_bf16 v[64:67], v[24:27], v[180:183], v[64:67]
  v_add_f32 v9, v9, v5
  v_mfma_f32_16x16x32_bf16 v[68:71], v[24:27], v[212:215], v[68:71]
  v_exp_f32 v92, v92
  v_mfma_f32_16x16x32_bf16 v[72:75], v[24:27], v[244:247], v[72:75]
  v_add_f32 v17, v88, v89
  s_waitcnt lgkmcnt(2)
  v_mfma_f32_16x16x32_bf16 v[56:59], v[28:31], v[120:123], v[56:59]
  v_add_f32 v18, v90, v91
  v_mfma_f32_16x16x32_bf16 v[60:63], v[28:31], v[152:155], v[60:63]
  v_exp_f32 v93, v93
  v_mfma_f32_16x16x32_bf16 v[64:67], v[28:31], v[184:187], v[64:67]
  v_cvt_pk_bf16_f32 v88, v88, v89
  v_cvt_pk_bf16_f32 v89, v90, v91
  v_mfma_f32_16x16x32_bf16 v[68:71], v[28:31], v[216:219], v[68:71]
  v_exp_f32 v94, v94
  v_mfma_f32_16x16x32_bf16 v[72:75], v[28:31], v[248:251], v[72:75]
  v_add_f32 v17, v17, v18
  s_waitcnt lgkmcnt(1)
  v_mfma_f32_16x16x32_bf16 v[56:59], v[32:35], v[124:127], v[56:59]
  ds_write_b64 v3, v[88:89] offset:11008
  v_mfma_f32_16x16x32_bf16 v[60:63], v[32:35], v[156:159], v[60:63]
  v_exp_f32 v95, v95
  v_mfma_f32_16x16x32_bf16 v[64:67], v[32:35], v[188:191], v[64:67]
  v_add_f32 v10, v10, v17
  v_add_f32 v5, v92, v93
  v_mfma_f32_16x16x32_bf16 v[68:71], v[32:35], v[220:223], v[68:71]
  v_add_f32 v6, v94, v95
  v_cvt_pk_bf16_f32 v92, v92, v93
  v_mfma_f32_16x16x32_bf16 v[72:75], v[32:35], v[252:255], v[72:75]
  v_cvt_pk_bf16_f32 v93, v94, v95
  v_add_f32 v5, v5, v6
  ds_write_b64 v3, v[92:93] offset:11264
  v_add_f32 v11, v11, v5
  s_waitcnt vmcnt(8) lgkmcnt(0)
  s_barrier
  ds_read_b128 v[20:23], v1 offset:16384
  ds_read_b128 v[24:27], v2 offset:16384
  ds_read_b128 v[28:31], v1 offset:18432
  ds_read_b128 v[32:35], v2 offset:18432
  s_add_u32 m0, s39, 0
  s_nop 0
  buffer_load_dwordx4 v16, s[60:63], s29 offen offset:0 nt lds
  v_exp_f32 v56, v56
  v_exp_f32 v57, v57
  s_add_u32 m0, s39, 1920
  s_nop 0
  buffer_load_dwordx4 v16, s[60:63], s29 offen offset:128 nt lds
  v_exp_f32 v58, v58
  v_exp_f32 v59, v59
  s_add_u32 m0, s39, 3840
  s_nop 0
  buffer_load_dwordx4 v16, s[60:63], s29 offen offset:256 nt lds
  v_exp_f32 v60, v60
  v_add_f32 v5, v56, v57
  v_add_f32 v6, v58, v59
  s_add_u32 m0, s39, 5760
  s_nop 0
  buffer_load_dwordx4 v16, s[60:63], s29 offen offset:384 nt lds
  s_add_u32 s29, s29, 16384
  v_exp_f32 v61, v61
  v_cvt_pk_bf16_f32 v56, v56, v57
  v_cvt_pk_bf16_f32 v57, v58, v59
  s_waitcnt lgkmcnt(3)
  v_mfma_f32_16x16x32_bf16 v[76:79], v[20:23], v[96:99], v[36:39]
  v_exp_f32 v62, v62
  v_mfma_f32_16x16x32_bf16 v[80:83], v[20:23], v[128:131], v[40:43]
  v_add_f32 v5, v5, v6
  ds_write_b64 v3, v[56:57] offset:0
  v_mfma_f32_16x16x32_bf16 v[84:87], v[20:23], v[160:163], v[44:47]
  v_exp_f32 v63, v63
  v_mfma_f32_16x16x32_bf16 v[88:91], v[20:23], v[192:195], v[48:51]
  v_add_f32 v7, v7, v5
  v_mfma_f32_16x16x32_bf16 v[92:95], v[20:23], v[224:227], v[52:55]
  s_waitcnt lgkmcnt(3)
  v_mfma_f32_16x16x32_bf16 v[76:79], v[24:27], v[100:103], v[76:79]
  v_exp_f32 v64, v64
  v_mfma_f32_16x16x32_bf16 v[80:83], v[24:27], v[132:135], v[80:83]
  ds_read_b128 v[20:23], v1 offset:20480
  v_add_f32 v17, v60, v61
  v_mfma_f32_16x16x32_bf16 v[84:87], v[24:27], v[164:167], v[84:87]
  v_add_f32 v18, v62, v63
  v_mfma_f32_16x16x32_bf16 v[88:91], v[24:27], v[196:199], v[88:91]
  v_exp_f32 v65, v65
  v_mfma_f32_16x16x32_bf16 v[92:95], v[24:27], v[228:231], v[92:95]
  v_cvt_pk_bf16_f32 v60, v60, v61
  s_waitcnt lgkmcnt(3)
  v_mfma_f32_16x16x32_bf16 v[76:79], v[28:31], v[104:107], v[76:79]
  v_cvt_pk_bf16_f32 v61, v62, v63
  v_mfma_f32_16x16x32_bf16 v[80:83], v[28:31], v[136:139], v[80:83]
  ds_read_b128 v[24:27], v2 offset:20480
  v_mfma_f32_16x16x32_bf16 v[84:87], v[28:31], v[168:171], v[84:87]
  v_exp_f32 v66, v66
  v_mfma_f32_16x16x32_bf16 v[88:91], v[28:31], v[200:203], v[88:91]
  v_add_f32 v17, v17, v18
  ds_write_b64 v3, v[60:61] offset:256
  v_mfma_f32_16x16x32_bf16 v[92:95], v[28:31], v[232:235], v[92:95]
  s_waitcnt lgkmcnt(4)
  v_mfma_f32_16x16x32_bf16 v[76:79], v[32:35], v[108:111], v[76:79]
  v_exp_f32 v67, v67
  v_mfma_f32_16x16x32_bf16 v[80:83], v[32:35], v[140:143], v[80:83]
  ds_read_b128 v[28:31], v1 offset:22528
  v_add_f32 v8, v8, v17
  v_mfma_f32_16x16x32_bf16 v[84:87], v[32:35], v[172:175], v[84:87]
  v_exp_f32 v68, v68
  v_mfma_f32_16x16x32_bf16 v[88:91], v[32:35], v[204:207], v[88:91]
  v_add_f32 v5, v64, v65
  v_add_f32 v6, v66, v67
  v_mfma_f32_16x16x32_bf16 v[92:95], v[32:35], v[236:239], v[92:95]
  s_waitcnt lgkmcnt(3)
  v_mfma_f32_16x16x32_bf16 v[76:79], v[20:23], v[112:115], v[76:79]
  v_exp_f32 v69, v69
  v_mfma_f32_16x16x32_bf16 v[80:83], v[20:23], v[144:147], v[80:83]
  ds_read_b128 v[32:35], v2 offset:22528
  v_cvt_pk_bf16_f32 v64, v64, v65
  v_mfma_f32_16x16x32_bf16 v[84:87], v[20:23], v[176:179], v[84:87]
  v_cvt_pk_bf16_f32 v65, v66, v67
  v_mfma_f32_16x16x32_bf16 v[88:91], v[20:23], v[208:211], v[88:91]
  v_exp_f32 v70, v70
  v_mfma_f32_16x16x32_bf16 v[92:95], v[20:23], v[240:243], v[92:95]
  v_add_f32 v5, v5, v6
  s_waitcnt lgkmcnt(3)
  v_mfma_f32_16x16x32_bf16 v[76:79], v[24:27], v[116:119], v[76:79]
  ds_write_b64 v3, v[64:65] offset:512
  v_mfma_f32_16x16x32_bf16 v[80:83], v[24:27], v[148:151], v[80:83]
  v_exp_f32 v71, v71
  v_mfma_f32_16x16x32_bf16 v[84:87], v[24:27], v[180:183], v[84:87]
  v_add_f32 v9, v9, v5
  v_mfma_f32_16x16x32_bf16 v[88:91], v[24:27], v[212:215], v[88:91]
  v_exp_f32 v72, v72
  v_mfma_f32_16x16x32_bf16 v[92:95], v[24:27], v[244:247], v[92:95]
  v_add_f32 v17, v68, v69
  s_waitcnt lgkmcnt(2)
  v_mfma_f32_16x16x32_bf16 v[76:79], v[28:31], v[120:123], v[76:79]
  v_add_f32 v18, v70, v71
  v_mfma_f32_16x16x32_bf16 v[80:83], v[28:31], v[152:155], v[80:83]
  v_exp_f32 v73, v73
  v_mfma_f32_16x16x32_bf16 v[84:87], v[28:31], v[184:187], v[84:87]
  v_cvt_pk_bf16_f32 v68, v68, v69
  v_cvt_pk_bf16_f32 v69, v70, v71
  v_mfma_f32_16x16x32_bf16 v[88:91], v[28:31], v[216:219], v[88:91]
  v_exp_f32 v74, v74
  v_mfma_f32_16x16x32_bf16 v[92:95], v[28:31], v[248:251], v[92:95]
  v_add_f32 v17, v17, v18
  s_waitcnt lgkmcnt(1)
  v_mfma_f32_16x16x32_bf16 v[76:79], v[32:35], v[124:127], v[76:79]
  ds_write_b64 v3, v[68:69] offset:768
  v_mfma_f32_16x16x32_bf16 v[80:83], v[32:35], v[156:159], v[80:83]
  v_exp_f32 v75, v75
  v_mfma_f32_16x16x32_bf16 v[84:87], v[32:35], v[188:191], v[84:87]
  v_add_f32 v10, v10, v17
  v_add_f32 v5, v72, v73
  v_mfma_f32_16x16x32_bf16 v[88:91], v[32:35], v[220:223], v[88:91]
  v_add_f32 v6, v74, v75
  v_cvt_pk_bf16_f32 v72, v72, v73
  v_mfma_f32_16x16x32_bf16 v[92:95], v[32:35], v[252:255], v[92:95]
  v_cvt_pk_bf16_f32 v73, v74, v75
  v_add_f32 v5, v5, v6
  ds_write_b64 v3, v[72:73] offset:1024
  v_add_f32 v11, v11, v5
  s_waitcnt vmcnt(8) lgkmcnt(0)
  s_barrier
  ds_read_b128 v[20:23], v1 offset:32768
  ds_read_b128 v[24:27], v2 offset:32768
  ds_read_b128 v[28:31], v1 offset:34816
  ds_read_b128 v[32:35], v2 offset:34816
  s_add_u32 m0, s39, 16384
  s_nop 0
  buffer_load_dwordx4 v16, s[60:63], s29 offen offset:0 nt lds
  v_exp_f32 v76, v76
  v_exp_f32 v77, v77
  s_add_u32 m0, s39, 18304
  s_nop 0
  buffer_load_dwordx4 v16, s[60:63], s29 offen offset:128 nt lds
  v_exp_f32 v78, v78
  v_exp_f32 v79, v79
  s_add_u32 m0, s39, 20224
  s_nop 0
  buffer_load_dwordx4 v16, s[60:63], s29 offen offset:256 nt lds
  v_exp_f32 v80, v80
  v_add_f32 v5, v76, v77
  v_add_f32 v6, v78, v79
  s_add_u32 m0, s39, 22144
  s_nop 0
  buffer_load_dwordx4 v16, s[60:63], s29 offen offset:384 nt lds
  s_add_u32 s29, s29, 16384
  v_exp_f32 v81, v81
  v_cvt_pk_bf16_f32 v76, v76, v77
  v_cvt_pk_bf16_f32 v77, v78, v79
  s_waitcnt lgkmcnt(3)
  v_mfma_f32_16x16x32_bf16 v[56:59], v[20:23], v[96:99], v[36:39]
  v_exp_f32 v82, v82
  v_mfma_f32_16x16x32_bf16 v[60:63], v[20:23], v[128:131], v[40:43]
  v_add_f32 v5, v5, v6
  ds_write_b64 v3, v[76:77] offset:10240
  v_mfma_f32_16x16x32_bf16 v[64:67], v[20:23], v[160:163], v[44:47]
  v_exp_f32 v83, v83
  v_mfma_f32_16x16x32_bf16 v[68:71], v[20:23], v[192:195], v[48:51]
  v_add_f32 v7, v7, v5
  v_mfma_f32_16x16x32_bf16 v[72:75], v[20:23], v[224:227], v[52:55]
  s_waitcnt lgkmcnt(3)
  v_mfma_f32_16x16x32_bf16 v[56:59], v[24:27], v[100:103], v[56:59]
  v_exp_f32 v84, v84
  v_mfma_f32_16x16x32_bf16 v[60:63], v[24:27], v[132:135], v[60:63]
  ds_read_b128 v[20:23], v1 offset:36864
  v_add_f32 v17, v80, v81
  v_mfma_f32_16x16x32_bf16 v[64:67], v[24:27], v[164:167], v[64:67]
  v_add_f32 v18, v82, v83
  v_mfma_f32_16x16x32_bf16 v[68:71], v[24:27], v[196:199], v[68:71]
  v_exp_f32 v85, v85
  v_mfma_f32_16x16x32_bf16 v[72:75], v[24:27], v[228:231], v[72:75]
  v_cvt_pk_bf16_f32 v80, v80, v81
  s_waitcnt lgkmcnt(3)
  v_mfma_f32_16x16x32_bf16 v[56:59], v[28:31], v[104:107], v[56:59]
  v_cvt_pk_bf16_f32 v81, v82, v83
  v_mfma_f32_16x16x32_bf16 v[60:63], v[28:31], v[136:139], v[60:63]
  ds_read_b128 v[24:27], v2 offset:36864
  v_mfma_f32_16x16x32_bf16 v[64:67], v[28:31], v[168:171], v[64:67]
  v_exp_f32 v86, v86
  v_mfma_f32_16x16x32_bf16 v[68:71], v[28:31], v[200:203], v[68:71]
  v_add_f32 v17, v17, v18
  ds_write_b64 v3, v[80:81] offset:10496
  v_mfma_f32_16x16x32_bf16 v[72:75], v[28:31], v[232:235], v[72:75]
  s_waitcnt lgkmcnt(4)
  v_mfma_f32_16x16x32_bf16 v[56:59], v[32:35], v[108:111], v[56:59]
  v_exp_f32 v87, v87
  v_mfma_f32_16x16x32_bf16 v[60:63], v[32:35], v[140:143], v[60:63]
  ds_read_b128 v[28:31], v1 offset:38912
  v_add_f32 v8, v8, v17
  v_mfma_f32_16x16x32_bf16 v[64:67], v[32:35], v[172:175], v[64:67]
  v_exp_f32 v88, v88
  v_mfma_f32_16x16x32_bf16 v[68:71], v[32:35], v[204:207], v[68:71]
  v_add_f32 v5, v84, v85
  v_add_f32 v6, v86, v87
  v_mfma_f32_16x16x32_bf16 v[72:75], v[32:35], v[236:239], v[72:75]
  s_waitcnt lgkmcnt(3)
  v_mfma_f32_16x16x32_bf16 v[56:59], v[20:23], v[112:115], v[56:59]
  v_exp_f32 v89, v89
  v_mfma_f32_16x16x32_bf16 v[60:63], v[20:23], v[144:147], v[60:63]
  ds_read_b128 v[32:35], v2 offset:38912
  v_cvt_pk_bf16_f32 v84, v84, v85
  v_mfma_f32_16x16x32_bf16 v[64:67], v[20:23], v[176:179], v[64:67]
  v_cvt_pk_bf16_f32 v85, v86, v87
  v_mfma_f32_16x16x32_bf16 v[68:71], v[20:23], v[208:211], v[68:71]
  v_exp_f32 v90, v90
  v_mfma_f32_16x16x32_bf16 v[72:75], v[20:23], v[240:243], v[72:75]
  v_add_f32 v5, v5, v6
  s_waitcnt lgkmcnt(3)
  v_mfma_f32_16x16x32_bf16 v[56:59], v[24:27], v[116:119], v[56:59]
  ds_write_b64 v3, v[84:85] offset:10752
  v_mfma_f32_16x16x32_bf16 v[60:63], v[24:27], v[148:151], v[60:63]
  v_exp_f32 v91, v91
  v_mfma_f32_16x16x32_bf16 v[64:67], v[24:27], v[180:183], v[64:67]
  v_add_f32 v9, v9, v5
  v_mfma_f32_16x16x32_bf16 v[68:71], v[24:27], v[212:215], v[68:71]
  v_exp_f32 v92, v92
  v_mfma_f32_16x16x32_bf16 v[72:75], v[24:27], v[244:247], v[72:75]
  v_add_f32 v17, v88, v89
  s_waitcnt lgkmcnt(2)
  v_mfma_f32_16x16x32_bf16 v[56:59], v[28:31], v[120:123], v[56:59]
  v_add_f32 v18, v90, v91
  v_mfma_f32_16x16x32_bf16 v[60:63], v[28:31], v[152:155], v[60:63]
  v_exp_f32 v93, v93
  v_mfma_f32_16x16x32_bf16 v[64:67], v[28:31], v[184:187], v[64:67]
  v_cvt_pk_bf16_f32 v88, v88, v89
  v_cvt_pk_bf16_f32 v89, v90, v91
  v_mfma_f32_16x16x32_bf16 v[68:71], v[28:31], v[216:219], v[68:71]
  v_exp_f32 v94, v94
  v_mfma_f32_16x16x32_bf16 v[72:75], v[28:31], v[248:251], v[72:75]
  v_add_f32 v17, v17, v18
  s_waitcnt lgkmcnt(1)
  v_mfma_f32_16x16x32_bf16 v[56:59], v[32:35], v[124:127], v[56:59]
  ds_write_b64 v3, v[88:89] offset:11008
  v_mfma_f32_16x16x32_bf16 v[60:63], v[32:35], v[156:159], v[60:63]
  v_exp_f32 v95, v95
  v_mfma_f32_16x16x32_bf16 v[64:67], v[32:35], v[188:191], v[64:67]
  v_add_f32 v10, v10, v17
  v_add_f32 v5, v92, v93
  v_mfma_f32_16x16x32_bf16 v[68:71], v[32:35], v[220:223], v[68:71]
  v_add_f32 v6, v94, v95
  v_cvt_pk_bf16_f32 v92, v92, v93
  v_mfma_f32_16x16x32_bf16 v[72:75], v[32:35], v[252:255], v[72:75]
  v_cvt_pk_bf16_f32 v93, v94, v95
  v_add_f32 v5, v5, v6
  ds_write_b64 v3, v[92:93] offset:11264
  v_add_f32 v11, v11, v5
  s_waitcnt vmcnt(8) lgkmcnt(0)
  s_barrier
  ds_read_b128 v[20:23], v1 offset:49152
  ds_read_b128 v[24:27], v2 offset:49152
  ds_read_b128 v[28:31], v1 offset:51200
  ds_read_b128 v[32:35], v2 offset:51200
  s_add_u32 m0, s39, 32768
  s_nop 0
  buffer_load_dwordx4 v16, s[60:63], s29 offen offset:0 nt lds
  v_exp_f32 v56, v56
  v_exp_f32 v57, v57
  s_add_u32 m0, s39, 34688
  s_nop 0
  buffer_load_dwordx4 v16, s[60:63], s29 offen offset:128 nt lds
  v_exp_f32 v58, v58
  v_exp_f32 v59, v59
  s_add_u32 m0, s39, 36608
  s_nop 0
  buffer_load_dwordx4 v16, s[60:63], s29 offen offset:256 nt lds
  v_exp_f32 v60, v60
  v_add_f32 v5, v56, v57
  v_add_f32 v6, v58, v59
  s_add_u32 m0, s39, 38528
  s_nop 0
  buffer_load_dwordx4 v16, s[60:63], s29 offen offset:384 nt lds
  s_add_u32 s29, s29, 16384
  v_exp_f32 v61, v61
  v_cvt_pk_bf16_f32 v56, v56, v57
  v_cvt_pk_bf16_f32 v57, v58, v59
  s_waitcnt lgkmcnt(3)
  v_mfma_f32_16x16x32_bf16 v[76:79], v[20:23], v[96:99], v[36:39]
  v_exp_f32 v62, v62
  v_mfma_f32_16x16x32_bf16 v[80:83], v[20:23], v[128:131], v[40:43]
  v_add_f32 v5, v5, v6
  ds_write_b64 v3, v[56:57] offset:0
  v_mfma_f32_16x16x32_bf16 v[84:87], v[20:23], v[160:163], v[44:47]
  v_exp_f32 v63, v63
  v_mfma_f32_16x16x32_bf16 v[88:91], v[20:23], v[192:195], v[48:51]
  v_add_f32 v7, v7, v5
  v_mfma_f32_16x16x32_bf16 v[92:95], v[20:23], v[224:227], v[52:55]
  s_waitcnt lgkmcnt(3)
  v_mfma_f32_16x16x32_bf16 v[76:79], v[24:27], v[100:103], v[76:79]
  v_exp_f32 v64, v64
  v_mfma_f32_16x16x32_bf16 v[80:83], v[24:27], v[132:135], v[80:83]
  ds_read_b128 v[20:23], v1 offset:53248
  v_add_f32 v17, v60, v61
  v_mfma_f32_16x16x32_bf16 v[84:87], v[24:27], v[164:167], v[84:87]
  v_add_f32 v18, v62, v63
  v_mfma_f32_16x16x32_bf16 v[88:91], v[24:27], v[196:199], v[88:91]
  v_exp_f32 v65, v65
  v_mfma_f32_16x16x32_bf16 v[92:95], v[24:27], v[228:231], v[92:95]
  v_cvt_pk_bf16_f32 v60, v60, v61
  s_waitcnt lgkmcnt(3)
  v_mfma_f32_16x16x32_bf16 v[76:79], v[28:31], v[104:107], v[76:79]
  v_cvt_pk_bf16_f32 v61, v62, v63
  v_mfma_f32_16x16x32_bf16 v[80:83], v[28:31], v[136:139], v[80:83]
  ds_read_b128 v[24:27], v2 offset:53248
  v_mfma_f32_16x16x32_bf16 v[84:87], v[28:31], v[168:171], v[84:87]
  v_exp_f32 v66, v66
  v_mfma_f32_16x16x32_bf16 v[88:91], v[28:31], v[200:203], v[88:91]
  v_add_f32 v17, v17, v18
  ds_write_b64 v3, v[60:61] offset:256
  v_mfma_f32_16x16x32_bf16 v[92:95], v[28:31], v[232:235], v[92:95]
  s_waitcnt lgkmcnt(4)
  v_mfma_f32_16x16x32_bf16 v[76:79], v[32:35], v[108:111], v[76:79]
  v_exp_f32 v67, v67
  v_mfma_f32_16x16x32_bf16 v[80:83], v[32:35], v[140:143], v[80:83]
  ds_read_b128 v[28:31], v1 offset:55296
  v_add_f32 v8, v8, v17
  v_mfma_f32_16x16x32_bf16 v[84:87], v[32:35], v[172:175], v[84:87]
  v_exp_f32 v68, v68
  v_mfma_f32_16x16x32_bf16 v[88:91], v[32:35], v[204:207], v[88:91]
  v_add_f32 v5, v64, v65
  v_add_f32 v6, v66, v67
  v_mfma_f32_16x16x32_bf16 v[92:95], v[32:35], v[236:239], v[92:95]
  s_waitcnt lgkmcnt(3)
  v_mfma_f32_16x16x32_bf16 v[76:79], v[20:23], v[112:115], v[76:79]
  v_exp_f32 v69, v69
  v_mfma_f32_16x16x32_bf16 v[80:83], v[20:23], v[144:147], v[80:83]
  ds_read_b128 v[32:35], v2 offset:55296
  v_cvt_pk_bf16_f32 v64, v64, v65
  v_mfma_f32_16x16x32_bf16 v[84:87], v[20:23], v[176:179], v[84:87]
  v_cvt_pk_bf16_f32 v65, v66, v67
  v_mfma_f32_16x16x32_bf16 v[88:91], v[20:23], v[208:211], v[88:91]
  v_exp_f32 v70, v70
  v_mfma_f32_16x16x32_bf16 v[92:95], v[20:23], v[240:243], v[92:95]
  v_add_f32 v5, v5, v6
  s_waitcnt lgkmcnt(3)
  v_mfma_f32_16x16x32_bf16 v[76:79], v[24:27], v[116:119], v[76:79]
  ds_write_b64 v3, v[64:65] offset:512
  v_mfma_f32_16x16x32_bf16 v[80:83], v[24:27], v[148:151], v[80:83]
  v_exp_f32 v71, v71
  v_mfma_f32_16x16x32_bf16 v[84:87], v[24:27], v[180:183], v[84:87]
  v_add_f32 v9, v9, v5
  v_mfma_f32_16x16x32_bf16 v[88:91], v[24:27], v[212:215], v[88:91]
  v_exp_f32 v72, v72
  v_mfma_f32_16x16x32_bf16 v[92:95], v[24:27], v[244:247], v[92:95]
  v_add_f32 v17, v68, v69
  s_waitcnt lgkmcnt(2)
  v_mfma_f32_16x16x32_bf16 v[76:79], v[28:31], v[120:123], v[76:79]
  v_add_f32 v18, v70, v71
  v_mfma_f32_16x16x32_bf16 v[80:83], v[28:31], v[152:155], v[80:83]
  v_exp_f32 v73, v73
  v_mfma_f32_16x16x32_bf16 v[84:87], v[28:31], v[184:187], v[84:87]
  v_cvt_pk_bf16_f32 v68, v68, v69
  v_cvt_pk_bf16_f32 v69, v70, v71
  v_mfma_f32_16x16x32_bf16 v[88:91], v[28:31], v[216:219], v[88:91]
  v_exp_f32 v74, v74
  v_mfma_f32_16x16x32_bf16 v[92:95], v[28:31], v[248:251], v[92:95]
  v_add_f32 v17, v17, v18
  s_waitcnt lgkmcnt(1)
  v_mfma_f32_16x16x32_bf16 v[76:79], v[32:35], v[124:127], v[76:79]
  ds_write_b64 v3, v[68:69] offset:768
  v_mfma_f32_16x16x32_bf16 v[80:83], v[32:35], v[156:159], v[80:83]
  v_exp_f32 v75, v75
  v_mfma_f32_16x16x32_bf16 v[84:87], v[32:35], v[188:191], v[84:87]
  v_add_f32 v10, v10, v17
  v_add_f32 v5, v72, v73
  v_mfma_f32_16x16x32_bf16 v[88:91], v[32:35], v[220:223], v[88:91]
  v_add_f32 v6, v74, v75
  v_cvt_pk_bf16_f32 v72, v72, v73
  v_mfma_f32_16x16x32_bf16 v[92:95], v[32:35], v[252:255], v[92:95]
  v_cvt_pk_bf16_f32 v73, v74, v75
  v_add_f32 v5, v5, v6
  ds_write_b64 v3, v[72:73] offset:1024
  v_add_f32 v11, v11, v5
  s_waitcnt vmcnt(8) lgkmcnt(0)
  s_barrier
  s_sub_u32 s30, s30, 1
  s_cmp_lg_u32 s30, 0
  s_cbranch_scc1 L_S_loop
  ds_read_b128 v[20:23], v1 offset:0
  ds_read_b128 v[24:27], v2 offset:0
  ds_read_b128 v[28:31], v1 offset:2048
  ds_read_b128 v[32:35], v2 offset:2048
  s_add_u32 m0, s39, 49152
  s_nop 0
  buffer_load_dwordx4 v16, s[60:63], s29 offen offset:0 nt lds
  v_exp_f32 v76, v76
  v_exp_f32 v77, v77
  s_add_u32 m0, s39, 51072
  s_nop 0
  buffer_load_dwordx4 v16, s[60:63], s29 offen offset:128 nt lds
  v_exp_f32 v78, v78
  v_exp_f32 v79, v79
  s_add_u32 m0, s39, 52992
  s_nop 0
  buffer_load_dwordx4 v16, s[60:63], s29 offen offset:256 nt lds
  v_exp_f32 v80, v80
  v_add_f32 v5, v76, v77
  v_add_f32 v6, v78, v79
  s_add_u32 m0, s39, 54912
  s_nop 0
  buffer_load_dwordx4 v16, s[60:63], s29 offen offset:384 nt lds
  s_add_u32 s29, s29, 16384
  v_exp_f32 v81, v81
  v_cvt_pk_bf16_f32 v76, v76, v77
  v_cvt_pk_bf16_f32 v77, v78, v79
  s_waitcnt lgkmcnt(3)
  v_mfma_f32_16x16x32_bf16 v[56:59], v[20:23], v[96:99], v[36:39]
  v_exp_f32 v82, v82
  v_mfma_f32_16x16x32_bf16 v[60:63], v[20:23], v[128:131], v[40:43]
  v_add_f32 v5, v5, v6
  ds_write_b64 v3, v[76:77] offset:10240
  v_mfma_f32_16x16x32_bf16 v[64:67], v[20:23], v[160:163], v[44:47]
  v_exp_f32 v83, v83
  v_mfma_f32_16x16x32_bf16 v[68:71], v[20:23], v[192:195], v[48:51]
  v_add_f32 v7, v7, v5
  v_mfma_f32_16x16x32_bf16 v[72:75], v[20:23], v[224:227], v[52:55]
  s_waitcnt lgkmcnt(3)
  v_mfma_f32_16x16x32_bf16 v[56:59], v[24:27], v[100:103], v[56:59]
  v_exp_f32 v84, v84
  v_mfma_f32_16x16x32_bf16 v[60:63], v[24:27], v[132:135], v[60:63]
  ds_read_b128 v[20:23], v1 offset:4096
  v_add_f32 v17, v80, v81
  v_mfma_f32_16x16x32_bf16 v[64:67], v[24:27], v[164:167], v[64:67]
  v_add_f32 v18, v82, v83
  v_mfma_f32_16x16x32_bf16 v[68:71], v[24:27], v[196:199], v[68:71]
  v_exp_f32 v85, v85
  v_mfma_f32_16x16x32_bf16 v[72:75], v[24:27], v[228:231], v[72:75]
  v_cvt_pk_bf16_f32 v80, v80, v81
  s_waitcnt lgkmcnt(3)
  v_mfma_f32_16x16x32_bf16 v[56:59], v[28:31], v[104:107], v[56:59]
  v_cvt_pk_bf16_f32 v81, v82, v83
  v_mfma_f32_16x16x32_bf16 v[60:63], v[28:31], v[136:139], v[60:63]
  ds_read_b128 v[24:27], v2 offset:4096
  v_mfma_f32_16x16x32_bf16 v[64:67], v[28:31], v[168:171], v[64:67]
  v_exp_f32 v86, v86
  v_mfma_f32_16x16x32_bf16 v[68:71], v[28:31], v[200:203], v[68:71]
  v_add_f32 v17, v17, v18
  ds_write_b64 v3, v[80:81] offset:10496
  v_mfma_f32_16x16x32_bf16 v[72:75], v[28:31], v[232:235], v[72:75]
  s_waitcnt lgkmcnt(4)
  v_mfma_f32_16x16x32_bf16 v[56:59], v[32:35], v[108:111], v[56:59]
  v_exp_f32 v87, v87
  v_mfma_f32_16x16x32_bf16 v[60:63], v[32:35], v[140:143], v[60:63]
  ds_read_b128 v[28:31], v1 offset:6144
  v_add_f32 v8, v8, v17
  v_mfma_f32_16x16x32_bf16 v[64:67], v[32:35], v[172:175], v[64:67]
  v_exp_f32 v88, v88
  v_mfma_f32_16x16x32_bf16 v[68:71], v[32:35], v[204:207], v[68:71]
  v_add_f32 v5, v84, v85
  v_add_f32 v6, v86, v87
  v_mfma_f32_16x16x32_bf16 v[72:75], v[32:35], v[236:239], v[72:75]
  s_waitcnt lgkmcnt(3)
  v_mfma_f32_16x16x32_bf16 v[56:59], v[20:23], v[112:115], v[56:59]
  v_exp_f32 v89, v89
  v_mfma_f32_16x16x32_bf16 v[60:63], v[20:23], v[144:147], v[60:63]
  ds_read_b128 v[32:35], v2 offset:6144
  v_cvt_pk_bf16_f32 v84, v84, v85
  v_mfma_f32_16x16x32_bf16 v[64:67], v[20:23], v[176:179], v[64:67]
  v_cvt_pk_bf16_f32 v85, v86, v87
  v_mfma_f32_16x16x32_bf16 v[68:71], v[20:23], v[208:211], v[68:71]
  v_exp_f32 v90, v90
  v_mfma_f32_16x16x32_bf16 v[72:75], v[20:23], v[240:243], v[72:75]
  v_add_f32 v5, v5, v6
  s_waitcnt lgkmcnt(3)
  v_mfma_f32_16x16x32_bf16 v[56:59], v[24:27], v[116:119], v[56:59]
  ds_write_b64 v3, v[84:85] offset:10752
  v_mfma_f32_16x16x32_bf16 v[60:63], v[24:27], v[148:151], v[60:63]
  v_exp_f32 v91, v91
  v_mfma_f32_16x16x32_bf16 v[64:67], v[24:27], v[180:183], v[64:67]
  v_add_f32 v9, v9, v5
  v_mfma_f32_16x16x32_bf16 v[68:71], v[24:27], v[212:215], v[68:71]
  v_exp_f32 v92, v92
  v_mfma_f32_16x16x32_bf16 v[72:75], v[24:27], v[244:247], v[72:75]
  v_add_f32 v17, v88, v89
  s_waitcnt lgkmcnt(2)
  v_mfma_f32_16x16x32_bf16 v[56:59], v[28:31], v[120:123], v[56:59]
  v_add_f32 v18, v90, v91
  v_mfma_f32_16x16x32_bf16 v[60:63], v[28:31], v[152:155], v[60:63]
  v_exp_f32 v93, v93
  v_mfma_f32_16x16x32_bf16 v[64:67], v[28:31], v[184:187], v[64:67]
  v_cvt_pk_bf16_f32 v88, v88, v89
  v_cvt_pk_bf16_f32 v89, v90, v91
  v_mfma_f32_16x16x32_bf16 v[68:71], v[28:31], v[216:219], v[68:71]
  v_exp_f32 v94, v94
  v_mfma_f32_16x16x32_bf16 v[72:75], v[28:31], v[248:251], v[72:75]
  v_add_f32 v17, v17, v18
  s_waitcnt lgkmcnt(1)
  v_mfma_f32_16x16x32_bf16 v[56:59], v[32:35], v[124:127], v[56:59]
  ds_write_b64 v3, v[88:89] offset:11008
  v_mfma_f32_16x16x32_bf16 v[60:63], v[32:35], v[156:159], v[60:63]
  v_exp_f32 v95, v95
  v_mfma_f32_16x16x32_bf16 v[64:67], v[32:35], v[188:191], v[64:67]
  v_add_f32 v10, v10, v17
  v_add_f32 v5, v92, v93
  v_mfma_f32_16x16x32_bf16 v[68:71], v[32:35], v[220:223], v[68:71]
  v_add_f32 v6, v94, v95
  v_cvt_pk_bf16_f32 v92, v92, v93
  v_mfma_f32_16x16x32_bf16 v[72:75], v[32:35], v[252:255], v[72:75]
  v_cvt_pk_bf16_f32 v93, v94, v95
  v_add_f32 v5, v5, v6
  ds_write_b64 v3, v[92:93] offset:11264
  v_add_f32 v11, v11, v5
  s_waitcnt vmcnt(8) lgkmcnt(0)
  s_barrier
  ds_read_b128 v[20:23], v1 offset:16384
  ds_read_b128 v[24:27], v2 offset:16384
  ds_read_b128 v[28:31], v1 offset:18432
  ds_read_b128 v[32:35], v2 offset:18432
  v_bfe_u32 v13, v0, 4, 1
  s_lshl_b32 s32, s44, 1
  v_or_b32 v13, s32, v13
  v_lshlrev_b32 v13, 1, v13
  v_and_b32 v14, 7, v0
  v_xor_b32 v13, v13, v14
  v_lshrrev_b32 v14, 3, v0
  s_lshl_b32 s32, s24, 3
  v_add_u32 v14, s32, v14
  v_mul_u32_u24 v14, 896, v14
  v_lshl_add_u32 v12, v13, 4, v14
  s_lshl_b32 s32, s27, 7
  s_add_u32 s76, s42, s32
  s_sub_u32 s77, s42, s32
  v_exp_f32 v56, v56
  v_exp_f32 v57, v57
  s_add_u32 m0, s36, 98304
  s_add_u32 s32, s76, 0
  buffer_load_dwordx4 v12, s[16:19], s32 offen  lds
  v_exp_f32 v58, v58
  v_exp_f32 v59, v59
  s_add_u32 m0, s36, 102400
  s_add_u32 s32, s76, 28672
  buffer_load_dwordx4 v12, s[16:19], s32 offen  lds
  v_exp_f32 v60, v60
  v_add_f32 v5, v56, v57
  v_add_f32 v6, v58, v59
  s_add_u32 m0, s36, 106496
  s_add_u32 s32, s76, 57344
  buffer_load_dwordx4 v12, s[16:19], s32 offen  lds
  v_exp_f32 v61, v61
  v_cvt_pk_bf16_f32 v56, v56, v57
  v_cvt_pk_bf16_f32 v57, v58, v59
  s_add_u32 m0, s36, 110592
  s_add_u32 s32, s76, 86016
  buffer_load_dwordx4 v12, s[16:19], s32 offen  lds
  v_exp_f32 v62, v62
  v_add_f32 v5, v5, v6
  ds_write_b64 v3, v[56:57] offset:0
  s_waitcnt lgkmcnt(4)
  v_mfma_f32_16x16x32_bf16 v[76:79], v[20:23], v[96:99], v[36:39]
  v_exp_f32 v63, v63
  v_mfma_f32_16x16x32_bf16 v[80:83], v[20:23], v[128:131], v[40:43]
  v_add_f32 v7, v7, v5
  v_mfma_f32_16x16x32_bf16 v[84:87], v[20:23], v[160:163], v[44:47]
  v_exp_f32 v64, v64
  v_mfma_f32_16x16x32_bf16 v[88:91], v[20:23], v[192:195], v[48:51]
  v_add_f32 v17, v60, v61
  v_add_f32 v18, v62, v63
  v_mfma_f32_16x16x32_bf16 v[92:95], v[20:23], v[224:227], v[52:55]
  s_waitcnt lgkmcnt(3)
  v_mfma_f32_16x16x32_bf16 v[76:79], v[24:27], v[100:103], v[76:79]
  v_exp_f32 v65, v65
  v_mfma_f32_16x16x32_bf16 v[80:83], v[24:27], v[132:135], v[80:83]
  ds_read_b128 v[20:23], v1 offset:20480
  v_cvt_pk_bf16_f32 v60, v60, v61
  v_mfma_f32_16x16x32_bf16 v[84:87], v[24:27], v[164:167], v[84:87]
  v_cvt_pk_bf16_f32 v61, v62, v63
  v_mfma_f32_16x16x32_bf16 v[88:91], v[24:27], v[196:199], v[88:91]
  v_exp_f32 v66, v66
  v_mfma_f32_16x16x32_bf16 v[92:95], v[24:27], v[228:231], v[92:95]
  v_add_f32 v17, v17, v18
  s_waitcnt lgkmcnt(3)
  v_mfma_f32_16x16x32_bf16 v[76:79], v[28:31], v[104:107], v[76:79]
  ds_write_b64 v3, v[60:61] offset:256
  v_mfma_f32_16x16x32_bf16 v[80:83], v[28:31], v[136:139], v[80:83]
  ds_read_b128 v[24:27], v2 offset:20480
  v_mfma_f32_16x16x32_bf16 v[84:87], v[28:31], v[168:171], v[84:87]
  v_exp_f32 v67, v67
  v_mfma_f32_16x16x32_bf16 v[88:91], v[28:31], v[200:203], v[88:91]
  v_add_f32 v8, v8, v17
  v_mfma_f32_16x16x32_bf16 v[92:95], v[28:31], v[232:235], v[92:95]
  s_waitcnt lgkmcnt(4)
  v_mfma_f32_16x16x32_bf16 v[76:79], v[32:35], v[108:111], v[76:79]
  v_exp_f32 v68, v68
  v_mfma_f32_16x16x32_bf16 v[80:83], v[32:35], v[140:143], v[80:83]
  ds_read_b128 v[28:31], v1 offset:22528
  v_add_f32 v5, v64, v65
  v_mfma_f32_16x16x32_bf16 v[84:87], v[32:35], v[172:175], v[84:87]
  v_add_f32 v6, v66, v67
  v_mfma_f32_16x16x32_bf16 v[88:91], v[32:35], v[204:207], v[88:91]
  v_exp_f32 v69, v69
  v_mfma_f32_16x16x32_bf16 v[92:95], v[32:35], v[236:239], v[92:95]
  v_cvt_pk_bf16_f32 v64, v64, v65
  s_waitcnt lgkmcnt(3)
  v_mfma_f32_16x16x32_bf16 v[76:79], v[20:23], v[112:115], v[76:79]
  v_cvt_pk_bf16_f32 v65, v66, v67
  v_mfma_f32_16x16x32_bf16 v[80:83], v[20:23], v[144:147], v[80:83]
  ds_read_b128 v[32:35], v2 offset:22528
  v_mfma_f32_16x16x32_bf16 v[84:87], v[20:23], v[176:179], v[84:87]
  v_exp_f32 v70, v70
  v_mfma_f32_16x16x32_bf16 v[88:91], v[20:23], v[208:211], v[88:91]
  v_add_f32 v5, v5, v6
  ds_write_b64 v3, v[64:65] offset:512
  v_mfma_f32_16x16x32_bf16 v[92:95], v[20:23], v[240:243], v[92:95]
  s_waitcnt lgkmcnt(3)
  v_mfma_f32_16x16x32_bf16 v[76:79], v[24:27], v[116:119], v[76:79]
  v_exp_f32 v71, v71
  v_mfma_f32_16x16x32_bf16 v[80:83], v[24:27], v[148:151], v[80:83]
  v_add_f32 v9, v9, v5
  v_mfma_f32_16x16x32_bf16 v[84:87], v[24:27], v[180:183], v[84:87]
  v_exp_f32 v72, v72
  v_mfma_f32_16x16x32_bf16 v[88:91], v[24:27], v[212:215], v[88:91]
  v_add_f32 v17, v68, v69
  v_add_f32 v18, v70, v71
  v_mfma_f32_16x16x32_bf16 v[92:95], v[24:27], v[244:247], v[92:95]
  s_waitcnt lgkmcnt(2)
  v_mfma_f32_16x16x32_bf16 v[76:79], v[28:31], v[120:123], v[76:79]
  v_exp_f32 v73, v73
  v_mfma_f32_16x16x32_bf16 v[80:83], v[28:31], v[152:155], v[80:83]
  v_cvt_pk_bf16_f32 v68, v68, v69
  v_cvt_pk_bf16_f32 v69, v70, v71
  v_mfma_f32_16x16x32_bf16 v[84:87], v[28:31], v[184:187], v[84:87]
  v_exp_f32 v74, v74
  v_mfma_f32_16x16x32_bf16 v[88:91], v[28:31], v[216:219], v[88:91]
  v_add_f32 v17, v17, v18
  ds_write_b64 v3, v[68:69] offset:768
  v_mfma_f32_16x16x32_bf16 v[92:95], v[28:31], v[248:251], v[92:95]
  s_waitcnt lgkmcnt(2)
  v_mfma_f32_16x16x32_bf16 v[76:79], v[32:35], v[124:127], v[76:79]
  v_exp_f32 v75, v75
  v_mfma_f32_16x16x32_bf16 v[80:83], v[32:35], v[156:159], v[80:83]
  v_add_f32 v10, v10, v17
  v_add_f32 v5, v72, v73
  v_mfma_f32_16x16x32_bf16 v[84:87], v[32:35], v[188:191], v[84:87]
  v_add_f32 v6, v74, v75
  v_cvt_pk_bf16_f32 v72, v72, v73
  v_mfma_f32_16x16x32_bf16 v[88:91], v[32:35], v[220:223], v[88:91]
  v_cvt_pk_bf16_f32 v73, v74, v75
  v_add_f32 v5, v5, v6
  v_mfma_f32_16x16x32_bf16 v[92:95], v[32:35], v[252:255], v[92:95]
  ds_write_b64 v3, v[72:73] offset:1024
  v_add_f32 v11, v11, v5
  s_waitcnt vmcnt(8) lgkmcnt(0)
  s_barrier
  ds_read_b128 v[20:23], v1 offset:32768
  ds_read_b128 v[24:27], v2 offset:32768
  ds_read_b128 v[28:31], v1 offset:34816
  ds_read_b128 v[32:35], v2 offset:34816
  s_add_u32 m0, s36, 114688
  s_add_u32 s32, s76, 114688
  buffer_load_dwordx4 v12, s[16:19], s32 offen  lds
  v_exp_f32 v76, v76
  v_exp_f32 v77, v77
  s_add_u32 m0, s36, 118784
  s_add_u32 s32, s76, 143360
  buffer_load_dwordx4 v12, s[16:19], s32 offen  lds
  v_exp_f32 v78, v78
  v_exp_f32 v79, v79
  s_add_u32 m0, s36, 122880
  s_add_u32 s32, s76, 172032
  buffer_load_dwordx4 v12, s[16:19], s32 offen  lds
  v_exp_f32 v80, v80
  v_add_f32 v5, v76, v77
  v_add_f32 v6, v78, v79
  s_add_u32 m0, s36, 126976
  s_add_u32 s32, s76, 200704
  buffer_load_dwordx4 v12, s[16:19], s32 offen  lds
  v_exp_f32 v81, v81
  v_cvt_pk_bf16_f32 v76, v76, v77
  v_cvt_pk_bf16_f32 v77, v78, v79
  s_waitcnt lgkmcnt(3)
  v_mfma_f32_16x16x32_bf16 v[56:59], v[20:23], v[96:99], v[36:39]
  v_exp_f32 v82, v82
  v_mfma_f32_16x16x32_bf16 v[60:63], v[20:23], v[128:131], v[40:43]
  v_add_f32 v5, v5, v6
  ds_write_b64 v3, v[76:77] offset:10240
  v_mfma_f32_16x16x32_bf16 v[64:67], v[20:23], v[160:163], v[44:47]
  v_exp_f32 v83, v83
  v_mfma_f32_16x16x32_bf16 v[68:71], v[20:23], v[192:195], v[48:51]
  v_add_f32 v7, v7, v5
  v_mfma_f32_16x16x32_bf16 v[72:75], v[20:23], v[224:227], v[52:55]
  s_waitcnt lgkmcnt(3)
  v_mfma_f32_16x16x32_bf16 v[56:59], v[24:27], v[100:103], v[56:59]
  v_exp_f32 v84, v84
  v_mfma_f32_16x16x32_bf16 v[60:63], v[24:27], v[132:135], v[60:63]
  ds_read_b128 v[20:23], v1 offset:36864
  v_add_f32 v17, v80, v81
  v_mfma_f32_16x16x32_bf16 v[64:67], v[24:27], v[164:167], v[64:67]
  v_add_f32 v18, v82, v83
  v_mfma_f32_16x16x32_bf16 v[68:71], v[24:27], v[196:199], v[68:71]
  v_exp_f32 v85, v85
  v_mfma_f32_16x16x32_bf16 v[72:75], v[24:27], v[228:231], v[72:75]
  v_cvt_pk_bf16_f32 v80, v80, v81
  s_waitcnt lgkmcnt(3)
  v_mfma_f32_16x16x32_bf16 v[56:59], v[28:31], v[104:107], v[56:59]
  v_cvt_pk_bf16_f32 v81, v82, v83
  v_mfma_f32_16x16x32_bf16 v[60:63], v[28:31], v[136:139], v[60:63]
  ds_read_b128 v[24:27], v2 offset:36864
  v_mfma_f32_16x16x32_bf16 v[64:67], v[28:31], v[168:171], v[64:67]
  v_exp_f32 v86, v86
  v_mfma_f32_16x16x32_bf16 v[68:71], v[28:31], v[200:203], v[68:71]
  v_add_f32 v17, v17, v18
  ds_write_b64 v3, v[80:81] offset:10496
  v_mfma_f32_16x16x32_bf16 v[72:75], v[28:31], v[232:235], v[72:75]
  s_waitcnt lgkmcnt(4)
  v_mfma_f32_16x16x32_bf16 v[56:59], v[32:35], v[108:111], v[56:59]
  v_exp_f32 v87, v87
  v_mfma_f32_16x16x32_bf16 v[60:63], v[32:35], v[140:143], v[60:63]
  ds_read_b128 v[28:31], v1 offset:38912
  v_add_f32 v8, v8, v17
  v_mfma_f32_16x16x32_bf16 v[64:67], v[32:35], v[172:175], v[64:67]
  v_exp_f32 v88, v88
  v_mfma_f32_16x16x32_bf16 v[68:71], v[32:35], v[204:207], v[68:71]
  v_add_f32 v5, v84, v85
  v_add_f32 v6, v86, v87
  v_mfma_f32_16x16x32_bf16 v[72:75], v[32:35], v[236:239], v[72:75]
  s_waitcnt lgkmcnt(3)
  v_mfma_f32_16x16x32_bf16 v[56:59], v[20:23], v[112:115], v[56:59]
  v_exp_f32 v89, v89
  v_mfma_f32_16x16x32_bf16 v[60:63], v[20:23], v[144:147], v[60:63]
  ds_read_b128 v[32:35], v2 offset:38912
  v_cvt_pk_bf16_f32 v84, v84, v85
  v_mfma_f32_16x16x32_bf16 v[64:67], v[20:23], v[176:179], v[64:67]
  v_cvt_pk_bf16_f32 v85, v86, v87
  v_mfma_f32_16x16x32_bf16 v[68:71], v[20:23], v[208:211], v[68:71]
  v_exp_f32 v90, v90
  v_mfma_f32_16x16x32_bf16 v[72:75], v[20:23], v[240:243], v[72:75]
  v_add_f32 v5, v5, v6
  s_waitcnt lgkmcnt(3)
  v_mfma_f32_16x16x32_bf16 v[56:59], v[24:27], v[116:119], v[56:59]
  ds_write_b64 v3, v[84:85] offset:10752
  v_mfma_f32_16x16x32_bf16 v[60:63], v[24:27], v[148:151], v[60:63]
  v_exp_f32 v91, v91
  v_mfma_f32_16x16x32_bf16 v[64:67], v[24:27], v[180:183], v[64:67]
  v_add_f32 v9, v9, v5
  v_mfma_f32_16x16x32_bf16 v[68:71], v[24:27], v[212:215], v[68:71]
  v_exp_f32 v92, v92
  v_mfma_f32_16x16x32_bf16 v[72:75], v[24:27], v[244:247], v[72:75]
  v_add_f32 v17, v88, v89
  s_waitcnt lgkmcnt(2)
  v_mfma_f32_16x16x32_bf16 v[56:59], v[28:31], v[120:123], v[56:59]
  v_add_f32 v18, v90, v91
  v_mfma_f32_16x16x32_bf16 v[60:63], v[28:31], v[152:155], v[60:63]
  v_exp_f32 v93, v93
  v_mfma_f32_16x16x32_bf16 v[64:67], v[28:31], v[184:187], v[64:67]
  v_cvt_pk_bf16_f32 v88, v88, v89
  v_cvt_pk_bf16_f32 v89, v90, v91
  v_mfma_f32_16x16x32_bf16 v[68:71], v[28:31], v[216:219], v[68:71]
  v_exp_f32 v94, v94
  v_mfma_f32_16x16x32_bf16 v[72:75], v[28:31], v[248:251], v[72:75]
  v_add_f32 v17, v17, v18
  s_waitcnt lgkmcnt(1)
  v_mfma_f32_16x16x32_bf16 v[56:59], v[32:35], v[124:127], v[56:59]
  ds_write_b64 v3, v[88:89] offset:11008
  v_mfma_f32_16x16x32_bf16 v[60:63], v[32:35], v[156:159], v[60:63]
  v_exp_f32 v95, v95
  v_mfma_f32_16x16x32_bf16 v[64:67], v[32:35], v[188:191], v[64:67]
  v_add_f32 v10, v10, v17
  v_add_f32 v5, v92, v93
  v_mfma_f32_16x16x32_bf16 v[68:71], v[32:35], v[220:223], v[68:71]
  v_add_f32 v6, v94, v95
  v_cvt_pk_bf16_f32 v92, v92, v93
  v_mfma_f32_16x16x32_bf16 v[72:75], v[32:35], v[252:255], v[72:75]
  v_cvt_pk_bf16_f32 v93, v94, v95
  v_add_f32 v5, v5, v6
  ds_write_b64 v3, v[92:93] offset:11264
  v_add_f32 v11, v11, v5
  s_add_u32 m0, s36, 81920
  s_add_u32 s32, s76, 114944
  buffer_load_dwordx4 v12, s[16:19], s32 offen  lds
  s_add_u32 m0, s36, 86016
  s_add_u32 s32, s76, 143616
  buffer_load_dwordx4 v12, s[16:19], s32 offen  lds
  s_add_u32 m0, s36, 90112
  s_add_u32 s32, s76, 172288
  buffer_load_dwordx4 v12, s[16:19], s32 offen  lds
  s_add_u32 m0, s36, 94208
  s_add_u32 s32, s76, 200960
  buffer_load_dwordx4 v12, s[16:19], s32 offen  lds
  s_waitcnt vmcnt(12) lgkmcnt(0)
  s_barrier
  ds_read_b128 v[20:23], v1 offset:49152
  ds_read_b128 v[24:27], v2 offset:49152
  ds_read_b128 v[28:31], v1 offset:51200
  ds_read_b128 v[32:35], v2 offset:51200
  s_add_u32 m0, s36, 131072
  s_add_u32 s32, s77, 128
  buffer_load_dwordx4 v12, s[16:19], s32 offen  lds
  v_exp_f32 v56, v56
  v_exp_f32 v57, v57
  s_add_u32 m0, s36, 135168
  s_add_u32 s32, s77, 28800
  buffer_load_dwordx4 v12, s[16:19], s32 offen  lds
  v_exp_f32 v58, v58
  v_exp_f32 v59, v59
  s_add_u32 m0, s36, 139264
  s_add_u32 s32, s77, 57472
  buffer_load_dwordx4 v12, s[16:19], s32 offen  lds
  v_exp_f32 v60, v60
  v_add_f32 v5, v56, v57
  v_add_f32 v6, v58, v59
  s_add_u32 m0, s36, 143360
  s_add_u32 s32, s77, 86144
  buffer_load_dwordx4 v12, s[16:19], s32 offen  lds
  v_exp_f32 v61, v61
  v_cvt_pk_bf16_f32 v56, v56, v57
  v_cvt_pk_bf16_f32 v57, v58, v59
  s_waitcnt lgkmcnt(3)
  v_mfma_f32_16x16x32_bf16 v[76:79], v[20:23], v[96:99], v[36:39]
  v_exp_f32 v62, v62
  v_mfma_f32_16x16x32_bf16 v[80:83], v[20:23], v[128:131], v[40:43]
  v_add_f32 v5, v5, v6
  ds_write_b64 v3, v[56:57] offset:0
  v_mfma_f32_16x16x32_bf16 v[84:87], v[20:23], v[160:163], v[44:47]
  v_exp_f32 v63, v63
  v_mfma_f32_16x16x32_bf16 v[88:91], v[20:23], v[192:195], v[48:51]
  v_add_f32 v7, v7, v5
  v_mfma_f32_16x16x32_bf16 v[92:95], v[20:23], v[224:227], v[52:55]
  s_waitcnt lgkmcnt(3)
  v_mfma_f32_16x16x32_bf16 v[76:79], v[24:27], v[100:103], v[76:79]
  v_exp_f32 v64, v64
  v_mfma_f32_16x16x32_bf16 v[80:83], v[24:27], v[132:135], v[80:83]
  ds_read_b128 v[20:23], v1 offset:53248
  v_add_f32 v17, v60, v61
  v_mfma_f32_16x16x32_bf16 v[84:87], v[24:27], v[164:167], v[84:87]
  v_add_f32 v18, v62, v63
  v_mfma_f32_16x16x32_bf16 v[88:91], v[24:27], v[196:199], v[88:91]
  v_exp_f32 v65, v65
  v_mfma_f32_16x16x32_bf16 v[92:95], v[24:27], v[228:231], v[92:95]
  v_cvt_pk_bf16_f32 v60, v60, v61
  s_waitcnt lgkmcnt(3)
  v_mfma_f32_16x16x32_bf16 v[76:79], v[28:31], v[104:107], v[76:79]
  v_cvt_pk_bf16_f32 v61, v62, v63
  v_mfma_f32_16x16x32_bf16 v[80:83], v[28:31], v[136:139], v[80:83]
  ds_read_b128 v[24:27], v2 offset:53248
  v_mfma_f32_16x16x32_bf16 v[84:87], v[28:31], v[168:171], v[84:87]
  v_exp_f32 v66, v66
  v_mfma_f32_16x16x32_bf16 v[88:91], v[28:31], v[200:203], v[88:91]
  v_add_f32 v17, v17, v18
  ds_write_b64 v3, v[60:61] offset:256
  v_mfma_f32_16x16x32_bf16 v[92:95], v[28:31], v[232:235], v[92:95]
  s_waitcnt lgkmcnt(4)
  v_mfma_f32_16x16x32_bf16 v[76:79], v[32:35], v[108:111], v[76:79]
  v_exp_f32 v67, v67
  v_mfma_f32_16x16x32_bf16 v[80:83], v[32:35], v[140:143], v[80:83]
  ds_read_b128 v[28:31], v1 offset:55296
  v_add_f32 v8, v8, v17
  v_mfma_f32_16x16x32_bf16 v[84:87], v[32:35], v[172:175], v[84:87]
  v_exp_f32 v68, v68
  v_mfma_f32_16x16x32_bf16 v[88:91], v[32:35], v[204:207], v[88:91]
  v_add_f32 v5, v64, v65
  v_add_f32 v6, v66, v67
  v_mfma_f32_16x16x32_bf16 v[92:95], v[32:35], v[236:239], v[92:95]
  s_waitcnt lgkmcnt(3)
  v_mfma_f32_16x16x32_bf16 v[76:79], v[20:23], v[112:115], v[76:79]
  v_exp_f32 v69, v69
  v_mfma_f32_16x16x32_bf16 v[80:83], v[20:23], v[144:147], v[80:83]
  ds_read_b128 v[32:35], v2 offset:55296
  v_cvt_pk_bf16_f32 v64, v64, v65
  v_mfma_f32_16x16x32_bf16 v[84:87], v[20:23], v[176:179], v[84:87]
  v_cvt_pk_bf16_f32 v65, v66, v67
  v_mfma_f32_16x16x32_bf16 v[88:91], v[20:23], v[208:211], v[88:91]
  v_exp_f32 v70, v70
  v_mfma_f32_16x16x32_bf16 v[92:95], v[20:23], v[240:243], v[92:95]
  v_add_f32 v5, v5, v6
  s_waitcnt lgkmcnt(3)
  v_mfma_f32_16x16x32_bf16 v[76:79], v[24:27], v[116:119], v[76:79]
  ds_write_b64 v3, v[64:65] offset:512
  v_mfma_f32_16x16x32_bf16 v[80:83], v[24:27], v[148:151], v[80:83]
  v_exp_f32 v71, v71
  v_mfma_f32_16x16x32_bf16 v[84:87], v[24:27], v[180:183], v[84:87]
  v_add_f32 v9, v9, v5
  v_mfma_f32_16x16x32_bf16 v[88:91], v[24:27], v[212:215], v[88:91]
  v_exp_f32 v72, v72
  v_mfma_f32_16x16x32_bf16 v[92:95], v[24:27], v[244:247], v[92:95]
  v_add_f32 v17, v68, v69
  s_waitcnt lgkmcnt(2)
  v_mfma_f32_16x16x32_bf16 v[76:79], v[28:31], v[120:123], v[76:79]
  v_add_f32 v18, v70, v71
  v_mfma_f32_16x16x32_bf16 v[80:83], v[28:31], v[152:155], v[80:83]
  v_exp_f32 v73, v73
  v_mfma_f32_16x16x32_bf16 v[84:87], v[28:31], v[184:187], v[84:87]
  v_cvt_pk_bf16_f32 v68, v68, v69
  v_cvt_pk_bf16_f32 v69, v70, v71
  v_mfma_f32_16x16x32_bf16 v[88:91], v[28:31], v[216:219], v[88:91]
  v_exp_f32 v74, v74
  v_mfma_f32_16x16x32_bf16 v[92:95], v[28:31], v[248:251], v[92:95]
  v_add_f32 v17, v17, v18
  s_waitcnt lgkmcnt(1)
  v_mfma_f32_16x16x32_bf16 v[76:79], v[32:35], v[124:127], v[76:79]
  ds_write_b64 v3, v[68:69] offset:768
  v_mfma_f32_16x16x32_bf16 v[80:83], v[32:35], v[156:159], v[80:83]
  v_exp_f32 v75, v75
  v_mfma_f32_16x16x32_bf16 v[84:87], v[32:35], v[188:191], v[84:87]
  v_add_f32 v10, v10, v17
  v_add_f32 v5, v72, v73
  v_mfma_f32_16x16x32_bf16 v[88:91], v[32:35], v[220:223], v[88:91]
  v_add_f32 v6, v74, v75
  v_cvt_pk_bf16_f32 v72, v72, v73
  v_mfma_f32_16x16x32_bf16 v[92:95], v[32:35], v[252:255], v[92:95]
  v_cvt_pk_bf16_f32 v73, v74, v75
  v_add_f32 v5, v5, v6
  ds_write_b64 v3, v[72:73] offset:1024
  v_add_f32 v11, v11, v5
  s_add_u32 m0, s36, 32768
  s_add_u32 s32, s77, 384
  buffer_load_dwordx4 v12, s[16:19], s32 offen  lds
  s_add_u32 m0, s36, 36864
  s_add_u32 s32, s77, 29056
  buffer_load_dwordx4 v12, s[16:19], s32 offen  lds
  s_add_u32 m0, s36, 40960
  s_add_u32 s32, s77, 57728
  buffer_load_dwordx4 v12, s[16:19], s32 offen  lds
  s_add_u32 m0, s36, 45056
  s_add_u32 s32, s77, 86400
  buffer_load_dwordx4 v12, s[16:19], s32 offen  lds
  s_waitcnt lgkmcnt(0)
  s_barrier
  v_exp_f32 v76, v76
  v_exp_f32 v77, v77
  v_exp_f32 v78, v78
  v_exp_f32 v79, v79
  v_exp_f32 v80, v80
  v_add_f32 v5, v76, v77
  v_add_f32 v6, v78, v79
  v_exp_f32 v81, v81
  v_cvt_pk_bf16_f32 v76, v76, v77
  v_cvt_pk_bf16_f32 v77, v78, v79
  v_exp_f32 v82, v82
  v_add_f32 v5, v5, v6
  ds_write_b64 v3, v[76:77] offset:10240
  v_exp_f32 v83, v83
  v_add_f32 v7, v7, v5
  v_exp_f32 v84, v84
  v_add_f32 v17, v80, v81
  v_add_f32 v18, v82, v83
  v_exp_f32 v85, v85
  v_cvt_pk_bf16_f32 v80, v80, v81
  v_cvt_pk_bf16_f32 v81, v82, v83
  v_exp_f32 v86, v86
  v_add_f32 v17, v17, v18
  ds_write_b64 v3, v[80:81] offset:10496
  v_exp_f32 v87, v87
  v_add_f32 v8, v8, v17
  v_exp_f32 v88, v88
  v_add_f32 v5, v84, v85
  v_add_f32 v6, v86, v87
  v_exp_f32 v89, v89
  v_cvt_pk_bf16_f32 v84, v84, v85
  v_cvt_pk_bf16_f32 v85, v86, v87
  v_exp_f32 v90, v90
  v_add_f32 v5, v5, v6
  ds_write_b64 v3, v[84:85] offset:10752
  v_exp_f32 v91, v91
  v_add_f32 v9, v9, v5
  v_exp_f32 v92, v92
  v_add_f32 v17, v88, v89
  v_add_f32 v18, v90, v91
  v_exp_f32 v93, v93
  v_cvt_pk_bf16_f32 v88, v88, v89
  v_cvt_pk_bf16_f32 v89, v90, v91
  v_exp_f32 v94, v94
  v_add_f32 v17, v17, v18
  ds_write_b64 v3, v[88:89] offset:11008
  v_exp_f32 v95, v95
  v_add_f32 v10, v10, v17
  v_add_f32 v5, v92, v93
  v_add_f32 v6, v94, v95
  v_cvt_pk_bf16_f32 v92, v92, v93
  v_cvt_pk_bf16_f32 v93, v94, v95
  v_add_f32 v5, v5, v6
  ds_write_b64 v3, v[92:93] offset:11264
  v_add_f32 v11, v11, v5
  s_add_u32 m0, s36, 147456
  s_add_u32 s32, s77, 114816
  buffer_load_dwordx4 v12, s[16:19], s32 offen  lds
  s_add_u32 m0, s36, 151552
  s_add_u32 s32, s77, 143488
  buffer_load_dwordx4 v12, s[16:19], s32 offen  lds
  s_add_u32 m0, s36, 155648
  s_add_u32 s32, s77, 172160
  buffer_load_dwordx4 v12, s[16:19], s32 offen  lds
  s_add_u32 m0, s36, 159744
  s_add_u32 s32, s77, 200832
  buffer_load_dwordx4 v12, s[16:19], s32 offen  lds
  s_add_u32 m0, s36, 49152
  s_add_u32 s32, s77, 115072
  buffer_load_dwordx4 v12, s[16:19], s32 offen  lds
  s_add_u32 m0, s36, 53248
  s_add_u32 s32, s77, 143744
  buffer_load_dwordx4 v12, s[16:19], s32 offen  lds
  s_add_u32 m0, s36, 57344
  s_add_u32 s32, s77, 172416
  buffer_load_dwordx4 v12, s[16:19], s32 offen  lds
  s_add_u32 m0, s36, 61440
  s_add_u32 s32, s77, 201088
  buffer_load_dwordx4 v12, s[16:19], s32 offen  lds
  s_waitcnt lgkmcnt(0)
  s_barrier
  s_setprio 0
  v_mov_b32 v24, v7
  v_mov_b32 v25, v8
  v_mov_b32 v26, v9
  v_mov_b32 v27, v10
  v_mov_b32 v28, v11
  v_permlane32_swap_b32 v24, v7
  v_permlane32_swap_b32 v25, v8
  v_permlane32_swap_b32 v26, v9
  v_permlane32_swap_b32 v27, v10
  v_permlane32_swap_b32 v28, v11
  v_add_f32 v7, v7, v24
  v_mov_b32 v24, v7
  v_add_f32 v8, v8, v25
  v_mov_b32 v25, v8
  v_add_f32 v9, v9, v26
  v_mov_b32 v26, v9
  v_add_f32 v10, v10, v27
  v_mov_b32 v27, v10
  v_add_f32 v11, v11, v28
  v_mov_b32 v28, v11
  v_permlane16_swap_b32 v24, v7
  v_permlane16_swap_b32 v25, v8
  v_permlane16_swap_b32 v26, v9
  v_permlane16_swap_b32 v27, v10
  v_permlane16_swap_b32 v28, v11
  v_add_u32 v5, 4294848512, v4
  v_subrev_u32 v6, 147456, v4
  v_lshrrev_b32 v6, 3, v6
  v_lshlrev_b32 v6, 2, v6
  v_add_u32 v6, 29952, v6
  v_add_f32 v7, v7, v24
  ds_write_b32 v5, v7 offset:0
  ds_write_b32 v6, v36 offset:0
  v_add_f32 v8, v8, v25
  ds_write_b32 v5, v8 offset:128
  ds_write_b32 v6, v40 offset:64
  v_add_f32 v9, v9, v26
  ds_write_b32 v5, v9 offset:256
  ds_write_b32 v6, v44 offset:128
  v_add_f32 v10, v10, v27
  ds_write_b32 v5, v10 offset:384
  ds_write_b32 v6, v48 offset:192
  v_add_f32 v11, v11, v28
  ds_write_b32 v5, v11 offset:512
  ds_write_b32 v6, v52 offset:256
  v_and_b32 v17, 15, v0
  v_lshlrev_b32 v17, 4, v17
  s_add_u32 s34, s64, 71680
  s_lshl_b32 s33, s45, 3
  s_add_u32 s33, s33, s34
  s_cmp_eq_u32 s44, 0
  s_cbranch_scc1 L_nost
  v_mov_b32 v37, v7
  v_mov_b32 v41, v8
  v_mov_b32 v45, v9
  v_mov_b32 v49, v10
  v_mov_b32 v53, v11
  buffer_store_dwordx2 v[36:37], v17, s[20:23], s33 offen offset:0
  buffer_store_dwordx2 v[40:41], v17, s[20:23], s33 offen offset:256
  buffer_store_dwordx2 v[44:45], v17, s[20:23], s33 offen offset:512
  buffer_store_dwordx2 v[48:49], v17, s[20:23], s33 offen offset:768
  buffer_store_dwordx2 v[52:53], v17, s[20:23], s33 offen offset:1024
L_nost:
  s_add_u32 m0, s36, 65536
  s_add_u32 s32, s76, 256
  buffer_load_dwordx4 v12, s[16:19], s32 offen  lds
  s_add_u32 m0, s36, 69632
  s_add_u32 s32, s76, 28928
  buffer_load_dwordx4 v12, s[16:19], s32 offen  lds
  s_add_u32 m0, s36, 73728
  s_add_u32 s32, s76, 57600
  buffer_load_dwordx4 v12, s[16:19], s32 offen  lds
  s_add_u32 m0, s36, 77824
  s_add_u32 s32, s76, 86272
  buffer_load_dwordx4 v12, s[16:19], s32 offen  lds
  s_waitcnt lgkmcnt(0)
  s_barrier
  v_lshlrev_b32 v17, 3, v0
  v_min_u32 v18, 31, v0
  v_lshlrev_b32 v18, 3, v18
  v_add_u32 v17, 28672, v17
  v_add_u32 v18, 28672, v18
  ds_read_b64 v[76:77], v17
  ds_read_b64 v[82:83], v17 offset:512
  ds_read_b64 v[78:79], v18 offset:1024
  v_mov_b32 v17, 30976
  ds_read_b32 v80, v17
  s_waitcnt lgkmcnt(0)
  v_readfirstlane_b32 s67, v80
  v_add_f32 v76, v76, v77
  v_add_f32 v82, v82, v83
  v_add_f32 v78, v78, v79
  v_cmp_ge_f32 s[50:51], s48, v76
  v_cmp_ge_f32 s[52:53], s48, v82
  v_cmp_ge_f32 s[54:55], s48, v78
  s_nop 0
  s_and_b64 s[50:51], s[50:51], s[52:53]
  s_and_b64 s[50:51], s[50:51], s[54:55]
  s_cmp_eq_u64 s[50:51], -1
  s_cbranch_scc1 L_S_ok
  s_cmp_eq_u32 s31, 0
  s_cbranch_scc1 L_S_fallback
L_S_ok:
  s_lshl_b32 s32, s24, 6
  v_add_u32 v23, s32, v0
  v_and_b32 v16, 15, v0
  v_lshrrev_b32 v17, 4, v0
  v_lshrrev_b32 v18, 2, v16
  v_lshl_add_u32 v20, v17, 3, v18
  v_lshlrev_b32 v20, 7, v20
  v_and_b32 v21, 3, v0
  v_lshl_add_u32 v20, v21, 3, v20
  v_lshrrev_b32 v18, 1, v18
  v_and_b32 v21, 1, v17
  v_lshl_add_u32 v18, v21, 1, v18
  v_xor_b32 v18, s46, v18
  v_lshl_add_u32 v1, v18, 5, v20
  v_add_u32 v2, 0x10000, v1
  v_add_u32 v3, 0x20000, v1
  s_lshl_b32 s33, s46, 9
  s_cmp_eq_u32 s67, 1
  s_cselect_b32 s50, s65, s43
  s_add_u32 s50, s50, s33
  s_lshl_b32 s33, s27, 11
  s_add_u32 s51, s50, s33
  s_sub_u32 s52, s50, s33
  v_lshrrev_b32 v18, 1, v17
  v_lshlrev_b32 v18, 8, v18
  v_lshl_add_u32 v18, v16, 4, v18
  v_mul_u32_u24 v22, 14336, v21
  v_xor_b32 v13, 64, v19
  v_add_u32 v14, v22, v18
  v_lshl_add_u32 v15, v21, 3, v18
  s_waitcnt vmcnt(0) lgkmcnt(0)
  s_barrier
  ds_read_b64_tr_b16 v[128:129], v2 offset:32768
  ds_read_b64_tr_b16 v[130:131], v2 offset:33280
  ds_read_b64_tr_b16 v[132:133], v2 offset:36864
  ds_read_b64_tr_b16 v[134:135], v2 offset:37376
  ds_read_b64_tr_b16 v[136:137], v2 offset:40960
  ds_read_b64_tr_b16 v[138:139], v2 offset:41472
  ds_read_b64_tr_b16 v[140:141], v2 offset:45056
  ds_read_b64_tr_b16 v[142:143], v2 offset:45568
  ds_read_b64_tr_b16 v[144:145], v2 offset:49152
  ds_read_b64_tr_b16 v[146:147], v2 offset:49664
  ds_read_b64_tr_b16 v[148:149], v2 offset:53248
  ds_read_b64_tr_b16 v[150:151], v2 offset:53760
  ds_read_b64_tr_b16 v[152:153], v2 offset:57344
  ds_read_b64_tr_b16 v[154:155], v2 offset:57856
  ds_read_b64_tr_b16 v[156:157], v2 offset:61440
  ds_read_b64_tr_b16 v[158:159], v2 offset:61952
  ds_read_b64_tr_b16 v[160:161], v3 offset:0
  ds_read_b64_tr_b16 v[162:163], v3 offset:512
  ds_read_b64_tr_b16 v[164:165], v3 offset:4096
  ds_read_b64_tr_b16 v[166:167], v3 offset:4608
  ds_read_b64_tr_b16 v[168:169], v3 offset:8192
  ds_read_b64_tr_b16 v[170:171], v3 offset:8704
  ds_read_b64_tr_b16 v[172:173], v3 offset:12288
  ds_read_b64_tr_b16 v[174:175], v3 offset:12800
  ds_read_b64_tr_b16 v[176:177], v3 offset:16384
  ds_read_b64_tr_b16 v[178:179], v3 offset:16896
  ds_read_b64_tr_b16 v[180:181], v3 offset:20480
  ds_read_b64_tr_b16 v[182:183], v3 offset:20992
  ds_read_b64_tr_b16 v[184:185], v3 offset:24576
  ds_read_b64_tr_b16 v[186:187], v3 offset:25088
  ds_read_b64_tr_b16 v[188:189], v3 offset:28672
  ds_read_b64_tr_b16 v[190:191], v3 offset:29184
  ds_read_b64_tr_b16 v[224:225], v1 offset:32768
  ds_read_b64_tr_b16 v[226:227], v1 offset:33280
  ds_read_b64_tr_b16 v[228:229], v1 offset:36864
  ds_read_b64_tr_b16 v[230:231], v1 offset:37376
  ds_read_b64_tr_b16 v[232:233], v1 offset:40960
  ds_read_b64_tr_b16 v[234:235], v1 offset:41472
  ds_read_b64_tr_b16 v[236:237], v1 offset:45056
  ds_read_b64_tr_b16 v[238:239], v1 offset:45568
  ds_read_b64_tr_b16 v[240:241], v1 offset:49152
  ds_read_b64_tr_b16 v[242:243], v1 offset:49664
  ds_read_b64_tr_b16 v[244:245], v1 offset:53248
  ds_read_b64_tr_b16 v[246:247], v1 offset:53760
  ds_read_b64_tr_b16 v[248:249], v1 offset:57344
  ds_read_b64_tr_b16 v[250:251], v1 offset:57856
  ds_read_b64_tr_b16 v[252:253], v1 offset:61440
  ds_read_b64_tr_b16 v[254:255], v1 offset:61952
  s_waitcnt lgkmcnt(0)
  s_barrier
  ds_read_b64_tr_b16 v[192:193], v2 offset:0
  ds_read_b64_tr_b16 v[194:195], v2 offset:512
  ds_read_b64_tr_b16 v[196:197], v2 offset:4096
  ds_read_b64_tr_b16 v[198:199], v2 offset:4608
  ds_read_b64_tr_b16 v[200:201], v2 offset:8192
  ds_read_b64_tr_b16 v[202:203], v2 offset:8704
  ds_read_b64_tr_b16 v[204:205], v2 offset:12288
  ds_read_b64_tr_b16 v[206:207], v2 offset:12800
  ds_read_b64_tr_b16 v[208:209], v2 offset:16384
  ds_read_b64_tr_b16 v[210:211], v2 offset:16896
  ds_read_b64_tr_b16 v[212:213], v2 offset:20480
  ds_read_b64_tr_b16 v[214:215], v2 offset:20992
  ds_read_b64_tr_b16 v[216:217], v2 offset:24576
  ds_read_b64_tr_b16 v[218:219], v2 offset:25088
  ds_read_b64_tr_b16 v[220:221], v2 offset:28672
  ds_read_b64_tr_b16 v[222:223], v2 offset:29184
  s_waitcnt lgkmcnt(0)
  s_barrier
  s_add_u32 m0, s36, 98304
  s_add_u32 s32, s76, 512
  buffer_load_dwordx4 v12, s[16:19], s32 offen  lds
  s_add_u32 m0, s36, 102400
  s_add_u32 s32, s76, 29184
  buffer_load_dwordx4 v12, s[16:19], s32 offen  lds
  s_add_u32 m0, s36, 106496
  s_add_u32 s32, s76, 57856
  buffer_load_dwordx4 v12, s[16:19], s32 offen  lds
  s_add_u32 m0, s36, 110592
  s_add_u32 s32, s76, 86528
  buffer_load_dwordx4 v12, s[16:19], s32 offen  lds
  s_add_u32 m0, s36, 114688
  s_add_u32 s32, s76, 115200
  buffer_load_dwordx4 v12, s[16:19], s32 offen  lds
  s_add_u32 m0, s36, 118784
  s_add_u32 s32, s76, 143872
  buffer_load_dwordx4 v12, s[16:19], s32 offen  lds
  s_add_u32 m0, s36, 122880
  s_add_u32 s32, s76, 172544
  buffer_load_dwordx4 v12, s[16:19], s32 offen  lds
  s_add_u32 m0, s36, 126976
  s_add_u32 s32, s76, 201216
  buffer_load_dwordx4 v12, s[16:19], s32 offen  lds
  s_add_u32 m0, s36, 131072
  s_add_u32 s32, s77, 640
  buffer_load_dwordx4 v12, s[16:19], s32 offen  lds
  s_add_u32 m0, s36, 135168
  s_add_u32 s32, s77, 29312
  buffer_load_dwordx4 v12, s[16:19], s32 offen  lds
  s_add_u32 m0, s36, 139264
  s_add_u32 s32, s77, 57984
  buffer_load_dwordx4 v12, s[16:19], s32 offen  lds
  s_add_u32 m0, s36, 143360
  s_add_u32 s32, s77, 86656
  buffer_load_dwordx4 v12, s[16:19], s32 offen  lds
  s_add_u32 m0, s36, 147456
  s_add_u32 s32, s77, 115328
  buffer_load_dwordx4 v12, s[16:19], s32 offen  lds
  s_add_u32 m0, s36, 151552
  s_add_u32 s32, s77, 144000
  buffer_load_dwordx4 v12, s[16:19], s32 offen  lds
  s_add_u32 m0, s36, 155648
  s_add_u32 s32, s77, 172672
  buffer_load_dwordx4 v12, s[16:19], s32 offen  lds
  s_add_u32 m0, s36, 159744
  s_add_u32 s32, s77, 201344
  buffer_load_dwordx4 v12, s[16:19], s32 offen  lds
  v_lshlrev_b32 v17, 4, v0
  s_add_u32 s34, s65, s36
  s_waitcnt vmcnt(8)
  s_barrier
  ds_read_b128 v[24:27], v19 offset:0
  ds_read_b128 v[28:31], v19 offset:8192
  ds_read_b128 v[32:35], v19 offset:16384
  ds_read_b128 v[36:39], v19 offset:24576
  ds_read_b128 v[40:43], v19 offset:32768
  s_waitcnt lgkmcnt(4)
  v_mfma_f32_16x16x32_bf16 v[48:51], v[128:131], v[24:27], 0
  ds_read_b128 v[44:47], v13 offset:0
  v_mfma_f32_16x16x32_bf16 v[68:71], v[160:163], v[24:27], 0
  s_add_u32 m0, s36, 65536
  s_add_u32 s32, s42, 768
  buffer_load_dwordx4 v12, s[16:19], s32 offen  lds
  s_waitcnt lgkmcnt(4)
  v_mfma_f32_16x16x32_bf16 v[52:55], v[128:131], v[28:31], 0
  ds_read_b128 v[24:27], v13 offset:8192
  v_mfma_f32_16x16x32_bf16 v[72:75], v[160:163], v[28:31], 0
  s_waitcnt lgkmcnt(4)
  v_mfma_f32_16x16x32_bf16 v[56:59], v[128:131], v[32:35], 0
  ds_read_b128 v[28:31], v13 offset:16384
  v_mfma_f32_16x16x32_bf16 v[76:79], v[160:163], v[32:35], 0
  s_add_u32 m0, s36, 69632
  s_add_u32 s32, s42, 29440
  buffer_load_dwordx4 v12, s[16:19], s32 offen  lds
  s_waitcnt lgkmcnt(4)
  v_mfma_f32_16x16x32_bf16 v[60:63], v[128:131], v[36:39], 0
  ds_read_b128 v[32:35], v13 offset:24576
  v_mfma_f32_16x16x32_bf16 v[80:83], v[160:163], v[36:39], 0
  s_waitcnt lgkmcnt(4)
  v_mfma_f32_16x16x32_bf16 v[64:67], v[128:131], v[40:43], 0
  ds_read_b128 v[36:39], v13 offset:32768
  v_mfma_f32_16x16x32_bf16 v[84:87], v[160:163], v[40:43], 0
  s_add_u32 m0, s36, 73728
  s_add_u32 s32, s42, 58112
  buffer_load_dwordx4 v12, s[16:19], s32 offen  lds
  s_waitcnt lgkmcnt(4)
  v_mfma_f32_16x16x32_bf16 v[48:51], v[132:135], v[44:47], v[48:51]
  ds_read_b128 v[40:43], v19 offset:2048
  v_mfma_f32_16x16x32_bf16 v[68:71], v[164:167], v[44:47], v[68:71]
  s_waitcnt lgkmcnt(4)
  v_mfma_f32_16x16x32_bf16 v[52:55], v[132:135], v[24:27], v[52:55]
  ds_read_b128 v[44:47], v19 offset:10240
  v_mfma_f32_16x16x32_bf16 v[72:75], v[164:167], v[24:27], v[72:75]
  s_add_u32 m0, s36, 77824
  s_add_u32 s32, s42, 86784
  buffer_load_dwordx4 v12, s[16:19], s32 offen  lds
  s_waitcnt lgkmcnt(4)
  v_mfma_f32_16x16x32_bf16 v[56:59], v[132:135], v[28:31], v[56:59]
  ds_read_b128 v[24:27], v19 offset:18432
  v_mfma_f32_16x16x32_bf16 v[76:79], v[164:167], v[28:31], v[76:79]
  s_waitcnt lgkmcnt(4)
  v_mfma_f32_16x16x32_bf16 v[60:63], v[132:135], v[32:35], v[60:63]
  ds_read_b128 v[28:31], v19 offset:26624
  v_mfma_f32_16x16x32_bf16 v[80:83], v[164:167], v[32:35], v[80:83]
  s_add_u32 m0, s36, 81920
  s_add_u32 s32, s42, 115456
  buffer_load_dwordx4 v12, s[16:19], s32 offen  lds
  s_waitcnt lgkmcnt(4)
  v_mfma_f32_16x16x32_bf16 v[64:67], v[132:135], v[36:39], v[64:67]
  ds_read_b128 v[32:35], v19 offset:34816
  v_mfma_f32_16x16x32_bf16 v[84:87], v[164:167], v[36:39], v[84:87]
  s_waitcnt lgkmcnt(4)
  v_mfma_f32_16x16x32_bf16 v[48:51], v[136:139], v[40:43], v[48:51]
  ds_read_b128 v[36:39], v13 offset:2048
  v_mfma_f32_16x16x32_bf16 v[68:71], v[168:171], v[40:43], v[68:71]
  s_add_u32 m0, s36, 86016
  s_add_u32 s32, s42, 144128
  buffer_load_dwordx4 v12, s[16:19], s32 offen  lds
  s_waitcnt lgkmcnt(4)
  v_mfma_f32_16x16x32_bf16 v[52:55], v[136:139], v[44:47], v[52:55]
  ds_read_b128 v[40:43], v13 offset:10240
  v_mfma_f32_16x16x32_bf16 v[72:75], v[168:171], v[44:47], v[72:75]
  s_waitcnt lgkmcnt(4)
  v_mfma_f32_16x16x32_bf16 v[56:59], v[136:139], v[24:27], v[56:59]
  ds_read_b128 v[44:47], v13 offset:18432
  v_mfma_f32_16x16x32_bf16 v[76:79], v[168:171], v[24:27], v[76:79]
  s_add_u32 m0, s36, 90112
  s_add_u32 s32, s42, 172800
  buffer_load_dwordx4 v12, s[16:19], s32 offen  lds
  s_waitcnt lgkmcnt(4)
  v_mfma_f32_16x16x32_bf16 v[60:63], v[136:139], v[28:31], v[60:63]
  ds_read_b128 v[24:27], v13 offset:26624
  v_mfma_f32_16x16x32_bf16 v[80:83], v[168:171], v[28:31], v[80:83]
  s_waitcnt lgkmcnt(4)
  v_mfma_f32_16x16x32_bf16 v[64:67], v[136:139], v[32:35], v[64:67]
  ds_read_b128 v[28:31], v13 offset:34816
  v_mfma_f32_16x16x32_bf16 v[84:87], v[168:171], v[32:35], v[84:87]
  s_add_u32 m0, s36, 94208
  s_add_u32 s32, s42, 201472
  buffer_load_dwordx4 v12, s[16:19], s32 offen  lds
  s_waitcnt lgkmcnt(4)
  v_mfma_f32_16x16x32_bf16 v[48:51], v[140:143], v[36:39], v[48:51]
  ds_read_b128 v[32:35], v19 offset:4096
  v_mfma_f32_16x16x32_bf16 v[68:71], v[172:175], v[36:39], v[68:71]
  s_waitcnt lgkmcnt(4)
  v_mfma_f32_16x16x32_bf16 v[52:55], v[140:143], v[40:43], v[52:55]
  ds_read_b128 v[36:39], v19 offset:12288
  v_mfma_f32_16x16x32_bf16 v[72:75], v[172:175], v[40:43], v[72:75]
  s_add_u32 s33, s34, 40960
  buffer_load_dwordx4 v[8:11], v17, s[20:23], s33 offen sc1
  s_waitcnt lgkmcnt(4)
  v_mfma_f32_16x16x32_bf16 v[56:59], v[140:143], v[44:47], v[56:59]
  ds_read_b128 v[40:43], v19 offset:20480
  v_mfma_f32_16x16x32_bf16 v[76:79], v[172:175], v[44:47], v[76:79]
  s_waitcnt lgkmcnt(4)
  v_mfma_f32_16x16x32_bf16 v[60:63], v[140:143], v[24:27], v[60:63]
  ds_read_b128 v[44:47], v19 offset:28672
  v_mfma_f32_16x16x32_bf16 v[80:83], v[172:175], v[24:27], v[80:83]
  s_add_u32 s33, s34, 45056
  buffer_load_dwordx4 v[8:11], v17, s[20:23], s33 offen sc1
  s_waitcnt lgkmcnt(4)
  v_mfma_f32_16x16x32_bf16 v[64:67], v[140:143], v[28:31], v[64:67]
  ds_read_b128 v[24:27], v19 offset:36864
  v_mfma_f32_16x16x32_bf16 v[84:87], v[172:175], v[28:31], v[84:87]
  s_waitcnt lgkmcnt(4)
  v_mfma_f32_16x16x32_bf16 v[48:51], v[144:147], v[32:35], v[48:51]
  ds_read_b128 v[28:31], v13 offset:4096
  v_mfma_f32_16x16x32_bf16 v[68:71], v[176:179], v[32:35], v[68:71]
  s_add_u32 s33, s34, 49152
  buffer_load_dwordx4 v[8:11], v17, s[20:23], s33 offen sc1
  s_waitcnt lgkmcnt(4)
  v_mfma_f32_16x16x32_bf16 v[52:55], v[144:147], v[36:39], v[52:55]
  ds_read_b128 v[32:35], v13 offset:12288
  v_mfma_f32_16x16x32_bf16 v[72:75], v[176:179], v[36:39], v[72:75]
  s_waitcnt lgkmcnt(4)
  v_mfma_f32_16x16x32_bf16 v[56:59], v[144:147], v[40:43], v[56:59]
  ds_read_b128 v[36:39], v13 offset:20480
  v_mfma_f32_16x16x32_bf16 v[76:79], v[176:179], v[40:43], v[76:79]
  s_add_u32 s33, s34, 53248
  buffer_load_dwordx4 v[8:11], v17, s[20:23], s33 offen sc1
  s_waitcnt lgkmcnt(4)
  v_mfma_f32_16x16x32_bf16 v[60:63], v[144:147], v[44:47], v[60:63]
  ds_read_b128 v[40:43], v13 offset:28672
  v_mfma_f32_16x16x32_bf16 v[80:83], v[176:179], v[44:47], v[80:83]
  s_waitcnt lgkmcnt(4)
  v_mfma_f32_16x16x32_bf16 v[64:67], v[144:147], v[24:27], v[64:67]
  ds_read_b128 v[44:47], v13 offset:36864
  v_mfma_f32_16x16x32_bf16 v[84:87], v[176:179], v[24:27], v[84:87]
  s_add_u32 s33, s34, 57344
  buffer_load_dwordx4 v[8:11], v17, s[20:23], s33 offen sc1
  s_waitcnt lgkmcnt(4)
  v_mfma_f32_16x16x32_bf16 v[48:51], v[148:151], v[28:31], v[48:51]
  ds_read_b128 v[24:27], v19 offset:6144
  v_mfma_f32_16x16x32_bf16 v[68:71], v[180:183], v[28:31], v[68:71]
  s_waitcnt lgkmcnt(4)
  v_mfma_f32_16x16x32_bf16 v[52:55], v[148:151], v[32:35], v[52:55]
  ds_read_b128 v[28:31], v19 offset:14336
  v_mfma_f32_16x16x32_bf16 v[72:75], v[180:183], v[32:35], v[72:75]
  s_add_u32 s33, s34, 61440
  buffer_load_dwordx4 v[8:11], v17, s[20:23], s33 offen sc1
  s_waitcnt lgkmcnt(4)
  v_mfma_f32_16x16x32_bf16 v[56:59], v[148:151], v[36:39], v[56:59]
  ds_read_b128 v[32:35], v19 offset:22528
  v_mfma_f32_16x16x32_bf16 v[76:79], v[180:183], v[36:39], v[76:79]
  s_waitcnt lgkmcnt(4)
  v_mfma_f32_16x16x32_bf16 v[60:63], v[148:151], v[40:43], v[60:63]
  ds_read_b128 v[36:39], v19 offset:30720
  v_mfma_f32_16x16x32_bf16 v[80:83], v[180:183], v[40:43], v[80:83]
  s_add_u32 s33, s34, 65536
  buffer_load_dwordx4 v[8:11], v17, s[20:23], s33 offen sc1
  s_waitcnt lgkmcnt(4)
  v_mfma_f32_16x16x32_bf16 v[64:67], v[148:151], v[44:47], v[64:67]
  ds_read_b128 v[40:43], v19 offset:38912
  v_mfma_f32_16x16x32_bf16 v[84:87], v[180:183], v[44:47], v[84:87]
  s_waitcnt lgkmcnt(4)
  v_mfma_f32_16x16x32_bf16 v[48:51], v[152:155], v[24:27], v[48:51]
  ds_read_b128 v[44:47], v13 offset:6144
  v_mfma_f32_16x16x32_bf16 v[68:71], v[184:187], v[24:27], v[68:71]
  s_add_u32 s33, s34, 69632
  buffer_load_dwordx4 v[8:11], v17, s[20:23], s33 offen sc1
  s_waitcnt lgkmcnt(4)
  v_mfma_f32_16x16x32_bf16 v[52:55], v[152:155], v[28:31], v[52:55]
  ds_read_b128 v[24:27], v13 offset:14336
  v_mfma_f32_16x16x32_bf16 v[72:75], v[184:187], v[28:31], v[72:75]
  s_waitcnt vmcnt(8)
  s_barrier
  s_waitcnt lgkmcnt(4)
  v_mfma_f32_16x16x32_bf16 v[56:59], v[152:155], v[32:35], v[56:59]
  ds_read_b128 v[28:31], v13 offset:22528
  v_mfma_f32_16x16x32_bf16 v[76:79], v[184:187], v[32:35], v[76:79]
  s_waitcnt lgkmcnt(4)
  v_mfma_f32_16x16x32_bf16 v[60:63], v[152:155], v[36:39], v[60:63]
  ds_read_b128 v[32:35], v13 offset:30720
  v_mfma_f32_16x16x32_bf16 v[80:83], v[184:187], v[36:39], v[80:83]
  s_waitcnt lgkmcnt(4)
  v_mfma_f32_16x16x32_bf16 v[64:67], v[152:155], v[40:43], v[64:67]
  ds_read_b128 v[36:39], v13 offset:38912
  v_mfma_f32_16x16x32_bf16 v[84:87], v[184:187], v[40:43], v[84:87]
  s_waitcnt lgkmcnt(4)
  v_mfma_f32_16x16x32_bf16 v[48:51], v[156:159], v[44:47], v[48:51]
  ds_read_b128 v[40:43], v19 offset:0
  v_mfma_f32_16x16x32_bf16 v[68:71], v[188:191], v[44:47], v[68:71]
  s_waitcnt lgkmcnt(4)
  v_mfma_f32_16x16x32_bf16 v[52:55], v[156:159], v[24:27], v[52:55]
  ds_read_b128 v[44:47], v19 offset:8192
  v_mfma_f32_16x16x32_bf16 v[72:75], v[188:191], v[24:27], v[72:75]
  s_waitcnt lgkmcnt(4)
  v_mfma_f32_16x16x32_bf16 v[56:59], v[156:159], v[28:31], v[56:59]
  ds_read_b128 v[24:27], v19 offset:16384
  v_mfma_f32_16x16x32_bf16 v[76:79], v[188:191], v[28:31], v[76:79]
  s_waitcnt lgkmcnt(4)
  v_mfma_f32_16x16x32_bf16 v[60:63], v[156:159], v[32:35], v[60:63]
  ds_read_b128 v[28:31], v19 offset:24576
  v_mfma_f32_16x16x32_bf16 v[80:83], v[188:191], v[32:35], v[80:83]
  s_waitcnt lgkmcnt(4)
  v_mfma_f32_16x16x32_bf16 v[64:67], v[156:159], v[36:39], v[64:67]
  ds_read_b128 v[32:35], v19 offset:32768
  v_mfma_f32_16x16x32_bf16 v[84:87], v[188:191], v[36:39], v[84:87]
  s_waitcnt lgkmcnt(4)
  v_mfma_f32_16x16x32_bf16 v[88:91], v[192:195], v[40:43], 0
  ds_read_b128 v[36:39], v13 offset:0
  v_mfma_f32_16x16x32_bf16 v[108:111], v[224:227], v[40:43], 0
  s_waitcnt lgkmcnt(4)
  v_mfma_f32_16x16x32_bf16 v[92:95], v[192:195], v[44:47], 0
  ds_read_b128 v[40:43], v13 offset:8192
  v_mfma_f32_16x16x32_bf16 v[112:115], v[224:227], v[44:47], 0
  s_waitcnt lgkmcnt(4)
  v_mfma_f32_16x16x32_bf16 v[96:99], v[192:195], v[24:27], 0
  ds_read_b128 v[44:47], v13 offset:16384
  v_mfma_f32_16x16x32_bf16 v[116:119], v[224:227], v[24:27], 0
  v_cvt_pk_bf16_f32 v48, v48, v49
  v_cvt_pk_bf16_f32 v49, v50, v51
  s_waitcnt lgkmcnt(4)
  v_mfma_f32_16x16x32_bf16 v[100:103], v[192:195], v[28:31], 0
  ds_read_b128 v[24:27], v13 offset:24576
  v_mfma_f32_16x16x32_bf16 v[120:123], v[224:227], v[28:31], 0
  v_cvt_pk_bf16_f32 v50, v52, v53
  v_cvt_pk_bf16_f32 v51, v54, v55
  s_waitcnt lgkmcnt(4)
  v_mfma_f32_16x16x32_bf16 v[104:107], v[192:195], v[32:35], 0
  ds_read_b128 v[28:31], v13 offset:32768
  v_mfma_f32_16x16x32_bf16 v[124:127], v[224:227], v[32:35], 0
  s_add_u32 s33, s51, 0
  s_waitcnt lgkmcnt(4)
  v_mfma_f32_16x16x32_bf16 v[88:91], v[196:199], v[36:39], v[88:91]
  ds_read_b128 v[32:35], v19 offset:2048
  v_mfma_f32_16x16x32_bf16 v[108:111], v[228:231], v[36:39], v[108:111]
  v_permlane16_swap_b32 v48, v50
  v_permlane16_swap_b32 v49, v51
  s_waitcnt lgkmcnt(4)
  v_mfma_f32_16x16x32_bf16 v[92:95], v[196:199], v[40:43], v[92:95]
  ds_read_b128 v[36:39], v19 offset:10240
  v_mfma_f32_16x16x32_bf16 v[112:115], v[228:231], v[40:43], v[112:115]
  buffer_store_dwordx4 v[48:51], v14, s[20:23], s33 offen
  s_waitcnt lgkmcnt(4)
  v_mfma_f32_16x16x32_bf16 v[96:99], v[196:199], v[44:47], v[96:99]
  ds_read_b128 v[40:43], v19 offset:18432
  v_mfma_f32_16x16x32_bf16 v[116:119], v[228:231], v[44:47], v[116:119]
  v_cvt_pk_bf16_f32 v56, v56, v57
  v_cvt_pk_bf16_f32 v57, v58, v59
  s_waitcnt lgkmcnt(4)
  v_mfma_f32_16x16x32_bf16 v[100:103], v[196:199], v[24:27], v[100:103]
  ds_read_b128 v[44:47], v19 offset:26624
  v_mfma_f32_16x16x32_bf16 v[120:123], v[228:231], v[24:27], v[120:123]
  v_cvt_pk_bf16_f32 v58, v60, v61
  v_cvt_pk_bf16_f32 v59, v62, v63
  s_waitcnt lgkmcnt(4)
  v_mfma_f32_16x16x32_bf16 v[104:107], v[196:199], v[28:31], v[104:107]
  ds_read_b128 v[24:27], v19 offset:34816
  v_mfma_f32_16x16x32_bf16 v[124:127], v[228:231], v[28:31], v[124:127]
  s_add_u32 s33, s51, 28672
  s_waitcnt lgkmcnt(4)
  v_mfma_f32_16x16x32_bf16 v[88:91], v[200:203], v[32:35], v[88:91]
  ds_read_b128 v[28:31], v13 offset:2048
  v_mfma_f32_16x16x32_bf16 v[108:111], v[232:235], v[32:35], v[108:111]
  v_permlane16_swap_b32 v56, v58
  v_permlane16_swap_b32 v57, v59
  s_waitcnt lgkmcnt(4)
  v_mfma_f32_16x16x32_bf16 v[92:95], v[200:203], v[36:39], v[92:95]
  ds_read_b128 v[32:35], v13 offset:10240
  v_mfma_f32_16x16x32_bf16 v[112:115], v[232:235], v[36:39], v[112:115]
  buffer_store_dwordx4 v[56:59], v14, s[20:23], s33 offen
  s_waitcnt lgkmcnt(4)
  v_mfma_f32_16x16x32_bf16 v[96:99], v[200:203], v[40:43], v[96:99]
  ds_read_b128 v[36:39], v13 offset:18432
  v_mfma_f32_16x16x32_bf16 v[116:119], v[232:235], v[40:43], v[116:119]
  v_cvt_pk_bf16_f32 v64, v64, v65
  v_cvt_pk_bf16_f32 v65, v66, v67
  s_waitcnt lgkmcnt(4)
  v_mfma_f32_16x16x32_bf16 v[100:103], v[200:203], v[44:47], v[100:103]
  ds_read_b128 v[40:43], v13 offset:26624
  v_mfma_f32_16x16x32_bf16 v[120:123], v[232:235], v[44:47], v[120:123]
  s_add_u32 s33, s51, 57344
  buffer_store_dwordx2 v[64:65], v15, s[20:23], s33 offen
  s_waitcnt lgkmcnt(4)
  v_mfma_f32_16x16x32_bf16 v[104:107], v[200:203], v[24:27], v[104:107]
  ds_read_b128 v[44:47], v13 offset:34816
  v_mfma_f32_16x16x32_bf16 v[124:127], v[232:235], v[24:27], v[124:127]
  v_cvt_pk_bf16_f32 v68, v68, v69
  v_cvt_pk_bf16_f32 v69, v70, v71
  s_waitcnt lgkmcnt(4)
  v_mfma_f32_16x16x32_bf16 v[88:91], v[204:207], v[28:31], v[88:91]
  ds_read_b128 v[24:27], v19 offset:4096
  v_mfma_f32_16x16x32_bf16 v[108:111], v[236:239], v[28:31], v[108:111]
  v_cvt_pk_bf16_f32 v70, v72, v73
  v_cvt_pk_bf16_f32 v71, v74, v75
  s_waitcnt lgkmcnt(4)
  v_mfma_f32_16x16x32_bf16 v[92:95], v[204:207], v[32:35], v[92:95]
  ds_read_b128 v[28:31], v19 offset:12288
  v_mfma_f32_16x16x32_bf16 v[112:115], v[236:239], v[32:35], v[112:115]
  s_add_u32 s33, s52, 2048
  s_waitcnt lgkmcnt(4)
  v_mfma_f32_16x16x32_bf16 v[96:99], v[204:207], v[36:39], v[96:99]
  ds_read_b128 v[32:35], v19 offset:20480
  v_mfma_f32_16x16x32_bf16 v[116:119], v[236:239], v[36:39], v[116:119]
  v_permlane16_swap_b32 v68, v70
  v_permlane16_swap_b32 v69, v71
  s_waitcnt lgkmcnt(4)
  v_mfma_f32_16x16x32_bf16 v[100:103], v[204:207], v[40:43], v[100:103]
  ds_read_b128 v[36:39], v19 offset:28672
  v_mfma_f32_16x16x32_bf16 v[120:123], v[236:239], v[40:43], v[120:123]
  buffer_store_dwordx4 v[68:71], v14, s[20:23], s33 offen
  s_waitcnt lgkmcnt(4)
  v_mfma_f32_16x16x32_bf16 v[104:107], v[204:207], v[44:47], v[104:107]
  ds_read_b128 v[40:43], v19 offset:36864
  v_mfma_f32_16x16x32_bf16 v[124:127], v[236:239], v[44:47], v[124:127]
  v_cvt_pk_bf16_f32 v76, v76, v77
  v_cvt_pk_bf16_f32 v77, v78, v79
  s_waitcnt lgkmcnt(4)
  v_mfma_f32_16x16x32_bf16 v[88:91], v[208:211], v[24:27], v[88:91]
  ds_read_b128 v[44:47], v13 offset:4096
  v_mfma_f32_16x16x32_bf16 v[108:111], v[240:243], v[24:27], v[108:111]
  v_cvt_pk_bf16_f32 v78, v80, v81
  v_cvt_pk_bf16_f32 v79, v82, v83
  s_waitcnt lgkmcnt(4)
  v_mfma_f32_16x16x32_bf16 v[92:95], v[208:211], v[28:31], v[92:95]
  ds_read_b128 v[24:27], v13 offset:12288
  v_mfma_f32_16x16x32_bf16 v[112:115], v[240:243], v[28:31], v[112:115]
  s_add_u32 s33, s52, 30720
  s_waitcnt lgkmcnt(4)
  v_mfma_f32_16x16x32_bf16 v[96:99], v[208:211], v[32:35], v[96:99]
  ds_read_b128 v[28:31], v13 offset:20480
  v_mfma_f32_16x16x32_bf16 v[116:119], v[240:243], v[32:35], v[116:119]
  v_permlane16_swap_b32 v76, v78
  v_permlane16_swap_b32 v77, v79
  s_waitcnt lgkmcnt(4)
  v_mfma_f32_16x16x32_bf16 v[100:103], v[208:211], v[36:39], v[100:103]
  ds_read_b128 v[32:35], v13 offset:28672
  v_mfma_f32_16x16x32_bf16 v[120:123], v[240:243], v[36:39], v[120:123]
  buffer_store_dwordx4 v[76:79], v14, s[20:23], s33 offen
  s_waitcnt lgkmcnt(4)
  v_mfma_f32_16x16x32_bf16 v[104:107], v[208:211], v[40:43], v[104:107]
  ds_read_b128 v[36:39], v13 offset:36864
  v_mfma_f32_16x16x32_bf16 v[124:127], v[240:243], v[40:43], v[124:127]
  v_cvt_pk_bf16_f32 v84, v84, v85
  v_cvt_pk_bf16_f32 v85, v86, v87
  s_waitcnt lgkmcnt(4)
  v_mfma_f32_16x16x32_bf16 v[88:91], v[212:215], v[44:47], v[88:91]
  ds_read_b128 v[40:43], v19 offset:6144
  v_mfma_f32_16x16x32_bf16 v[108:111], v[244:247], v[44:47], v[108:111]
  s_add_u32 s33, s52, 59392
  buffer_store_dwordx2 v[84:85], v15, s[20:23], s33 offen
  s_waitcnt lgkmcnt(4)
  v_mfma_f32_16x16x32_bf16 v[92:95], v[212:215], v[24:27], v[92:95]
  ds_read_b128 v[44:47], v19 offset:14336
  v_mfma_f32_16x16x32_bf16 v[112:115], v[244:247], v[24:27], v[112:115]
  s_waitcnt lgkmcnt(4)
  v_mfma_f32_16x16x32_bf16 v[96:99], v[212:215], v[28:31], v[96:99]
  ds_read_b128 v[24:27], v19 offset:22528
  v_mfma_f32_16x16x32_bf16 v[116:119], v[244:247], v[28:31], v[116:119]
  s_waitcnt lgkmcnt(4)
  v_mfma_f32_16x16x32_bf16 v[100:103], v[212:215], v[32:35], v[100:103]
  ds_read_b128 v[28:31], v19 offset:30720
  v_mfma_f32_16x16x32_bf16 v[120:123], v[244:247], v[32:35], v[120:123]
  s_waitcnt lgkmcnt(4)
  v_mfma_f32_16x16x32_bf16 v[104:107], v[212:215], v[36:39], v[104:107]
  ds_read_b128 v[32:35], v19 offset:38912
  v_mfma_f32_16x16x32_bf16 v[124:127], v[244:247], v[36:39], v[124:127]
  s_waitcnt lgkmcnt(4)
  v_mfma_f32_16x16x32_bf16 v[88:91], v[216:219], v[40:43], v[88:91]
  ds_read_b128 v[36:39], v13 offset:6144
  v_mfma_f32_16x16x32_bf16 v[108:111], v[248:251], v[40:43], v[108:111]
  s_waitcnt lgkmcnt(4)
  v_mfma_f32_16x16x32_bf16 v[92:95], v[216:219], v[44:47], v[92:95]
  ds_read_b128 v[40:43], v13 offset:14336
  v_mfma_f32_16x16x32_bf16 v[112:115], v[248:251], v[44:47], v[112:115]
  s_waitcnt lgkmcnt(4)
  v_mfma_f32_16x16x32_bf16 v[96:99], v[216:219], v[24:27], v[96:99]
  ds_read_b128 v[44:47], v13 offset:22528
  v_mfma_f32_16x16x32_bf16 v[116:119], v[248:251], v[24:27], v[116:119]
  s_waitcnt lgkmcnt(4)
  v_mfma_f32_16x16x32_bf16 v[100:103], v[216:219], v[28:31], v[100:103]
  ds_read_b128 v[24:27], v13 offset:30720
  v_mfma_f32_16x16x32_bf16 v[120:123], v[248:251], v[28:31], v[120:123]
  s_waitcnt lgkmcnt(4)
  v_mfma_f32_16x16x32_bf16 v[104:107], v[216:219], v[32:35], v[104:107]
  ds_read_b128 v[28:31], v13 offset:38912
  v_mfma_f32_16x16x32_bf16 v[124:127], v[248:251], v[32:35], v[124:127]
  s_waitcnt lgkmcnt(4)
  v_mfma_f32_16x16x32_bf16 v[88:91], v[220:223], v[36:39], v[88:91]
  v_mfma_f32_16x16x32_bf16 v[108:111], v[252:255], v[36:39], v[108:111]
  s_waitcnt lgkmcnt(3)
  v_mfma_f32_16x16x32_bf16 v[92:95], v[220:223], v[40:43], v[92:95]
  v_mfma_f32_16x16x32_bf16 v[112:115], v[252:255], v[40:43], v[112:115]
  s_waitcnt lgkmcnt(2)
  v_mfma_f32_16x16x32_bf16 v[96:99], v[220:223], v[44:47], v[96:99]
  v_mfma_f32_16x16x32_bf16 v[116:119], v[252:255], v[44:47], v[116:119]
  s_waitcnt lgkmcnt(1)
  v_mfma_f32_16x16x32_bf16 v[100:103], v[220:223], v[24:27], v[100:103]
  v_mfma_f32_16x16x32_bf16 v[120:123], v[252:255], v[24:27], v[120:123]
  s_waitcnt lgkmcnt(0)
  v_mfma_f32_16x16x32_bf16 v[104:107], v[220:223], v[28:31], v[104:107]
  v_mfma_f32_16x16x32_bf16 v[124:127], v[252:255], v[28:31], v[124:127]
  v_cvt_pk_bf16_f32 v88, v88, v89
  v_cvt_pk_bf16_f32 v89, v90, v91
  v_cvt_pk_bf16_f32 v90, v92, v93
  v_cvt_pk_bf16_f32 v91, v94, v95
  s_add_u32 s33, s51, 4096
  v_permlane16_swap_b32 v88, v90
  v_permlane16_swap_b32 v89, v91
  buffer_store_dwordx4 v[88:91], v14, s[20:23], s33 offen
  v_cvt_pk_bf16_f32 v96, v96, v97
  v_cvt_pk_bf16_f32 v97, v98, v99
  v_cvt_pk_bf16_f32 v98, v100, v101
  v_cvt_pk_bf16_f32 v99, v102, v103
  s_add_u32 s33, s51, 32768
  v_permlane16_swap_b32 v96, v98
  v_permlane16_swap_b32 v97, v99
  buffer_store_dwordx4 v[96:99], v14, s[20:23], s33 offen
  v_cvt_pk_bf16_f32 v104, v104, v105
  v_cvt_pk_bf16_f32 v105, v106, v107
  s_add_u32 s33, s51, 61440
  buffer_store_dwordx2 v[104:105], v15, s[20:23], s33 offen
  v_cvt_pk_bf16_f32 v108, v108, v109
  v_cvt_pk_bf16_f32 v109, v110, v111
  v_cvt_pk_bf16_f32 v110, v112, v113
  v_cvt_pk_bf16_f32 v111, v114, v115
  s_add_u32 s33, s52, 6144
  v_permlane16_swap_b32 v108, v110
  v_permlane16_swap_b32 v109, v111
  buffer_store_dwordx4 v[108:111], v14, s[20:23], s33 offen
  v_cvt_pk_bf16_f32 v116, v116, v117
  v_cvt_pk_bf16_f32 v117, v118, v119
  v_cvt_pk_bf16_f32 v118, v120, v121
  v_cvt_pk_bf16_f32 v119, v122, v123
  s_add_u32 s33, s52, 34816
  v_permlane16_swap_b32 v116, v118
  v_permlane16_swap_b32 v117, v119
  buffer_store_dwordx4 v[116:119], v14, s[20:23], s33 offen
  v_cvt_pk_bf16_f32 v124, v124, v125
  v_cvt_pk_bf16_f32 v125, v126, v127
  s_add_u32 s33, s52, 63488
  buffer_store_dwordx2 v[124:125], v15, s[20:23], s33 offen
  v_mov_b32 v12, v23
  s_mul_i32 s32, s26, 280
  v_add_u32 v1, s32, v12
  v_lshrrev_b32 v2, 5, v1
  v_mul_u32_u24 v3, 2341, v2
  v_lshrrev_b32 v3, 16, v3
  v_mul_u32_u24 v4, 28, v3
  v_sub_u32 v4, v2, v4
  v_and_b32 v5, 15, v1
  v_lshl_add_u32 v5, v3, 4, v5
  v_bfe_u32 v6, v1, 4, 1
  v_lshlrev_b32 v6, 4, v6
  v_lshl_add_u32 v6, v4, 5, v6
  v_mul_u32_u24 v7, 896, v5
  v_add_u32 v6, v6, v7
  v_lshlrev_b32 v1, 4, v1
  v_mov_b32 v13, 0x7fffff00
  v_cmp_gt_u32 vcc, 280, v12
  s_nop 1
  v_cndmask_b32 v1, v13, v1, vcc
  v_cndmask_b32 v6, v13, v6, vcc
  s_waitcnt vmcnt(0)
  s_barrier
  s_cmp_lg_u32 s24, 0
  s_cbranch_scc1 L_fx_done
  v_mov_b32 v28, 1
  s_lshl_b32 s33, s26, 2
  s_add_u32 s33, s33, 0
  v_mov_b32 v27, s33
  v_lshlrev_b32 v29, 2, v0
  s_mov_b32 s34, s66
  s_mov_b32 s30, 0x40000
  s_mov_b64 exec, 1
  s_cmp_eq_u32 s67, 1
  s_cbranch_scc1 L_fx_loc
  buffer_wbl2 sc1
  s_waitcnt vmcnt(0)
  buffer_store_dword v28, v27, s[20:23], s66 offen sc1
  s_branch L_fx_sent
L_fx_loc:
  buffer_store_dword v28, v27, s[20:23], s66 offen
L_fx_sent:
  s_mov_b64 exec, 0xffff
L_fx_poll:
  buffer_load_dword v30, v29, s[20:23], s34 offen sc1
  s_waitcnt vmcnt(0)
  v_cmp_ne_u32 vcc, 1, v30
  s_sub_u32 s30, s30, 1
  s_cmp_eq_u32 s30, 0
  s_cbranch_scc1 L_fx_got
  s_cmp_eq_u64 vcc, 0
  s_cbranch_scc1 L_fx_got
  s_sleep 2
  s_branch L_fx_poll
L_fx_got:
  s_mov_b64 exec, -1
  s_cmp_eq_u32 s67, 1
  s_cbranch_scc1 L_fx_done
  buffer_inv sc1
  s_waitcnt vmcnt(0)
L_fx_done:
  s_branch L_red
L_S_fallback:
  s_mov_b32 s31, 1
  s_waitcnt vmcnt(0) lgkmcnt(0)
  s_barrier
  s_mov_b32 s29, s40
  s_mov_b32 s30, 32
  v_mov_b32 v7, 0xff800000
  v_mov_b32 v8, 0xff800000
  v_mov_b32 v9, 0xff800000
  v_mov_b32 v10, 0xff800000
  v_mov_b32 v11, 0xff800000
  v_bfe_u32 v24, v0, 4, 1
  v_lshlrev_b32 v24, 1, v24
  v_and_b32 v25, 7, v0
  v_xor_b32 v24, v24, v25
  v_lshlrev_b32 v24, 4, v24
  v_lshrrev_b32 v25, 3, v0
  v_lshl_add_u32 v24, v25, 9, v24
  s_lshl_b32 s32, s46, 7
  v_add_u32 v12, s32, v24
  v_xor_b32 v24, 64, v12
  v_add_u32 v13, 4096, v24
  v_add_u32 v14, 8192, v12
  v_add_u32 v15, 12288, v24
L_S_fbl:
  s_add_u32 m0, s39, 0
  s_nop 0
  buffer_load_dwordx4 v16, s[60:63], s29 offen offset:0 nt lds
  s_add_u32 m0, s39, 1920
  s_nop 0
  buffer_load_dwordx4 v16, s[60:63], s29 offen offset:128 nt lds
  s_add_u32 m0, s39, 3840
  s_nop 0
  buffer_load_dwordx4 v16, s[60:63], s29 offen offset:256 nt lds
  s_add_u32 m0, s39, 5760
  s_nop 0
  buffer_load_dwordx4 v16, s[60:63], s29 offen offset:384 nt lds
  s_add_u32 s29, s29, 16384
  s_waitcnt vmcnt(0)
  s_barrier
  ds_read_b128 v[20:23], v1 offset:0
  ds_read_b128 v[24:27], v2 offset:0
  ds_read_b128 v[28:31], v1 offset:2048
  ds_read_b128 v[32:35], v2 offset:2048
  s_waitcnt lgkmcnt(0)
  v_mfma_f32_16x16x32_bf16 v[56:59], v[20:23], v[96:99], 0
  v_mfma_f32_16x16x32_bf16 v[60:63], v[20:23], v[128:131], 0
  v_mfma_f32_16x16x32_bf16 v[64:67], v[20:23], v[160:163], 0
  v_mfma_f32_16x16x32_bf16 v[68:71], v[20:23], v[192:195], 0
  v_mfma_f32_16x16x32_bf16 v[72:75], v[20:23], v[224:227], 0
  v_mfma_f32_16x16x32_bf16 v[56:59], v[24:27], v[100:103], v[56:59]
  v_mfma_f32_16x16x32_bf16 v[60:63], v[24:27], v[132:135], v[60:63]
  v_mfma_f32_16x16x32_bf16 v[64:67], v[24:27], v[164:167], v[64:67]
  v_mfma_f32_16x16x32_bf16 v[68:71], v[24:27], v[196:199], v[68:71]
  v_mfma_f32_16x16x32_bf16 v[72:75], v[24:27], v[228:231], v[72:75]
  v_mfma_f32_16x16x32_bf16 v[56:59], v[28:31], v[104:107], v[56:59]
  v_mfma_f32_16x16x32_bf16 v[60:63], v[28:31], v[136:139], v[60:63]
  v_mfma_f32_16x16x32_bf16 v[64:67], v[28:31], v[168:171], v[64:67]
  v_mfma_f32_16x16x32_bf16 v[68:71], v[28:31], v[200:203], v[68:71]
  v_mfma_f32_16x16x32_bf16 v[72:75], v[28:31], v[232:235], v[72:75]
  v_mfma_f32_16x16x32_bf16 v[56:59], v[32:35], v[108:111], v[56:59]
  v_mfma_f32_16x16x32_bf16 v[60:63], v[32:35], v[140:143], v[60:63]
  v_mfma_f32_16x16x32_bf16 v[64:67], v[32:35], v[172:175], v[64:67]
  v_mfma_f32_16x16x32_bf16 v[68:71], v[32:35], v[204:207], v[68:71]
  v_mfma_f32_16x16x32_bf16 v[72:75], v[32:35], v[236:239], v[72:75]
  ds_read_b128 v[20:23], v1 offset:4096
  ds_read_b128 v[24:27], v2 offset:4096
  ds_read_b128 v[28:31], v1 offset:6144
  ds_read_b128 v[32:35], v2 offset:6144
  s_waitcnt lgkmcnt(0)
  v_mfma_f32_16x16x32_bf16 v[56:59], v[20:23], v[112:115], v[56:59]
  v_mfma_f32_16x16x32_bf16 v[60:63], v[20:23], v[144:147], v[60:63]
  v_mfma_f32_16x16x32_bf16 v[64:67], v[20:23], v[176:179], v[64:67]
  v_mfma_f32_16x16x32_bf16 v[68:71], v[20:23], v[208:211], v[68:71]
  v_mfma_f32_16x16x32_bf16 v[72:75], v[20:23], v[240:243], v[72:75]
  v_mfma_f32_16x16x32_bf16 v[56:59], v[24:27], v[116:119], v[56:59]
  v_mfma_f32_16x16x32_bf16 v[60:63], v[24:27], v[148:151], v[60:63]
  v_mfma_f32_16x16x32_bf16 v[64:67], v[24:27], v[180:183], v[64:67]
  v_mfma_f32_16x16x32_bf16 v[68:71], v[24:27], v[212:215], v[68:71]
  v_mfma_f32_16x16x32_bf16 v[72:75], v[24:27], v[244:247], v[72:75]
  v_mfma_f32_16x16x32_bf16 v[56:59], v[28:31], v[120:123], v[56:59]
  v_mfma_f32_16x16x32_bf16 v[60:63], v[28:31], v[152:155], v[60:63]
  v_mfma_f32_16x16x32_bf16 v[64:67], v[28:31], v[184:187], v[64:67]
  v_mfma_f32_16x16x32_bf16 v[68:71], v[28:31], v[216:219], v[68:71]
  v_mfma_f32_16x16x32_bf16 v[72:75], v[28:31], v[248:251], v[72:75]
  v_mfma_f32_16x16x32_bf16 v[56:59], v[32:35], v[124:127], v[56:59]
  v_mfma_f32_16x16x32_bf16 v[60:63], v[32:35], v[156:159], v[60:63]
  v_mfma_f32_16x16x32_bf16 v[64:67], v[32:35], v[188:191], v[64:67]
  v_mfma_f32_16x16x32_bf16 v[68:71], v[32:35], v[220:223], v[68:71]
  v_mfma_f32_16x16x32_bf16 v[72:75], v[32:35], v[252:255], v[72:75]
  s_nop 3
  v_max3_f32 v7, v56, v57, v7
  v_max3_f32 v7, v58, v59, v7
  v_max3_f32 v8, v60, v61, v8
  v_max3_f32 v8, v62, v63, v8
  v_max3_f32 v9, v64, v65, v9
  v_max3_f32 v9, v66, v67, v9
  v_max3_f32 v10, v68, v69, v10
  v_max3_f32 v10, v70, v71, v10
  v_max3_f32 v11, v72, v73, v11
  v_max3_f32 v11, v74, v75, v11
  s_barrier
  s_sub_u32 s30, s30, 1
  s_cmp_lg_u32 s30, 0
  s_cbranch_scc1 L_S_fbl
  s_mov_b32 s29, s40
  s_mov_b32 s49, s40
  s_add_u32 m0, s39, 0
  s_nop 0
  buffer_load_dwordx4 v16, s[60:63], s29 offen offset:0 nt lds
  s_add_u32 m0, s39, 1920
  s_nop 0
  buffer_load_dwordx4 v16, s[60:63], s29 offen offset:128 nt lds
  s_add_u32 m0, s39, 3840
  s_nop 0
  buffer_load_dwordx4 v16, s[60:63], s29 offen offset:256 nt lds
  s_add_u32 m0, s39, 5760
  s_nop 0
  buffer_load_dwordx4 v16, s[60:63], s29 offen offset:384 nt lds
  s_add_u32 s29, s29, 16384
  s_add_u32 m0, s39, 16384
  s_nop 0
  buffer_load_dwordx4 v16, s[60:63], s29 offen offset:0 nt lds
  s_add_u32 m0, s39, 18304
  s_nop 0
  buffer_load_dwordx4 v16, s[60:63], s29 offen offset:128 nt lds
  s_add_u32 m0, s39, 20224
  s_nop 0
  buffer_load_dwordx4 v16, s[60:63], s29 offen offset:256 nt lds
  s_add_u32 m0, s39, 22144
  s_nop 0
  buffer_load_dwordx4 v16, s[60:63], s29 offen offset:384 nt lds
  s_add_u32 s29, s29, 16384
  s_add_u32 m0, s3, 49152
  s_nop 0
  buffer_load_dwordx4 v12, s[12:15], s49 offen nt lds
  s_add_u32 m0, s3, 50176
  s_nop 0
  buffer_load_dwordx4 v13, s[12:15], s49 offen nt lds
  s_add_u32 m0, s3, 51200
  s_nop 0
  buffer_load_dwordx4 v14, s[12:15], s49 offen nt lds
  s_add_u32 m0, s3, 52224
  s_nop 0
  buffer_load_dwordx4 v15, s[12:15], s49 offen nt lds
  s_add_u32 s49, s49, 16384
  s_add_u32 m0, s39, 32768
  s_nop 0
  buffer_load_dwordx4 v16, s[60:63], s29 offen offset:0 nt lds
  s_add_u32 m0, s39, 34688
  s_nop 0
  buffer_load_dwordx4 v16, s[60:63], s29 offen offset:128 nt lds
  s_add_u32 m0, s39, 36608
  s_nop 0
  buffer_load_dwordx4 v16, s[60:63], s29 offen offset:256 nt lds
  s_add_u32 m0, s39, 38528
  s_nop 0
  buffer_load_dwordx4 v16, s[60:63], s29 offen offset:384 nt lds
  s_add_u32 s29, s29, 16384
  s_setprio 1
  s_waitcnt vmcnt(12)
  s_barrier
  ds_read_b128 v[20:23], v1 offset:0
  ds_read_b128 v[24:27], v2 offset:0
  ds_read_b128 v[28:31], v1 offset:2048
  ds_read_b128 v[32:35], v2 offset:2048
  s_waitcnt lgkmcnt(0)
  v_mfma_f32_16x16x32_bf16 v[56:59], v[20:23], v[96:99], 0
  v_mfma_f32_16x16x32_bf16 v[60:63], v[20:23], v[128:131], 0
  v_mfma_f32_16x16x32_bf16 v[64:67], v[20:23], v[160:163], 0
  v_mfma_f32_16x16x32_bf16 v[68:71], v[20:23], v[192:195], 0
  v_mfma_f32_16x16x32_bf16 v[72:75], v[20:23], v[224:227], 0
  v_mfma_f32_16x16x32_bf16 v[56:59], v[24:27], v[100:103], v[56:59]
  v_mfma_f32_16x16x32_bf16 v[60:63], v[24:27], v[132:135], v[60:63]
  v_mfma_f32_16x16x32_bf16 v[64:67], v[24:27], v[164:167], v[64:67]
  v_mfma_f32_16x16x32_bf16 v[68:71], v[24:27], v[196:199], v[68:71]
  v_mfma_f32_16x16x32_bf16 v[72:75], v[24:27], v[228:231], v[72:75]
  v_mfma_f32_16x16x32_bf16 v[56:59], v[28:31], v[104:107], v[56:59]
  v_mfma_f32_16x16x32_bf16 v[60:63], v[28:31], v[136:139], v[60:63]
  v_mfma_f32_16x16x32_bf16 v[64:67], v[28:31], v[168:171], v[64:67]
  v_mfma_f32_16x16x32_bf16 v[68:71], v[28:31], v[200:203], v[68:71]
  v_mfma_f32_16x16x32_bf16 v[72:75], v[28:31], v[232:235], v[72:75]
  v_mfma_f32_16x16x32_bf16 v[56:59], v[32:35], v[108:111], v[56:59]
  v_mfma_f32_16x16x32_bf16 v[60:63], v[32:35], v[140:143], v[60:63]
  v_mfma_f32_16x16x32_bf16 v[64:67], v[32:35], v[172:175], v[64:67]
  v_mfma_f32_16x16x32_bf16 v[68:71], v[32:35], v[204:207], v[68:71]
  v_mfma_f32_16x16x32_bf16 v[72:75], v[32:35], v[236:239], v[72:75]
  ds_read_b128 v[20:23], v1 offset:4096
  ds_read_b128 v[24:27], v2 offset:4096
  ds_read_b128 v[28:31], v1 offset:6144
  ds_read_b128 v[32:35], v2 offset:6144
  s_waitcnt lgkmcnt(0)
  v_mfma_f32_16x16x32_bf16 v[56:59], v[20:23], v[112:115], v[56:59]
  v_mfma_f32_16x16x32_bf16 v[60:63], v[20:23], v[144:147], v[60:63]
  v_mfma_f32_16x16x32_bf16 v[64:67], v[20:23], v[176:179], v[64:67]
  v_mfma_f32_16x16x32_bf16 v[68:71], v[20:23], v[208:211], v[68:71]
  v_mfma_f32_16x16x32_bf16 v[72:75], v[20:23], v[240:243], v[72:75]
  v_mfma_f32_16x16x32_bf16 v[56:59], v[24:27], v[116:119], v[56:59]
  v_mfma_f32_16x16x32_bf16 v[60:63], v[24:27], v[148:151], v[60:63]
  v_mfma_f32_16x16x32_bf16 v[64:67], v[24:27], v[180:183], v[64:67]
  v_mfma_f32_16x16x32_bf16 v[68:71], v[24:27], v[212:215], v[68:71]
  v_mfma_f32_16x16x32_bf16 v[72:75], v[24:27], v[244:247], v[72:75]
  v_mfma_f32_16x16x32_bf16 v[56:59], v[28:31], v[120:123], v[56:59]
  v_mfma_f32_16x16x32_bf16 v[60:63], v[28:31], v[152:155], v[60:63]
  v_mfma_f32_16x16x32_bf16 v[64:67], v[28:31], v[184:187], v[64:67]
  v_mfma_f32_16x16x32_bf16 v[68:71], v[28:31], v[216:219], v[68:71]
  v_mfma_f32_16x16x32_bf16 v[72:75], v[28:31], v[248:251], v[72:75]
  v_mfma_f32_16x16x32_bf16 v[56:59], v[32:35], v[124:127], v[56:59]
  v_mfma_f32_16x16x32_bf16 v[60:63], v[32:35], v[156:159], v[60:63]
  v_mfma_f32_16x16x32_bf16 v[64:67], v[32:35], v[188:191], v[64:67]
  v_mfma_f32_16x16x32_bf16 v[68:71], v[32:35], v[220:223], v[68:71]
  v_mfma_f32_16x16x32_bf16 v[72:75], v[32:35], v[252:255], v[72:75]
  s_branch L_S_join
L_PV:
  v_mov_b32 v1, v56
  v_subrev_u32 v4, 40960, v50
  v_mov_b32 v2, v57
  v_subrev_u32 v5, 40960, v51
  v_mov_b32 v20, v58
  v_subrev_u32 v6, 40960, v52
  v_mov_b32 v21, v59
  v_subrev_u32 v7, 40960, v53
  v_mov_b32 v3, v60
  s_waitcnt lgkmcnt(0)
  s_barrier
  s_cmp_lg_u32 s24, 4
  s_cbranch_scc1 L_noreg
  s_getreg_b32 s32, hwreg(HW_REG_XCC_ID)
  s_and_b32 s32, s32, 15
  s_mul_i32 s33, s32, s32
  s_lshl_b32 s33, s33, 18
  s_lshl_b32 s32, s32, 8
  s_add_u32 s32, s32, s33
  s_add_u32 s32, s32, 1
  v_mov_b32 v23, 0
  v_mov_b32 v22, s32
  s_lshl_b32 s33, s25, 5
  s_mov_b64 exec, 1
  buffer_atomic_add v22, v23, s[68:71], s33 offen
  s_mov_b64 exec, -1
L_noreg:
L_PV_join:
  s_barrier
  s_barrier
  ds_read_b64_tr_b16 v[40:41], v1 offset:49152
  ds_read_b64_tr_b16 v[42:43], v1 offset:49664
  ds_read_b64_tr_b16 v[44:45], v2 offset:49152
  ds_read_b64_tr_b16 v[46:47], v2 offset:49664
  ds_read_b64_tr_b16 v[48:49], v20 offset:49152
  ds_read_b64_tr_b16 v[50:51], v20 offset:49664
  ds_read_b64_tr_b16 v[52:53], v21 offset:49152
  ds_read_b64_tr_b16 v[54:55], v21 offset:49664
  v_lshlrev_b32 v17, 4, v0
  s_lshl_b32 s53, s46, 10
  s_add_u32 s53, s53, s64
  s_add_u32 s49, s40, 49152
  s_add_u32 m0, s3, 32768
  s_nop 0
  buffer_load_dwordx4 v12, s[12:15], s49 offen nt lds
  s_add_u32 m0, s3, 33792
  s_nop 0
  buffer_load_dwordx4 v13, s[12:15], s49 offen nt lds
  s_add_u32 m0, s3, 34816
  s_nop 0
  buffer_load_dwordx4 v14, s[12:15], s49 offen nt lds
  s_add_u32 m0, s3, 35840
  s_nop 0
  buffer_load_dwordx4 v15, s[12:15], s49 offen nt lds
  s_add_u32 s49, s49, 16384
  s_waitcnt lgkmcnt(0)
  s_barrier
  ds_read_b128 v[76:79], v3 offset:1280
  ds_read_b128 v[80:83], v3 offset:1536
  ds_read_b128 v[84:87], v3 offset:1792
  ds_read_b128 v[88:91], v3 offset:2048
  ds_read_b128 v[92:95], v3 offset:2304
  ds_read_b128 v[56:59], v3 offset:0
  ds_read_b128 v[60:63], v3 offset:256
  ds_read_b128 v[64:67], v3 offset:512
  ds_read_b128 v[68:71], v3 offset:768
  s_add_u32 m0, s3, 49152
  s_nop 0
  buffer_load_dwordx4 v12, s[12:15], s49 offen nt lds
  s_add_u32 m0, s3, 50176
  s_nop 0
  buffer_load_dwordx4 v13, s[12:15], s49 offen nt lds
  s_add_u32 m0, s3, 51200
  s_nop 0
  buffer_load_dwordx4 v14, s[12:15], s49 offen nt lds
  s_add_u32 m0, s3, 52224
  s_nop 0
  buffer_load_dwordx4 v15, s[12:15], s49 offen nt lds
  s_add_u32 s49, s49, 16384
  s_waitcnt lgkmcnt(4)
  v_mfma_f32_16x16x32_bf16 v[176:179], v[40:43], v[76:79], 0
  v_mfma_f32_16x16x32_bf16 v[180:183], v[44:47], v[76:79], 0
  v_mfma_f32_16x16x32_bf16 v[184:187], v[48:51], v[76:79], 0
  ds_read_b128 v[72:75], v3 offset:1024
  v_mfma_f32_16x16x32_bf16 v[188:191], v[52:55], v[76:79], 0
  s_mul_i32 s33, s2, 14336
  s_lshl_b32 s34, s46, 10
  s_add_u32 s33, s33, s34
  s_add_u32 m0, s36, 20480
  v_mfma_f32_16x16x32_bf16 v[192:195], v[40:43], v[80:83], 0
  buffer_load_dwordx4 v17, s[16:19], s33 offen lds
  s_add_u32 s33, s33, 4096
  v_mfma_f32_16x16x32_bf16 v[196:199], v[44:47], v[80:83], 0
  buffer_load_dwordx4 v17, s[16:19], s33 offen lds
  s_add_u32 s33, s33, 4096
  v_mfma_f32_16x16x32_bf16 v[200:203], v[48:51], v[80:83], 0
  buffer_load_dwordx4 v17, s[16:19], s33 offen lds
  s_add_u32 s33, s33, 4096
  v_mfma_f32_16x16x32_bf16 v[204:207], v[52:55], v[80:83], 0
  buffer_load_dwordx4 v17, s[16:19], s33 offen lds
  s_add_u32 s33, s33, 4096
  v_mfma_f32_16x16x32_bf16 v[208:211], v[40:43], v[84:87], 0
  v_mfma_f32_16x16x32_bf16 v[212:215], v[44:47], v[84:87], 0
  v_mfma_f32_16x16x32_bf16 v[216:219], v[48:51], v[84:87], 0
  v_mfma_f32_16x16x32_bf16 v[220:223], v[52:55], v[84:87], 0
  v_mfma_f32_16x16x32_bf16 v[224:227], v[40:43], v[88:91], 0
  v_mfma_f32_16x16x32_bf16 v[228:231], v[44:47], v[88:91], 0
  v_mfma_f32_16x16x32_bf16 v[232:235], v[48:51], v[88:91], 0
  v_mfma_f32_16x16x32_bf16 v[236:239], v[52:55], v[88:91], 0
  v_mfma_f32_16x16x32_bf16 v[240:243], v[40:43], v[92:95], 0
  v_mfma_f32_16x16x32_bf16 v[244:247], v[44:47], v[92:95], 0
  v_mfma_f32_16x16x32_bf16 v[248:251], v[48:51], v[92:95], 0
  v_mfma_f32_16x16x32_bf16 v[252:255], v[52:55], v[92:95], 0
  s_waitcnt lgkmcnt(0)
  s_barrier
  ds_read_b64_tr_b16 v[24:25], v1 offset:0
  ds_read_b64_tr_b16 v[26:27], v1 offset:512
  ds_read_b64_tr_b16 v[28:29], v2 offset:0
  ds_read_b64_tr_b16 v[30:31], v2 offset:512
  ds_read_b64_tr_b16 v[32:33], v20 offset:0
  ds_read_b64_tr_b16 v[34:35], v20 offset:512
  ds_read_b64_tr_b16 v[36:37], v21 offset:0
  ds_read_b64_tr_b16 v[38:39], v21 offset:512
  v_mfma_f32_16x16x32_bf16 v[96:99], v[40:43], v[56:59], 0
  ds_read_b128 v[76:79], v3 offset:11520
  v_mfma_f32_16x16x32_bf16 v[100:103], v[44:47], v[56:59], 0
  v_mfma_f32_16x16x32_bf16 v[104:107], v[48:51], v[56:59], 0
  ds_read_b128 v[80:83], v3 offset:11776
  v_mfma_f32_16x16x32_bf16 v[108:111], v[52:55], v[56:59], 0
  v_mfma_f32_16x16x32_bf16 v[112:115], v[40:43], v[60:63], 0
  ds_read_b128 v[84:87], v3 offset:12032
  v_mfma_f32_16x16x32_bf16 v[116:119], v[44:47], v[60:63], 0
  v_mfma_f32_16x16x32_bf16 v[120:123], v[48:51], v[60:63], 0
  ds_read_b128 v[88:91], v3 offset:12288
  v_mfma_f32_16x16x32_bf16 v[124:127], v[52:55], v[60:63], 0
  v_mfma_f32_16x16x32_bf16 v[128:131], v[40:43], v[64:67], 0
  ds_read_b128 v[92:95], v3 offset:12544
  v_mfma_f32_16x16x32_bf16 v[132:135], v[44:47], v[64:67], 0
  v_mfma_f32_16x16x32_bf16 v[136:139], v[48:51], v[64:67], 0
  ds_read_b128 v[56:59], v3 offset:10240
  v_mfma_f32_16x16x32_bf16 v[140:143], v[52:55], v[64:67], 0
  v_mfma_f32_16x16x32_bf16 v[144:147], v[40:43], v[68:71], 0
  ds_read_b128 v[60:63], v3 offset:10496
  v_mfma_f32_16x16x32_bf16 v[148:151], v[44:47], v[68:71], 0
  v_mfma_f32_16x16x32_bf16 v[152:155], v[48:51], v[68:71], 0
  ds_read_b128 v[64:67], v3 offset:10752
  v_mfma_f32_16x16x32_bf16 v[156:159], v[52:55], v[68:71], 0
  v_mfma_f32_16x16x32_bf16 v[160:163], v[40:43], v[72:75], 0
  v_mfma_f32_16x16x32_bf16 v[164:167], v[44:47], v[72:75], 0
  v_mfma_f32_16x16x32_bf16 v[168:171], v[48:51], v[72:75], 0
  v_mfma_f32_16x16x32_bf16 v[172:175], v[52:55], v[72:75], 0
  ds_read_b128 v[68:71], v3 offset:11008
  s_waitcnt lgkmcnt(9)
  s_add_u32 m0, s3, 0
  s_nop 0
  buffer_load_dwordx4 v12, s[12:15], s49 offen nt lds
  s_add_u32 m0, s3, 1024
  s_nop 0
  buffer_load_dwordx4 v13, s[12:15], s49 offen nt lds
  s_add_u32 m0, s3, 2048
  s_nop 0
  buffer_load_dwordx4 v14, s[12:15], s49 offen nt lds
  s_add_u32 m0, s3, 3072
  s_nop 0
  buffer_load_dwordx4 v15, s[12:15], s49 offen nt lds
  s_add_u32 s49, s49, 16384
  s_waitcnt lgkmcnt(4)
  v_mfma_f32_16x16x32_bf16 v[176:179], v[24:27], v[76:79], v[176:179]
  v_mfma_f32_16x16x32_bf16 v[180:183], v[28:31], v[76:79], v[180:183]
  v_mfma_f32_16x16x32_bf16 v[184:187], v[32:35], v[76:79], v[184:187]
  ds_read_b64_tr_b16 v[40:41], v1 offset:16384
  v_mfma_f32_16x16x32_bf16 v[188:191], v[36:39], v[76:79], v[188:191]
  ds_read_b64_tr_b16 v[42:43], v1 offset:16896
  v_mfma_f32_16x16x32_bf16 v[192:195], v[24:27], v[80:83], v[192:195]
  ds_read_b128 v[72:75], v3 offset:11264
  v_mfma_f32_16x16x32_bf16 v[196:199], v[28:31], v[80:83], v[196:199]
  ds_read_b64_tr_b16 v[44:45], v2 offset:16384
  v_mfma_f32_16x16x32_bf16 v[200:203], v[32:35], v[80:83], v[200:203]
  ds_read_b64_tr_b16 v[46:47], v2 offset:16896
  v_mfma_f32_16x16x32_bf16 v[204:207], v[36:39], v[80:83], v[204:207]
  ds_read_b64_tr_b16 v[48:49], v20 offset:16384
  v_mfma_f32_16x16x32_bf16 v[208:211], v[24:27], v[84:87], v[208:211]
  ds_read_b64_tr_b16 v[50:51], v20 offset:16896
  v_mfma_f32_16x16x32_bf16 v[212:215], v[28:31], v[84:87], v[212:215]
  ds_read_b64_tr_b16 v[52:53], v21 offset:16384
  v_mfma_f32_16x16x32_bf16 v[216:219], v[32:35], v[84:87], v[216:219]
  ds_read_b64_tr_b16 v[54:55], v21 offset:16896
  v_mfma_f32_16x16x32_bf16 v[220:223], v[36:39], v[84:87], v[220:223]
  v_mfma_f32_16x16x32_bf16 v[224:227], v[24:27], v[88:91], v[224:227]
  v_mfma_f32_16x16x32_bf16 v[228:231], v[28:31], v[88:91], v[228:231]
  v_mfma_f32_16x16x32_bf16 v[232:235], v[32:35], v[88:91], v[232:235]
  v_mfma_f32_16x16x32_bf16 v[236:239], v[36:39], v[88:91], v[236:239]
  v_mfma_f32_16x16x32_bf16 v[240:243], v[24:27], v[92:95], v[240:243]
  v_mfma_f32_16x16x32_bf16 v[244:247], v[28:31], v[92:95], v[244:247]
  v_mfma_f32_16x16x32_bf16 v[248:251], v[32:35], v[92:95], v[248:251]
  v_mfma_f32_16x16x32_bf16 v[252:255], v[36:39], v[92:95], v[252:255]
  s_waitcnt lgkmcnt(0)
  s_barrier
  s_mov_b32 s30, 6
L_PV_loop:
  v_mfma_f32_16x16x32_bf16 v[96:99], v[24:27], v[56:59], v[96:99]
  ds_read_b128 v[76:79], v3 offset:1280
  v_mfma_f32_16x16x32_bf16 v[100:103], v[28:31], v[56:59], v[100:103]
  v_mfma_f32_16x16x32_bf16 v[104:107], v[32:35], v[56:59], v[104:107]
  ds_read_b128 v[80:83], v3 offset:1536
  v_mfma_f32_16x16x32_bf16 v[108:111], v[36:39], v[56:59], v[108:111]
  v_mfma_f32_16x16x32_bf16 v[112:115], v[24:27], v[60:63], v[112:115]
  ds_read_b128 v[84:87], v3 offset:1792
  v_mfma_f32_16x16x32_bf16 v[116:119], v[28:31], v[60:63], v[116:119]
  v_mfma_f32_16x16x32_bf16 v[120:123], v[32:35], v[60:63], v[120:123]
  ds_read_b128 v[88:91], v3 offset:2048
  v_mfma_f32_16x16x32_bf16 v[124:127], v[36:39], v[60:63], v[124:127]
  v_mfma_f32_16x16x32_bf16 v[128:131], v[24:27], v[64:67], v[128:131]
  ds_read_b128 v[92:95], v3 offset:2304
  v_mfma_f32_16x16x32_bf16 v[132:135], v[28:31], v[64:67], v[132:135]
  v_mfma_f32_16x16x32_bf16 v[136:139], v[32:35], v[64:67], v[136:139]
  ds_read_b128 v[56:59], v3 offset:0
  v_mfma_f32_16x16x32_bf16 v[140:143], v[36:39], v[64:67], v[140:143]
  v_mfma_f32_16x16x32_bf16 v[144:147], v[24:27], v[68:71], v[144:147]
  ds_read_b128 v[60:63], v3 offset:256
  v_mfma_f32_16x16x32_bf16 v[148:151], v[28:31], v[68:71], v[148:151]
  v_mfma_f32_16x16x32_bf16 v[152:155], v[32:35], v[68:71], v[152:155]
  ds_read_b128 v[64:67], v3 offset:512
  v_mfma_f32_16x16x32_bf16 v[156:159], v[36:39], v[68:71], v[156:159]
  v_mfma_f32_16x16x32_bf16 v[160:163], v[24:27], v[72:75], v[160:163]
  v_mfma_f32_16x16x32_bf16 v[164:167], v[28:31], v[72:75], v[164:167]
  v_mfma_f32_16x16x32_bf16 v[168:171], v[32:35], v[72:75], v[168:171]
  v_mfma_f32_16x16x32_bf16 v[172:175], v[36:39], v[72:75], v[172:175]
  ds_read_b128 v[68:71], v3 offset:768
  s_add_u32 m0, s3, 16384
  s_nop 0
  buffer_load_dwordx4 v12, s[12:15], s49 offen nt lds
  s_add_u32 m0, s3, 17408
  s_nop 0
  buffer_load_dwordx4 v13, s[12:15], s49 offen nt lds
  s_add_u32 m0, s3, 18432
  s_nop 0
  buffer_load_dwordx4 v14, s[12:15], s49 offen nt lds
  s_add_u32 m0, s3, 19456
  s_nop 0
  buffer_load_dwordx4 v15, s[12:15], s49 offen nt lds
  s_add_u32 s49, s49, 16384
  s_waitcnt vmcnt(12)
  s_waitcnt lgkmcnt(4)
  v_mfma_f32_16x16x32_bf16 v[176:179], v[40:43], v[76:79], v[176:179]
  v_mfma_f32_16x16x32_bf16 v[180:183], v[44:47], v[76:79], v[180:183]
  v_mfma_f32_16x16x32_bf16 v[184:187], v[48:51], v[76:79], v[184:187]
  ds_read_b64_tr_b16 v[24:25], v1 offset:32768
  v_mfma_f32_16x16x32_bf16 v[188:191], v[52:55], v[76:79], v[188:191]
  ds_read_b64_tr_b16 v[26:27], v1 offset:33280
  v_mfma_f32_16x16x32_bf16 v[192:195], v[40:43], v[80:83], v[192:195]
  ds_read_b128 v[72:75], v3 offset:1024
  v_mfma_f32_16x16x32_bf16 v[196:199], v[44:47], v[80:83], v[196:199]
  ds_read_b64_tr_b16 v[28:29], v2 offset:32768
  v_mfma_f32_16x16x32_bf16 v[200:203], v[48:51], v[80:83], v[200:203]
  ds_read_b64_tr_b16 v[30:31], v2 offset:33280
  v_mfma_f32_16x16x32_bf16 v[204:207], v[52:55], v[80:83], v[204:207]
  ds_read_b64_tr_b16 v[32:33], v20 offset:32768
  v_mfma_f32_16x16x32_bf16 v[208:211], v[40:43], v[84:87], v[208:211]
  ds_read_b64_tr_b16 v[34:35], v20 offset:33280
  v_mfma_f32_16x16x32_bf16 v[212:215], v[44:47], v[84:87], v[212:215]
  ds_read_b64_tr_b16 v[36:37], v21 offset:32768
  v_mfma_f32_16x16x32_bf16 v[216:219], v[48:51], v[84:87], v[216:219]
  ds_read_b64_tr_b16 v[38:39], v21 offset:33280
  v_mfma_f32_16x16x32_bf16 v[220:223], v[52:55], v[84:87], v[220:223]
  v_mfma_f32_16x16x32_bf16 v[224:227], v[40:43], v[88:91], v[224:227]
  v_mfma_f32_16x16x32_bf16 v[228:231], v[44:47], v[88:91], v[228:231]
  v_mfma_f32_16x16x32_bf16 v[232:235], v[48:51], v[88:91], v[232:235]
  v_mfma_f32_16x16x32_bf16 v[236:239], v[52:55], v[88:91], v[236:239]
  v_mfma_f32_16x16x32_bf16 v[240:243], v[40:43], v[92:95], v[240:243]
  v_mfma_f32_16x16x32_bf16 v[244:247], v[44:47], v[92:95], v[244:247]
  v_mfma_f32_16x16x32_bf16 v[248:251], v[48:51], v[92:95], v[248:251]
  v_mfma_f32_16x16x32_bf16 v[252:255], v[52:55], v[92:95], v[252:255]
  s_waitcnt lgkmcnt(0)
  s_barrier
  v_mfma_f32_16x16x32_bf16 v[96:99], v[40:43], v[56:59], v[96:99]
  ds_read_b128 v[76:79], v3 offset:11520
  v_mfma_f32_16x16x32_bf16 v[100:103], v[44:47], v[56:59], v[100:103]
  v_mfma_f32_16x16x32_bf16 v[104:107], v[48:51], v[56:59], v[104:107]
  ds_read_b128 v[80:83], v3 offset:11776
  v_mfma_f32_16x16x32_bf16 v[108:111], v[52:55], v[56:59], v[108:111]
  v_mfma_f32_16x16x32_bf16 v[112:115], v[40:43], v[60:63], v[112:115]
  ds_read_b128 v[84:87], v3 offset:12032
  v_mfma_f32_16x16x32_bf16 v[116:119], v[44:47], v[60:63], v[116:119]
  v_mfma_f32_16x16x32_bf16 v[120:123], v[48:51], v[60:63], v[120:123]
  ds_read_b128 v[88:91], v3 offset:12288
  v_mfma_f32_16x16x32_bf16 v[124:127], v[52:55], v[60:63], v[124:127]
  v_mfma_f32_16x16x32_bf16 v[128:131], v[40:43], v[64:67], v[128:131]
  ds_read_b128 v[92:95], v3 offset:12544
  v_mfma_f32_16x16x32_bf16 v[132:135], v[44:47], v[64:67], v[132:135]
  v_mfma_f32_16x16x32_bf16 v[136:139], v[48:51], v[64:67], v[136:139]
  ds_read_b128 v[56:59], v3 offset:10240
  v_mfma_f32_16x16x32_bf16 v[140:143], v[52:55], v[64:67], v[140:143]
  v_mfma_f32_16x16x32_bf16 v[144:147], v[40:43], v[68:71], v[144:147]
  ds_read_b128 v[60:63], v3 offset:10496
  v_mfma_f32_16x16x32_bf16 v[148:151], v[44:47], v[68:71], v[148:151]
  v_mfma_f32_16x16x32_bf16 v[152:155], v[48:51], v[68:71], v[152:155]
  ds_read_b128 v[64:67], v3 offset:10752
  v_mfma_f32_16x16x32_bf16 v[156:159], v[52:55], v[68:71], v[156:159]
  v_mfma_f32_16x16x32_bf16 v[160:163], v[40:43], v[72:75], v[160:163]
  v_mfma_f32_16x16x32_bf16 v[164:167], v[44:47], v[72:75], v[164:167]
  v_mfma_f32_16x16x32_bf16 v[168:171], v[48:51], v[72:75], v[168:171]
  v_mfma_f32_16x16x32_bf16 v[172:175], v[52:55], v[72:75], v[172:175]
  ds_read_b128 v[68:71], v3 offset:11008
  s_add_u32 m0, s3, 32768
  s_nop 0
  buffer_load_dwordx4 v12, s[12:15], s49 offen nt lds
  s_add_u32 m0, s3, 33792
  s_nop 0
  buffer_load_dwordx4 v13, s[12:15], s49 offen nt lds
  s_add_u32 m0, s3, 34816
  s_nop 0
  buffer_load_dwordx4 v14, s[12:15], s49 offen nt lds
  s_add_u32 m0, s3, 35840
  s_nop 0
  buffer_load_dwordx4 v15, s[12:15], s49 offen nt lds
  s_add_u32 s49, s49, 16384
  s_waitcnt vmcnt(12)
  s_waitcnt lgkmcnt(4)
  v_mfma_f32_16x16x32_bf16 v[176:179], v[24:27], v[76:79], v[176:179]
  v_mfma_f32_16x16x32_bf16 v[180:183], v[28:31], v[76:79], v[180:183]
  v_mfma_f32_16x16x32_bf16 v[184:187], v[32:35], v[76:79], v[184:187]
  ds_read_b64_tr_b16 v[40:41], v1 offset:49152
  v_mfma_f32_16x16x32_bf16 v[188:191], v[36:39], v[76:79], v[188:191]
  ds_read_b64_tr_b16 v[42:43], v1 offset:49664
  v_mfma_f32_16x16x32_bf16 v[192:195], v[24:27], v[80:83], v[192:195]
  ds_read_b128 v[72:75], v3 offset:11264
  v_mfma_f32_16x16x32_bf16 v[196:199], v[28:31], v[80:83], v[196:199]
  ds_read_b64_tr_b16 v[44:45], v2 offset:49152
  v_mfma_f32_16x16x32_bf16 v[200:203], v[32:35], v[80:83], v[200:203]
  ds_read_b64_tr_b16 v[46:47], v2 offset:49664
  v_mfma_f32_16x16x32_bf16 v[204:207], v[36:39], v[80:83], v[204:207]
  ds_read_b64_tr_b16 v[48:49], v20 offset:49152
  v_mfma_f32_16x16x32_bf16 v[208:211], v[24:27], v[84:87], v[208:211]
  ds_read_b64_tr_b16 v[50:51], v20 offset:49664
  v_mfma_f32_16x16x32_bf16 v[212:215], v[28:31], v[84:87], v[212:215]
  ds_read_b64_tr_b16 v[52:53], v21 offset:49152
  v_mfma_f32_16x16x32_bf16 v[216:219], v[32:35], v[84:87], v[216:219]
  ds_read_b64_tr_b16 v[54:55], v21 offset:49664
  v_mfma_f32_16x16x32_bf16 v[220:223], v[36:39], v[84:87], v[220:223]
  v_mfma_f32_16x16x32_bf16 v[224:227], v[24:27], v[88:91], v[224:227]
  v_mfma_f32_16x16x32_bf16 v[228:231], v[28:31], v[88:91], v[228:231]
  v_mfma_f32_16x16x32_bf16 v[232:235], v[32:35], v[88:91], v[232:235]
  v_mfma_f32_16x16x32_bf16 v[236:239], v[36:39], v[88:91], v[236:239]
  v_mfma_f32_16x16x32_bf16 v[240:243], v[24:27], v[92:95], v[240:243]
  v_mfma_f32_16x16x32_bf16 v[244:247], v[28:31], v[92:95], v[244:247]
  v_mfma_f32_16x16x32_bf16 v[248:251], v[32:35], v[92:95], v[248:251]
  v_mfma_f32_16x16x32_bf16 v[252:255], v[36:39], v[92:95], v[252:255]
  s_waitcnt lgkmcnt(0)
  s_barrier
  v_mfma_f32_16x16x32_bf16 v[96:99], v[24:27], v[56:59], v[96:99]
  ds_read_b128 v[76:79], v3 offset:1280
  v_mfma_f32_16x16x32_bf16 v[100:103], v[28:31], v[56:59], v[100:103]
  v_mfma_f32_16x16x32_bf16 v[104:107], v[32:35], v[56:59], v[104:107]
  ds_read_b128 v[80:83], v3 offset:1536
  v_mfma_f32_16x16x32_bf16 v[108:111], v[36:39], v[56:59], v[108:111]
  v_mfma_f32_16x16x32_bf16 v[112:115], v[24:27], v[60:63], v[112:115]
  ds_read_b128 v[84:87], v3 offset:1792
  v_mfma_f32_16x16x32_bf16 v[116:119], v[28:31], v[60:63], v[116:119]
  v_mfma_f32_16x16x32_bf16 v[120:123], v[32:35], v[60:63], v[120:123]
  ds_read_b128 v[88:91], v3 offset:2048
  v_mfma_f32_16x16x32_bf16 v[124:127], v[36:39], v[60:63], v[124:127]
  v_mfma_f32_16x16x32_bf16 v[128:131], v[24:27], v[64:67], v[128:131]
  ds_read_b128 v[92:95], v3 offset:2304
  v_mfma_f32_16x16x32_bf16 v[132:135], v[28:31], v[64:67], v[132:135]
  v_mfma_f32_16x16x32_bf16 v[136:139], v[32:35], v[64:67], v[136:139]
  ds_read_b128 v[56:59], v3 offset:0
  v_mfma_f32_16x16x32_bf16 v[140:143], v[36:39], v[64:67], v[140:143]
  v_mfma_f32_16x16x32_bf16 v[144:147], v[24:27], v[68:71], v[144:147]
  ds_read_b128 v[60:63], v3 offset:256
  v_mfma_f32_16x16x32_bf16 v[148:151], v[28:31], v[68:71], v[148:151]
  v_mfma_f32_16x16x32_bf16 v[152:155], v[32:35], v[68:71], v[152:155]
  ds_read_b128 v[64:67], v3 offset:512
  v_mfma_f32_16x16x32_bf16 v[156:159], v[36:39], v[68:71], v[156:159]
  v_mfma_f32_16x16x32_bf16 v[160:163], v[24:27], v[72:75], v[160:163]
  v_mfma_f32_16x16x32_bf16 v[164:167], v[28:31], v[72:75], v[164:167]
  v_mfma_f32_16x16x32_bf16 v[168:171], v[32:35], v[72:75], v[168:171]
  v_mfma_f32_16x16x32_bf16 v[172:175], v[36:39], v[72:75], v[172:175]
  ds_read_b128 v[68:71], v3 offset:768
  s_add_u32 m0, s3, 49152
  s_nop 0
  buffer_load_dwordx4 v12, s[12:15], s49 offen nt lds
  s_add_u32 m0, s3, 50176
  s_nop 0
  buffer_load_dwordx4 v13, s[12:15], s49 offen nt lds
  s_add_u32 m0, s3, 51200
  s_nop 0
  buffer_load_dwordx4 v14, s[12:15], s49 offen nt lds
  s_add_u32 m0, s3, 52224
  s_nop 0
  buffer_load_dwordx4 v15, s[12:15], s49 offen nt lds
  s_add_u32 s49, s49, 16384
  s_waitcnt vmcnt(12)
  s_waitcnt lgkmcnt(4)
  v_mfma_f32_16x16x32_bf16 v[176:179], v[40:43], v[76:79], v[176:179]
  v_mfma_f32_16x16x32_bf16 v[180:183], v[44:47], v[76:79], v[180:183]
  v_mfma_f32_16x16x32_bf16 v[184:187], v[48:51], v[76:79], v[184:187]
  ds_read_b64_tr_b16 v[24:25], v1 offset:0
  v_mfma_f32_16x16x32_bf16 v[188:191], v[52:55], v[76:79], v[188:191]
  ds_read_b64_tr_b16 v[26:27], v1 offset:512
  v_mfma_f32_16x16x32_bf16 v[192:195], v[40:43], v[80:83], v[192:195]
  ds_read_b128 v[72:75], v3 offset:1024
  v_mfma_f32_16x16x32_bf16 v[196:199], v[44:47], v[80:83], v[196:199]
  ds_read_b64_tr_b16 v[28:29], v2 offset:0
  v_mfma_f32_16x16x32_bf16 v[200:203], v[48:51], v[80:83], v[200:203]
  ds_read_b64_tr_b16 v[30:31], v2 offset:512
  v_mfma_f32_16x16x32_bf16 v[204:207], v[52:55], v[80:83], v[204:207]
  ds_read_b64_tr_b16 v[32:33], v20 offset:0
  v_mfma_f32_16x16x32_bf16 v[208:211], v[40:43], v[84:87], v[208:211]
  ds_read_b64_tr_b16 v[34:35], v20 offset:512
  v_mfma_f32_16x16x32_bf16 v[212:215], v[44:47], v[84:87], v[212:215]
  ds_read_b64_tr_b16 v[36:37], v21 offset:0
  v_mfma_f32_16x16x32_bf16 v[216:219], v[48:51], v[84:87], v[216:219]
  ds_read_b64_tr_b16 v[38:39], v21 offset:512
  v_mfma_f32_16x16x32_bf16 v[220:223], v[52:55], v[84:87], v[220:223]
  v_mfma_f32_16x16x32_bf16 v[224:227], v[40:43], v[88:91], v[224:227]
  v_mfma_f32_16x16x32_bf16 v[228:231], v[44:47], v[88:91], v[228:231]
  v_mfma_f32_16x16x32_bf16 v[232:235], v[48:51], v[88:91], v[232:235]
  v_mfma_f32_16x16x32_bf16 v[236:239], v[52:55], v[88:91], v[236:239]
  v_mfma_f32_16x16x32_bf16 v[240:243], v[40:43], v[92:95], v[240:243]
  v_mfma_f32_16x16x32_bf16 v[244:247], v[44:47], v[92:95], v[244:247]
  v_mfma_f32_16x16x32_bf16 v[248:251], v[48:51], v[92:95], v[248:251]
  v_mfma_f32_16x16x32_bf16 v[252:255], v[52:55], v[92:95], v[252:255]
  s_waitcnt lgkmcnt(0)
  s_barrier
  v_mfma_f32_16x16x32_bf16 v[96:99], v[40:43], v[56:59], v[96:99]
  ds_read_b128 v[76:79], v3 offset:11520
  v_mfma_f32_16x16x32_bf16 v[100:103], v[44:47], v[56:59], v[100:103]
  v_mfma_f32_16x16x32_bf16 v[104:107], v[48:51], v[56:59], v[104:107]
  ds_read_b128 v[80:83], v3 offset:11776
  v_mfma_f32_16x16x32_bf16 v[108:111], v[52:55], v[56:59], v[108:111]
  v_mfma_f32_16x16x32_bf16 v[112:115], v[40:43], v[60:63], v[112:115]
  ds_read_b128 v[84:87], v3 offset:12032
  v_mfma_f32_16x16x32_bf16 v[116:119], v[44:47], v[60:63], v[116:119]
  v_mfma_f32_16x16x32_bf16 v[120:123], v[48:51], v[60:63], v[120:123]
  ds_read_b128 v[88:91], v3 offset:12288
  v_mfma_f32_16x16x32_bf16 v[124:127], v[52:55], v[60:63], v[124:127]
  v_mfma_f32_16x16x32_bf16 v[128:131], v[40:43], v[64:67], v[128:131]
  ds_read_b128 v[92:95], v3 offset:12544
  v_mfma_f32_16x16x32_bf16 v[132:135], v[44:47], v[64:67], v[132:135]
  v_mfma_f32_16x16x32_bf16 v[136:139], v[48:51], v[64:67], v[136:139]
  ds_read_b128 v[56:59], v3 offset:10240
  v_mfma_f32_16x16x32_bf16 v[140:143], v[52:55], v[64:67], v[140:143]
  v_mfma_f32_16x16x32_bf16 v[144:147], v[40:43], v[68:71], v[144:147]
  ds_read_b128 v[60:63], v3 offset:10496
  v_mfma_f32_16x16x32_bf16 v[148:151], v[44:47], v[68:71], v[148:151]
  v_mfma_f32_16x16x32_bf16 v[152:155], v[48:51], v[68:71], v[152:155]
  ds_read_b128 v[64:67], v3 offset:10752
  v_mfma_f32_16x16x32_bf16 v[156:159], v[52:55], v[68:71], v[156:159]
  v_mfma_f32_16x16x32_bf16 v[160:163], v[40:43], v[72:75], v[160:163]
  v_mfma_f32_16x16x32_bf16 v[164:167], v[44:47], v[72:75], v[164:167]
  v_mfma_f32_16x16x32_bf16 v[168:171], v[48:51], v[72:75], v[168:171]
  v_mfma_f32_16x16x32_bf16 v[172:175], v[52:55], v[72:75], v[172:175]
  ds_read_b128 v[68:71], v3 offset:11008
  s_add_u32 m0, s3, 0
  s_nop 0
  buffer_load_dwordx4 v12, s[12:15], s49 offen nt lds
  s_add_u32 m0, s3, 1024
  s_nop 0
  buffer_load_dwordx4 v13, s[12:15], s49 offen nt lds
  s_add_u32 m0, s3, 2048
  s_nop 0
  buffer_load_dwordx4 v14, s[12:15], s49 offen nt lds
  s_add_u32 m0, s3, 3072
  s_nop 0
  buffer_load_dwordx4 v15, s[12:15], s49 offen nt lds
  s_add_u32 s49, s49, 16384
  s_waitcnt vmcnt(12)
  s_waitcnt lgkmcnt(4)
  v_mfma_f32_16x16x32_bf16 v[176:179], v[24:27], v[76:79], v[176:179]
  v_mfma_f32_16x16x32_bf16 v[180:183], v[28:31], v[76:79], v[180:183]
  v_mfma_f32_16x16x32_bf16 v[184:187], v[32:35], v[76:79], v[184:187]
  ds_read_b64_tr_b16 v[40:41], v1 offset:16384
  v_mfma_f32_16x16x32_bf16 v[188:191], v[36:39], v[76:79], v[188:191]
  ds_read_b64_tr_b16 v[42:43], v1 offset:16896
  v_mfma_f32_16x16x32_bf16 v[192:195], v[24:27], v[80:83], v[192:195]
  ds_read_b128 v[72:75], v3 offset:11264
  v_mfma_f32_16x16x32_bf16 v[196:199], v[28:31], v[80:83], v[196:199]
  ds_read_b64_tr_b16 v[44:45], v2 offset:16384
  v_mfma_f32_16x16x32_bf16 v[200:203], v[32:35], v[80:83], v[200:203]
  ds_read_b64_tr_b16 v[46:47], v2 offset:16896
  v_mfma_f32_16x16x32_bf16 v[204:207], v[36:39], v[80:83], v[204:207]
  ds_read_b64_tr_b16 v[48:49], v20 offset:16384
  v_mfma_f32_16x16x32_bf16 v[208:211], v[24:27], v[84:87], v[208:211]
  ds_read_b64_tr_b16 v[50:51], v20 offset:16896
  v_mfma_f32_16x16x32_bf16 v[212:215], v[28:31], v[84:87], v[212:215]
  ds_read_b64_tr_b16 v[52:53], v21 offset:16384
  v_mfma_f32_16x16x32_bf16 v[216:219], v[32:35], v[84:87], v[216:219]
  ds_read_b64_tr_b16 v[54:55], v21 offset:16896
  v_mfma_f32_16x16x32_bf16 v[220:223], v[36:39], v[84:87], v[220:223]
  v_mfma_f32_16x16x32_bf16 v[224:227], v[24:27], v[88:91], v[224:227]
  v_mfma_f32_16x16x32_bf16 v[228:231], v[28:31], v[88:91], v[228:231]
  v_mfma_f32_16x16x32_bf16 v[232:235], v[32:35], v[88:91], v[232:235]
  v_mfma_f32_16x16x32_bf16 v[236:239], v[36:39], v[88:91], v[236:239]
  v_mfma_f32_16x16x32_bf16 v[240:243], v[24:27], v[92:95], v[240:243]
  v_mfma_f32_16x16x32_bf16 v[244:247], v[28:31], v[92:95], v[244:247]
  v_mfma_f32_16x16x32_bf16 v[248:251], v[32:35], v[92:95], v[248:251]
  v_mfma_f32_16x16x32_bf16 v[252:255], v[36:39], v[92:95], v[252:255]
  s_waitcnt lgkmcnt(0)
  s_barrier
  s_sub_u32 s30, s30, 1
  s_cmp_lg_u32 s30, 0
  s_cbranch_scc1 L_PV_loop
  v_mfma_f32_16x16x32_bf16 v[96:99], v[24:27], v[56:59], v[96:99]
  ds_read_b128 v[76:79], v3 offset:1280
  v_mfma_f32_16x16x32_bf16 v[100:103], v[28:31], v[56:59], v[100:103]
  v_mfma_f32_16x16x32_bf16 v[104:107], v[32:35], v[56:59], v[104:107]
  ds_read_b128 v[80:83], v3 offset:1536
  v_mfma_f32_16x16x32_bf16 v[108:111], v[36:39], v[56:59], v[108:111]
  v_mfma_f32_16x16x32_bf16 v[112:115], v[24:27], v[60:63], v[112:115]
  ds_read_b128 v[84:87], v3 offset:1792
  v_mfma_f32_16x16x32_bf16 v[116:119], v[28:31], v[60:63], v[116:119]
  v_mfma_f32_16x16x32_bf16 v[120:123], v[32:35], v[60:63], v[120:123]
  ds_read_b128 v[88:91], v3 offset:2048
  v_mfma_f32_16x16x32_bf16 v[124:127], v[36:39], v[60:63], v[124:127]
  v_mfma_f32_16x16x32_bf16 v[128:131], v[24:27], v[64:67], v[128:131]
  ds_read_b128 v[92:95], v3 offset:2304
  v_mfma_f32_16x16x32_bf16 v[132:135], v[28:31], v[64:67], v[132:135]
  v_mfma_f32_16x16x32_bf16 v[136:139], v[32:35], v[64:67], v[136:139]
  ds_read_b128 v[56:59], v3 offset:0
  v_mfma_f32_16x16x32_bf16 v[140:143], v[36:39], v[64:67], v[140:143]
  v_mfma_f32_16x16x32_bf16 v[144:147], v[24:27], v[68:71], v[144:147]
  ds_read_b128 v[60:63], v3 offset:256
  v_mfma_f32_16x16x32_bf16 v[148:151], v[28:31], v[68:71], v[148:151]
  v_mfma_f32_16x16x32_bf16 v[152:155], v[32:35], v[68:71], v[152:155]
  ds_read_b128 v[64:67], v3 offset:512
  v_mfma_f32_16x16x32_bf16 v[156:159], v[36:39], v[68:71], v[156:159]
  v_mfma_f32_16x16x32_bf16 v[160:163], v[24:27], v[72:75], v[160:163]
  v_mfma_f32_16x16x32_bf16 v[164:167], v[28:31], v[72:75], v[164:167]
  v_mfma_f32_16x16x32_bf16 v[168:171], v[32:35], v[72:75], v[168:171]
  v_mfma_f32_16x16x32_bf16 v[172:175], v[36:39], v[72:75], v[172:175]
  ds_read_b128 v[68:71], v3 offset:768
  s_add_u32 m0, s3, 16384
  s_nop 0
  buffer_load_dwordx4 v12, s[12:15], s49 offen nt lds
  s_add_u32 m0, s3, 17408
  s_nop 0
  buffer_load_dwordx4 v13, s[12:15], s49 offen nt lds
  s_add_u32 m0, s3, 18432
  s_nop 0
  buffer_load_dwordx4 v14, s[12:15], s49 offen nt lds
  s_add_u32 m0, s3, 19456
  s_nop 0
  buffer_load_dwordx4 v15, s[12:15], s49 offen nt lds
  s_add_u32 s49, s49, 16384
  s_waitcnt vmcnt(12)
  s_cmp_lg_u32 s24, 5
  s_cbranch_scc1 L_cwb
  s_getpc_b64 s[54:55]
L_pcb:
  s_lshr_b32 s32, s2, 3
  s_mul_i32 s32, s32, 1280
  s_min_u32 s32, s32, L_codeend - standalone__gqa_block_cached__near_ridge_kernel - 2048
  s_sub_u32 s32, s32, L_pcb - standalone__gqa_block_cached__near_ridge_kernel
  s_ashr_i32 s33, s32, 31
  s_add_u32 s54, s54, s32
  s_addc_u32 s55, s55, s33
  v_lshlrev_b32 v16, 4, v0
  s_mov_b32 m0, 20480
  s_nop 0
  global_load_lds_dwordx4 v16, s[54:55]
  global_load_lds_dwordx4 v16, s[54:55] offset:1024
L_cwb:
  s_cmp_lg_u32 s24, 4
  s_cbranch_scc1 L_rg1
  v_mov_b32 v23, 0
  s_lshl_b32 s33, s25, 5
  buffer_load_dword v22, v23, s[68:71], s33 offen sc1
L_rg1:
  s_waitcnt lgkmcnt(4)
  v_mfma_f32_16x16x32_bf16 v[176:179], v[40:43], v[76:79], v[176:179]
  v_mfma_f32_16x16x32_bf16 v[180:183], v[44:47], v[76:79], v[180:183]
  v_mfma_f32_16x16x32_bf16 v[184:187], v[48:51], v[76:79], v[184:187]
  ds_read_b64_tr_b16 v[24:25], v1 offset:32768
  v_mfma_f32_16x16x32_bf16 v[188:191], v[52:55], v[76:79], v[188:191]
  ds_read_b64_tr_b16 v[26:27], v1 offset:33280
  v_mfma_f32_16x16x32_bf16 v[192:195], v[40:43], v[80:83], v[192:195]
  ds_read_b128 v[72:75], v3 offset:1024
  v_mfma_f32_16x16x32_bf16 v[196:199], v[44:47], v[80:83], v[196:199]
  ds_read_b64_tr_b16 v[28:29], v2 offset:32768
  v_mfma_f32_16x16x32_bf16 v[200:203], v[48:51], v[80:83], v[200:203]
  ds_read_b64_tr_b16 v[30:31], v2 offset:33280
  v_mfma_f32_16x16x32_bf16 v[204:207], v[52:55], v[80:83], v[204:207]
  ds_read_b64_tr_b16 v[32:33], v20 offset:32768
  v_mfma_f32_16x16x32_bf16 v[208:211], v[40:43], v[84:87], v[208:211]
  ds_read_b64_tr_b16 v[34:35], v20 offset:33280
  v_mfma_f32_16x16x32_bf16 v[212:215], v[44:47], v[84:87], v[212:215]
  ds_read_b64_tr_b16 v[36:37], v21 offset:32768
  v_mfma_f32_16x16x32_bf16 v[216:219], v[48:51], v[84:87], v[216:219]
  ds_read_b64_tr_b16 v[38:39], v21 offset:33280
  v_mfma_f32_16x16x32_bf16 v[220:223], v[52:55], v[84:87], v[220:223]
  v_mfma_f32_16x16x32_bf16 v[224:227], v[40:43], v[88:91], v[224:227]
  v_mfma_f32_16x16x32_bf16 v[228:231], v[44:47], v[88:91], v[228:231]
  v_mfma_f32_16x16x32_bf16 v[232:235], v[48:51], v[88:91], v[232:235]
  v_mfma_f32_16x16x32_bf16 v[236:239], v[52:55], v[88:91], v[236:239]
  v_mfma_f32_16x16x32_bf16 v[240:243], v[40:43], v[92:95], v[240:243]
  v_mfma_f32_16x16x32_bf16 v[244:247], v[44:47], v[92:95], v[244:247]
  v_mfma_f32_16x16x32_bf16 v[248:251], v[48:51], v[92:95], v[248:251]
  v_mfma_f32_16x16x32_bf16 v[252:255], v[52:55], v[92:95], v[252:255]
  s_waitcnt lgkmcnt(0)
  s_barrier
  v_mfma_f32_16x16x32_bf16 v[96:99], v[40:43], v[56:59], v[96:99]
  ds_read_b128 v[76:79], v3 offset:11520
  v_mfma_f32_16x16x32_bf16 v[100:103], v[44:47], v[56:59], v[100:103]
  v_mfma_f32_16x16x32_bf16 v[104:107], v[48:51], v[56:59], v[104:107]
  ds_read_b128 v[80:83], v3 offset:11776
  v_mfma_f32_16x16x32_bf16 v[108:111], v[52:55], v[56:59], v[108:111]
  v_mfma_f32_16x16x32_bf16 v[112:115], v[40:43], v[60:63], v[112:115]
  ds_read_b128 v[84:87], v3 offset:12032
  v_mfma_f32_16x16x32_bf16 v[116:119], v[44:47], v[60:63], v[116:119]
  v_mfma_f32_16x16x32_bf16 v[120:123], v[48:51], v[60:63], v[120:123]
  ds_read_b128 v[88:91], v3 offset:12288
  v_mfma_f32_16x16x32_bf16 v[124:127], v[52:55], v[60:63], v[124:127]
  v_mfma_f32_16x16x32_bf16 v[128:131], v[40:43], v[64:67], v[128:131]
  ds_read_b128 v[92:95], v3 offset:12544
  v_mfma_f32_16x16x32_bf16 v[132:135], v[44:47], v[64:67], v[132:135]
  v_mfma_f32_16x16x32_bf16 v[136:139], v[48:51], v[64:67], v[136:139]
  ds_read_b128 v[56:59], v3 offset:10240
  v_mfma_f32_16x16x32_bf16 v[140:143], v[52:55], v[64:67], v[140:143]
  v_mfma_f32_16x16x32_bf16 v[144:147], v[40:43], v[68:71], v[144:147]
  ds_read_b128 v[60:63], v3 offset:10496
  v_mfma_f32_16x16x32_bf16 v[148:151], v[44:47], v[68:71], v[148:151]
  v_mfma_f32_16x16x32_bf16 v[152:155], v[48:51], v[68:71], v[152:155]
  ds_read_b128 v[64:67], v3 offset:10752
  v_mfma_f32_16x16x32_bf16 v[156:159], v[52:55], v[68:71], v[156:159]
  v_mfma_f32_16x16x32_bf16 v[160:163], v[40:43], v[72:75], v[160:163]
  v_mfma_f32_16x16x32_bf16 v[164:167], v[44:47], v[72:75], v[164:167]
  v_mfma_f32_16x16x32_bf16 v[168:171], v[48:51], v[72:75], v[168:171]
  v_mfma_f32_16x16x32_bf16 v[172:175], v[52:55], v[72:75], v[172:175]
  ds_read_b128 v[68:71], v3 offset:11008
  s_add_u32 m0, s3, 32768
  s_nop 0
  buffer_load_dwordx4 v12, s[12:15], s49 offen nt lds
  s_add_u32 m0, s3, 33792
  s_nop 0
  buffer_load_dwordx4 v13, s[12:15], s49 offen nt lds
  s_add_u32 m0, s3, 34816
  s_nop 0
  buffer_load_dwordx4 v14, s[12:15], s49 offen nt lds
  s_add_u32 m0, s3, 35840
  s_nop 0
  buffer_load_dwordx4 v15, s[12:15], s49 offen nt lds
  s_add_u32 s49, s49, 16384
  s_waitcnt vmcnt(12)
  s_add_u32 m0, s36, 20480
  s_nop 0
  buffer_load_dwordx4 v17, s[20:23], s53 offen sc1 lds
  s_add_u32 s53, s53, 4096
  s_nop 0
  buffer_load_dwordx4 v17, s[20:23], s53 offen sc1 lds
  s_add_u32 s53, s53, 4096
  s_nop 0
  buffer_load_dwordx4 v17, s[20:23], s53 offen sc1 lds
  s_add_u32 s53, s53, 4096
  s_waitcnt lgkmcnt(4)
  v_mfma_f32_16x16x32_bf16 v[176:179], v[24:27], v[76:79], v[176:179]
  v_mfma_f32_16x16x32_bf16 v[180:183], v[28:31], v[76:79], v[180:183]
  v_mfma_f32_16x16x32_bf16 v[184:187], v[32:35], v[76:79], v[184:187]
  ds_read_b64_tr_b16 v[40:41], v1 offset:49152
  v_mfma_f32_16x16x32_bf16 v[188:191], v[36:39], v[76:79], v[188:191]
  ds_read_b64_tr_b16 v[42:43], v1 offset:49664
  v_mfma_f32_16x16x32_bf16 v[192:195], v[24:27], v[80:83], v[192:195]
  ds_read_b128 v[72:75], v3 offset:11264
  v_mfma_f32_16x16x32_bf16 v[196:199], v[28:31], v[80:83], v[196:199]
  ds_read_b64_tr_b16 v[44:45], v2 offset:49152
  v_mfma_f32_16x16x32_bf16 v[200:203], v[32:35], v[80:83], v[200:203]
  ds_read_b64_tr_b16 v[46:47], v2 offset:49664
  v_mfma_f32_16x16x32_bf16 v[204:207], v[36:39], v[80:83], v[204:207]
  ds_read_b64_tr_b16 v[48:49], v20 offset:49152
  v_mfma_f32_16x16x32_bf16 v[208:211], v[24:27], v[84:87], v[208:211]
  ds_read_b64_tr_b16 v[50:51], v20 offset:49664
  v_mfma_f32_16x16x32_bf16 v[212:215], v[28:31], v[84:87], v[212:215]
  ds_read_b64_tr_b16 v[52:53], v21 offset:49152
  v_mfma_f32_16x16x32_bf16 v[216:219], v[32:35], v[84:87], v[216:219]
  ds_read_b64_tr_b16 v[54:55], v21 offset:49664
  v_mfma_f32_16x16x32_bf16 v[220:223], v[36:39], v[84:87], v[220:223]
  v_mfma_f32_16x16x32_bf16 v[224:227], v[24:27], v[88:91], v[224:227]
  v_mfma_f32_16x16x32_bf16 v[228:231], v[28:31], v[88:91], v[228:231]
  v_mfma_f32_16x16x32_bf16 v[232:235], v[32:35], v[88:91], v[232:235]
  v_mfma_f32_16x16x32_bf16 v[236:239], v[36:39], v[88:91], v[236:239]
  v_mfma_f32_16x16x32_bf16 v[240:243], v[24:27], v[92:95], v[240:243]
  v_mfma_f32_16x16x32_bf16 v[244:247], v[28:31], v[92:95], v[244:247]
  v_mfma_f32_16x16x32_bf16 v[248:251], v[32:35], v[92:95], v[248:251]
  v_mfma_f32_16x16x32_bf16 v[252:255], v[36:39], v[92:95], v[252:255]
  s_waitcnt lgkmcnt(0)
  s_barrier
  v_mfma_f32_16x16x32_bf16 v[96:99], v[24:27], v[56:59], v[96:99]
  ds_read_b128 v[76:79], v3 offset:1280
  v_mfma_f32_16x16x32_bf16 v[100:103], v[28:31], v[56:59], v[100:103]
  v_mfma_f32_16x16x32_bf16 v[104:107], v[32:35], v[56:59], v[104:107]
  ds_read_b128 v[80:83], v3 offset:1536
  v_mfma_f32_16x16x32_bf16 v[108:111], v[36:39], v[56:59], v[108:111]
  v_mfma_f32_16x16x32_bf16 v[112:115], v[24:27], v[60:63], v[112:115]
  ds_read_b128 v[84:87], v3 offset:1792
  v_mfma_f32_16x16x32_bf16 v[116:119], v[28:31], v[60:63], v[116:119]
  v_mfma_f32_16x16x32_bf16 v[120:123], v[32:35], v[60:63], v[120:123]
  ds_read_b128 v[88:91], v3 offset:2048
  v_mfma_f32_16x16x32_bf16 v[124:127], v[36:39], v[60:63], v[124:127]
  v_mfma_f32_16x16x32_bf16 v[128:131], v[24:27], v[64:67], v[128:131]
  ds_read_b128 v[92:95], v3 offset:2304
  v_mfma_f32_16x16x32_bf16 v[132:135], v[28:31], v[64:67], v[132:135]
  v_mfma_f32_16x16x32_bf16 v[136:139], v[32:35], v[64:67], v[136:139]
  ds_read_b128 v[56:59], v3 offset:0
  v_mfma_f32_16x16x32_bf16 v[140:143], v[36:39], v[64:67], v[140:143]
  v_mfma_f32_16x16x32_bf16 v[144:147], v[24:27], v[68:71], v[144:147]
  ds_read_b128 v[60:63], v3 offset:256
  v_mfma_f32_16x16x32_bf16 v[148:151], v[28:31], v[68:71], v[148:151]
  v_mfma_f32_16x16x32_bf16 v[152:155], v[32:35], v[68:71], v[152:155]
  ds_read_b128 v[64:67], v3 offset:512
  v_mfma_f32_16x16x32_bf16 v[156:159], v[36:39], v[68:71], v[156:159]
  v_mfma_f32_16x16x32_bf16 v[160:163], v[24:27], v[72:75], v[160:163]
  v_mfma_f32_16x16x32_bf16 v[164:167], v[28:31], v[72:75], v[164:167]
  v_mfma_f32_16x16x32_bf16 v[168:171], v[32:35], v[72:75], v[168:171]
  v_mfma_f32_16x16x32_bf16 v[172:175], v[36:39], v[72:75], v[172:175]
  ds_read_b128 v[68:71], v3 offset:768
  s_waitcnt vmcnt(11)
  s_add_u32 m0, s36, 20480
  s_nop 0
  buffer_load_dwordx4 v17, s[20:23], s53 offen sc1 lds
  s_add_u32 s53, s53, 4096
  s_nop 0
  buffer_load_dwordx4 v17, s[20:23], s53 offen sc1 lds
  s_add_u32 s53, s53, 4096
  s_nop 0
  buffer_load_dwordx4 v17, s[20:23], s53 offen sc1 lds
  s_add_u32 s53, s53, 4096
  s_nop 0
  buffer_load_dwordx4 v17, s[20:23], s53 offen sc1 lds
  s_add_u32 s53, s53, 4096
  s_waitcnt lgkmcnt(4)
  v_mfma_f32_16x16x32_bf16 v[176:179], v[40:43], v[76:79], v[176:179]
  v_mfma_f32_16x16x32_bf16 v[180:183], v[44:47], v[76:79], v[180:183]
  v_mfma_f32_16x16x32_bf16 v[184:187], v[48:51], v[76:79], v[184:187]
  ds_read_b64_tr_b16 v[24:25], v1 offset:0
  v_mfma_f32_16x16x32_bf16 v[188:191], v[52:55], v[76:79], v[188:191]
  ds_read_b64_tr_b16 v[26:27], v1 offset:512
  v_mfma_f32_16x16x32_bf16 v[192:195], v[40:43], v[80:83], v[192:195]
  ds_read_b128 v[72:75], v3 offset:1024
  v_mfma_f32_16x16x32_bf16 v[196:199], v[44:47], v[80:83], v[196:199]
  ds_read_b64_tr_b16 v[28:29], v2 offset:0
  v_mfma_f32_16x16x32_bf16 v[200:203], v[48:51], v[80:83], v[200:203]
  ds_read_b64_tr_b16 v[30:31], v2 offset:512
  v_mfma_f32_16x16x32_bf16 v[204:207], v[52:55], v[80:83], v[204:207]
  ds_read_b64_tr_b16 v[32:33], v20 offset:0
  v_mfma_f32_16x16x32_bf16 v[208:211], v[40:43], v[84:87], v[208:211]
  ds_read_b64_tr_b16 v[34:35], v20 offset:512
  v_mfma_f32_16x16x32_bf16 v[212:215], v[44:47], v[84:87], v[212:215]
  ds_read_b64_tr_b16 v[36:37], v21 offset:0
  v_mfma_f32_16x16x32_bf16 v[216:219], v[48:51], v[84:87], v[216:219]
  ds_read_b64_tr_b16 v[38:39], v21 offset:512
  v_mfma_f32_16x16x32_bf16 v[220:223], v[52:55], v[84:87], v[220:223]
  v_mfma_f32_16x16x32_bf16 v[224:227], v[40:43], v[88:91], v[224:227]
  v_mfma_f32_16x16x32_bf16 v[228:231], v[44:47], v[88:91], v[228:231]
  v_mfma_f32_16x16x32_bf16 v[232:235], v[48:51], v[88:91], v[232:235]
  v_mfma_f32_16x16x32_bf16 v[236:239], v[52:55], v[88:91], v[236:239]
  v_mfma_f32_16x16x32_bf16 v[240:243], v[40:43], v[92:95], v[240:243]
  v_mfma_f32_16x16x32_bf16 v[244:247], v[44:47], v[92:95], v[244:247]
  v_mfma_f32_16x16x32_bf16 v[248:251], v[48:51], v[92:95], v[248:251]
  v_mfma_f32_16x16x32_bf16 v[252:255], v[52:55], v[92:95], v[252:255]
  s_waitcnt lgkmcnt(0)
  s_barrier
  v_mfma_f32_16x16x32_bf16 v[96:99], v[40:43], v[56:59], v[96:99]
  ds_read_b128 v[76:79], v3 offset:11520
  v_mfma_f32_16x16x32_bf16 v[100:103], v[44:47], v[56:59], v[100:103]
  v_mfma_f32_16x16x32_bf16 v[104:107], v[48:51], v[56:59], v[104:107]
  ds_read_b128 v[80:83], v3 offset:11776
  v_mfma_f32_16x16x32_bf16 v[108:111], v[52:55], v[56:59], v[108:111]
  v_mfma_f32_16x16x32_bf16 v[112:115], v[40:43], v[60:63], v[112:115]
  ds_read_b128 v[84:87], v3 offset:12032
  v_mfma_f32_16x16x32_bf16 v[116:119], v[44:47], v[60:63], v[116:119]
  v_mfma_f32_16x16x32_bf16 v[120:123], v[48:51], v[60:63], v[120:123]
  ds_read_b128 v[88:91], v3 offset:12288
  v_mfma_f32_16x16x32_bf16 v[124:127], v[52:55], v[60:63], v[124:127]
  v_mfma_f32_16x16x32_bf16 v[128:131], v[40:43], v[64:67], v[128:131]
  ds_read_b128 v[92:95], v3 offset:12544
  v_mfma_f32_16x16x32_bf16 v[132:135], v[44:47], v[64:67], v[132:135]
  v_mfma_f32_16x16x32_bf16 v[136:139], v[48:51], v[64:67], v[136:139]
  ds_read_b128 v[56:59], v3 offset:10240
  v_mfma_f32_16x16x32_bf16 v[140:143], v[52:55], v[64:67], v[140:143]
  v_mfma_f32_16x16x32_bf16 v[144:147], v[40:43], v[68:71], v[144:147]
  ds_read_b128 v[60:63], v3 offset:10496
  v_mfma_f32_16x16x32_bf16 v[148:151], v[44:47], v[68:71], v[148:151]
  v_mfma_f32_16x16x32_bf16 v[152:155], v[48:51], v[68:71], v[152:155]
  ds_read_b128 v[64:67], v3 offset:10752
  v_mfma_f32_16x16x32_bf16 v[156:159], v[52:55], v[68:71], v[156:159]
  v_mfma_f32_16x16x32_bf16 v[160:163], v[40:43], v[72:75], v[160:163]
  v_mfma_f32_16x16x32_bf16 v[164:167], v[44:47], v[72:75], v[164:167]
  v_mfma_f32_16x16x32_bf16 v[168:171], v[48:51], v[72:75], v[168:171]
  v_mfma_f32_16x16x32_bf16 v[172:175], v[52:55], v[72:75], v[172:175]
  ds_read_b128 v[68:71], v3 offset:11008
  s_waitcnt vmcnt(11)
  s_add_u32 m0, s36, 20480
  s_nop 0
  buffer_load_dwordx4 v17, s[20:23], s53 offen sc1 lds
  s_add_u32 s53, s53, 4096
  s_nop 0
  buffer_load_dwordx4 v17, s[20:23], s53 offen sc1 lds
  s_add_u32 s53, s53, 4096
  s_nop 0
  buffer_load_dwordx4 v17, s[20:23], s53 offen sc1 lds
  s_add_u32 s53, s53, 4096
  s_and_b32 s53, s36, 1024
  s_add_u32 s53, s53, s64
  s_add_u32 s53, s53, 71680
  buffer_load_dwordx4 v17, s[20:23], s53 offen sc1 lds
  s_add_u32 s53, s53, 4096
  s_waitcnt lgkmcnt(4)
  v_mfma_f32_16x16x32_bf16 v[176:179], v[24:27], v[76:79], v[176:179]
  v_mfma_f32_16x16x32_bf16 v[180:183], v[28:31], v[76:79], v[180:183]
  v_mfma_f32_16x16x32_bf16 v[184:187], v[32:35], v[76:79], v[184:187]
  ds_read_b64_tr_b16 v[40:41], v1 offset:16384
  v_mfma_f32_16x16x32_bf16 v[188:191], v[36:39], v[76:79], v[188:191]
  ds_read_b64_tr_b16 v[42:43], v1 offset:16896
  v_mfma_f32_16x16x32_bf16 v[192:195], v[24:27], v[80:83], v[192:195]
  ds_read_b128 v[72:75], v3 offset:11264
  v_mfma_f32_16x16x32_bf16 v[196:199], v[28:31], v[80:83], v[196:199]
  ds_read_b64_tr_b16 v[44:45], v2 offset:16384
  v_mfma_f32_16x16x32_bf16 v[200:203], v[32:35], v[80:83], v[200:203]
  ds_read_b64_tr_b16 v[46:47], v2 offset:16896
  v_mfma_f32_16x16x32_bf16 v[204:207], v[36:39], v[80:83], v[204:207]
  ds_read_b64_tr_b16 v[48:49], v20 offset:16384
  v_mfma_f32_16x16x32_bf16 v[208:211], v[24:27], v[84:87], v[208:211]
  ds_read_b64_tr_b16 v[50:51], v20 offset:16896
  v_mfma_f32_16x16x32_bf16 v[212:215], v[28:31], v[84:87], v[212:215]
  ds_read_b64_tr_b16 v[52:53], v21 offset:16384
  v_mfma_f32_16x16x32_bf16 v[216:219], v[32:35], v[84:87], v[216:219]
  ds_read_b64_tr_b16 v[54:55], v21 offset:16896
  v_mfma_f32_16x16x32_bf16 v[220:223], v[36:39], v[84:87], v[220:223]
  v_mfma_f32_16x16x32_bf16 v[224:227], v[24:27], v[88:91], v[224:227]
  v_mfma_f32_16x16x32_bf16 v[228:231], v[28:31], v[88:91], v[228:231]
  v_mfma_f32_16x16x32_bf16 v[232:235], v[32:35], v[88:91], v[232:235]
  v_mfma_f32_16x16x32_bf16 v[236:239], v[36:39], v[88:91], v[236:239]
  v_mfma_f32_16x16x32_bf16 v[240:243], v[24:27], v[92:95], v[240:243]
  v_mfma_f32_16x16x32_bf16 v[244:247], v[28:31], v[92:95], v[244:247]
  v_mfma_f32_16x16x32_bf16 v[248:251], v[32:35], v[92:95], v[248:251]
  v_mfma_f32_16x16x32_bf16 v[252:255], v[36:39], v[92:95], v[252:255]
  s_waitcnt lgkmcnt(0)
  s_barrier
  v_mfma_f32_16x16x32_bf16 v[96:99], v[24:27], v[56:59], v[96:99]
  ds_read_b128 v[76:79], v3 offset:1280
  v_mfma_f32_16x16x32_bf16 v[100:103], v[28:31], v[56:59], v[100:103]
  v_mfma_f32_16x16x32_bf16 v[104:107], v[32:35], v[56:59], v[104:107]
  ds_read_b128 v[80:83], v3 offset:1536
  v_mfma_f32_16x16x32_bf16 v[108:111], v[36:39], v[56:59], v[108:111]
  v_mfma_f32_16x16x32_bf16 v[112:115], v[24:27], v[60:63], v[112:115]
  ds_read_b128 v[84:87], v3 offset:1792
  v_mfma_f32_16x16x32_bf16 v[116:119], v[28:31], v[60:63], v[116:119]
  v_mfma_f32_16x16x32_bf16 v[120:123], v[32:35], v[60:63], v[120:123]
  ds_read_b128 v[88:91], v3 offset:2048
  v_mfma_f32_16x16x32_bf16 v[124:127], v[36:39], v[60:63], v[124:127]
  v_mfma_f32_16x16x32_bf16 v[128:131], v[24:27], v[64:67], v[128:131]
  ds_read_b128 v[92:95], v3 offset:2304
  v_mfma_f32_16x16x32_bf16 v[132:135], v[28:31], v[64:67], v[132:135]
  v_mfma_f32_16x16x32_bf16 v[136:139], v[32:35], v[64:67], v[136:139]
  ds_read_b128 v[56:59], v3 offset:0
  v_mfma_f32_16x16x32_bf16 v[140:143], v[36:39], v[64:67], v[140:143]
  v_mfma_f32_16x16x32_bf16 v[144:147], v[24:27], v[68:71], v[144:147]
  ds_read_b128 v[60:63], v3 offset:256
  v_mfma_f32_16x16x32_bf16 v[148:151], v[28:31], v[68:71], v[148:151]
  v_mfma_f32_16x16x32_bf16 v[152:155], v[32:35], v[68:71], v[152:155]
  ds_read_b128 v[64:67], v3 offset:512
  v_mfma_f32_16x16x32_bf16 v[156:159], v[36:39], v[68:71], v[156:159]
  v_mfma_f32_16x16x32_bf16 v[160:163], v[24:27], v[72:75], v[160:163]
  v_mfma_f32_16x16x32_bf16 v[164:167], v[28:31], v[72:75], v[164:167]
  v_mfma_f32_16x16x32_bf16 v[168:171], v[32:35], v[72:75], v[168:171]
  v_mfma_f32_16x16x32_bf16 v[172:175], v[36:39], v[72:75], v[172:175]
  ds_read_b128 v[68:71], v3 offset:768
  s_waitcnt vmcnt(11)
  s_cmp_lg_u32 s24, 4
  s_cbranch_scc1 L_regdone
  s_getreg_b32 s34, hwreg(HW_REG_XCC_ID)
  s_and_b32 s34, s34, 15
  s_mul_i32 s33, s34, s34
  s_lshl_b32 s33, s33, 23
  s_lshl_b32 s34, s34, 13
  s_add_u32 s34, s34, s33
  s_add_u32 s34, s34, 32
  s_lshl_b32 s33, s25, 5
  s_mov_b32 s30, 0x40000
  v_mov_b32 v23, 0
L_regpoll:
  v_readfirstlane_b32 s32, v22
  s_sub_u32 s30, s30, 1
  s_cmp_eq_u32 s30, 0
  s_cbranch_scc1 L_regok
  s_and_b32 s35, s32, 0xff
  s_cmp_ge_u32 s35, 32
  s_cbranch_scc1 L_regok
  s_sleep 8
  buffer_load_dword v22, v23, s[68:71], s33 offen sc1
  s_waitcnt vmcnt(0)
  s_branch L_regpoll
L_regok:
  s_cmp_eq_u32 s32, s34
  s_cselect_b32 s67, 1, 0
  v_mov_b32 v23, 30976
  v_mov_b32 v22, s67
  s_waitcnt lgkmcnt(0)
  ds_write_b32 v23, v22
  s_waitcnt lgkmcnt(0)
L_regdone:
  s_waitcnt lgkmcnt(4)
  v_mfma_f32_16x16x32_bf16 v[176:179], v[40:43], v[76:79], v[176:179]
  v_mfma_f32_16x16x32_bf16 v[180:183], v[44:47], v[76:79], v[180:183]
  v_mfma_f32_16x16x32_bf16 v[184:187], v[48:51], v[76:79], v[184:187]
  ds_read_b64_tr_b16 v[24:25], v1 offset:32768
  v_mfma_f32_16x16x32_bf16 v[188:191], v[52:55], v[76:79], v[188:191]
  ds_read_b64_tr_b16 v[26:27], v1 offset:33280
  v_mfma_f32_16x16x32_bf16 v[192:195], v[40:43], v[80:83], v[192:195]
  ds_read_b128 v[72:75], v3 offset:1024
  v_mfma_f32_16x16x32_bf16 v[196:199], v[44:47], v[80:83], v[196:199]
  ds_read_b64_tr_b16 v[28:29], v2 offset:32768
  v_mfma_f32_16x16x32_bf16 v[200:203], v[48:51], v[80:83], v[200:203]
  ds_read_b64_tr_b16 v[30:31], v2 offset:33280
  v_mfma_f32_16x16x32_bf16 v[204:207], v[52:55], v[80:83], v[204:207]
  ds_read_b64_tr_b16 v[32:33], v20 offset:32768
  v_mfma_f32_16x16x32_bf16 v[208:211], v[40:43], v[84:87], v[208:211]
  ds_read_b64_tr_b16 v[34:35], v20 offset:33280
  v_mfma_f32_16x16x32_bf16 v[212:215], v[44:47], v[84:87], v[212:215]
  ds_read_b64_tr_b16 v[36:37], v21 offset:32768
  v_mfma_f32_16x16x32_bf16 v[216:219], v[48:51], v[84:87], v[216:219]
  ds_read_b64_tr_b16 v[38:39], v21 offset:33280
  v_mfma_f32_16x16x32_bf16 v[220:223], v[52:55], v[84:87], v[220:223]
  v_mfma_f32_16x16x32_bf16 v[224:227], v[40:43], v[88:91], v[224:227]
  v_mfma_f32_16x16x32_bf16 v[228:231], v[44:47], v[88:91], v[228:231]
  v_mfma_f32_16x16x32_bf16 v[232:235], v[48:51], v[88:91], v[232:235]
  v_mfma_f32_16x16x32_bf16 v[236:239], v[52:55], v[88:91], v[236:239]
  v_mfma_f32_16x16x32_bf16 v[240:243], v[40:43], v[92:95], v[240:243]
  v_mfma_f32_16x16x32_bf16 v[244:247], v[44:47], v[92:95], v[244:247]
  v_mfma_f32_16x16x32_bf16 v[248:251], v[48:51], v[92:95], v[248:251]
  v_mfma_f32_16x16x32_bf16 v[252:255], v[52:55], v[92:95], v[252:255]
  s_waitcnt lgkmcnt(0)
  s_barrier
  v_mfma_f32_16x16x32_bf16 v[96:99], v[40:43], v[56:59], v[96:99]
  ds_read_b128 v[76:79], v3 offset:11520
  v_mfma_f32_16x16x32_bf16 v[100:103], v[44:47], v[56:59], v[100:103]
  v_mfma_f32_16x16x32_bf16 v[104:107], v[48:51], v[56:59], v[104:107]
  ds_read_b128 v[80:83], v3 offset:11776
  v_mfma_f32_16x16x32_bf16 v[108:111], v[52:55], v[56:59], v[108:111]
  v_mfma_f32_16x16x32_bf16 v[112:115], v[40:43], v[60:63], v[112:115]
  ds_read_b128 v[84:87], v3 offset:12032
  v_mfma_f32_16x16x32_bf16 v[116:119], v[44:47], v[60:63], v[116:119]
  v_mfma_f32_16x16x32_bf16 v[120:123], v[48:51], v[60:63], v[120:123]
  ds_read_b128 v[88:91], v3 offset:12288
  v_mfma_f32_16x16x32_bf16 v[124:127], v[52:55], v[60:63], v[124:127]
  v_mfma_f32_16x16x32_bf16 v[128:131], v[40:43], v[64:67], v[128:131]
  ds_read_b128 v[92:95], v3 offset:12544
  v_mfma_f32_16x16x32_bf16 v[132:135], v[44:47], v[64:67], v[132:135]
  v_mfma_f32_16x16x32_bf16 v[136:139], v[48:51], v[64:67], v[136:139]
  ds_read_b128 v[56:59], v3 offset:10240
  v_mfma_f32_16x16x32_bf16 v[140:143], v[52:55], v[64:67], v[140:143]
  v_mfma_f32_16x16x32_bf16 v[144:147], v[40:43], v[68:71], v[144:147]
  ds_read_b128 v[60:63], v3 offset:10496
  v_mfma_f32_16x16x32_bf16 v[148:151], v[44:47], v[68:71], v[148:151]
  v_mfma_f32_16x16x32_bf16 v[152:155], v[48:51], v[68:71], v[152:155]
  ds_read_b128 v[64:67], v3 offset:10752
  v_mfma_f32_16x16x32_bf16 v[156:159], v[52:55], v[68:71], v[156:159]
  v_mfma_f32_16x16x32_bf16 v[160:163], v[40:43], v[72:75], v[160:163]
  v_mfma_f32_16x16x32_bf16 v[164:167], v[44:47], v[72:75], v[164:167]
  v_mfma_f32_16x16x32_bf16 v[168:171], v[48:51], v[72:75], v[168:171]
  v_mfma_f32_16x16x32_bf16 v[172:175], v[52:55], v[72:75], v[172:175]
  ds_read_b128 v[68:71], v3 offset:11008
  s_waitcnt lgkmcnt(4)
  v_mfma_f32_16x16x32_bf16 v[176:179], v[24:27], v[76:79], v[176:179]
  v_mfma_f32_16x16x32_bf16 v[180:183], v[28:31], v[76:79], v[180:183]
  v_mfma_f32_16x16x32_bf16 v[184:187], v[32:35], v[76:79], v[184:187]
  ds_read_b128 v[72:75], v3 offset:11264
  v_mfma_f32_16x16x32_bf16 v[188:191], v[36:39], v[76:79], v[188:191]
  s_mul_i32 s35, s46, 10240
  s_add_u32 s34, s64, s35
  v_mfma_f32_16x16x32_bf16 v[192:195], v[24:27], v[80:83], v[192:195]
  v_mfma_f32_16x16x32_bf16 v[196:199], v[28:31], v[80:83], v[196:199]
  v_mfma_f32_16x16x32_bf16 v[200:203], v[32:35], v[80:83], v[200:203]
  v_mfma_f32_16x16x32_bf16 v[204:207], v[36:39], v[80:83], v[204:207]
  v_cvt_pk_bf16_f32 v176, v176, v177
  v_cvt_pk_bf16_f32 v177, v178, v179
  v_cvt_pk_bf16_f32 v178, v180, v181
  v_cvt_pk_bf16_f32 v179, v182, v183
  v_mfma_f32_16x16x32_bf16 v[208:211], v[24:27], v[84:87], v[208:211]
  s_add_u32 s32, s34, 0
  buffer_store_dwordx4 v[176:179], v17, s[20:23], s32 offen
  v_mfma_f32_16x16x32_bf16 v[212:215], v[28:31], v[84:87], v[212:215]
  v_cvt_pk_bf16_f32 v184, v184, v185
  v_cvt_pk_bf16_f32 v185, v186, v187
  v_cvt_pk_bf16_f32 v186, v188, v189
  v_cvt_pk_bf16_f32 v187, v190, v191
  v_mfma_f32_16x16x32_bf16 v[216:219], v[32:35], v[84:87], v[216:219]
  s_add_u32 s32, s34, 1024
  buffer_store_dwordx4 v[184:187], v17, s[20:23], s32 offen
  v_mfma_f32_16x16x32_bf16 v[220:223], v[36:39], v[84:87], v[220:223]
  v_cvt_pk_bf16_f32 v192, v192, v193
  v_cvt_pk_bf16_f32 v193, v194, v195
  v_cvt_pk_bf16_f32 v194, v196, v197
  v_cvt_pk_bf16_f32 v195, v198, v199
  v_mfma_f32_16x16x32_bf16 v[224:227], v[24:27], v[88:91], v[224:227]
  s_add_u32 s32, s34, 2048
  buffer_store_dwordx4 v[192:195], v17, s[20:23], s32 offen
  v_mfma_f32_16x16x32_bf16 v[228:231], v[28:31], v[88:91], v[228:231]
  v_cvt_pk_bf16_f32 v200, v200, v201
  v_cvt_pk_bf16_f32 v201, v202, v203
  v_cvt_pk_bf16_f32 v202, v204, v205
  v_cvt_pk_bf16_f32 v203, v206, v207
  v_mfma_f32_16x16x32_bf16 v[232:235], v[32:35], v[88:91], v[232:235]
  s_add_u32 s32, s34, 3072
  buffer_store_dwordx4 v[200:203], v17, s[20:23], s32 offen
  v_mfma_f32_16x16x32_bf16 v[236:239], v[36:39], v[88:91], v[236:239]
  v_cvt_pk_bf16_f32 v208, v208, v209
  v_cvt_pk_bf16_f32 v209, v210, v211
  v_cvt_pk_bf16_f32 v210, v212, v213
  v_cvt_pk_bf16_f32 v211, v214, v215
  v_mfma_f32_16x16x32_bf16 v[240:243], v[24:27], v[92:95], v[240:243]
  s_add_u32 s32, s34, 4096
  buffer_store_dwordx4 v[208:211], v17, s[20:23], s32 offen
  v_mfma_f32_16x16x32_bf16 v[244:247], v[28:31], v[92:95], v[244:247]
  v_cvt_pk_bf16_f32 v216, v216, v217
  v_cvt_pk_bf16_f32 v217, v218, v219
  v_cvt_pk_bf16_f32 v218, v220, v221
  v_cvt_pk_bf16_f32 v219, v222, v223
  v_mfma_f32_16x16x32_bf16 v[248:251], v[32:35], v[92:95], v[248:251]
  s_add_u32 s32, s34, 5120
  buffer_store_dwordx4 v[216:219], v17, s[20:23], s32 offen
  v_mfma_f32_16x16x32_bf16 v[252:255], v[36:39], v[92:95], v[252:255]
  v_cvt_pk_bf16_f32 v224, v224, v225
  v_cvt_pk_bf16_f32 v225, v226, v227
  v_cvt_pk_bf16_f32 v226, v228, v229
  v_cvt_pk_bf16_f32 v227, v230, v231
  s_add_u32 s32, s34, 6144
  buffer_store_dwordx4 v[224:227], v17, s[20:23], s32 offen
  v_cvt_pk_bf16_f32 v232, v232, v233
  v_cvt_pk_bf16_f32 v233, v234, v235
  v_cvt_pk_bf16_f32 v234, v236, v237
  v_cvt_pk_bf16_f32 v235, v238, v239
  s_add_u32 s32, s34, 7168
  buffer_store_dwordx4 v[232:235], v17, s[20:23], s32 offen
  v_cvt_pk_bf16_f32 v240, v240, v241
  v_cvt_pk_bf16_f32 v241, v242, v243
  v_cvt_pk_bf16_f32 v242, v244, v245
  v_cvt_pk_bf16_f32 v243, v246, v247
  s_add_u32 s32, s34, 8192
  buffer_store_dwordx4 v[240:243], v17, s[20:23], s32 offen
  v_cvt_pk_bf16_f32 v248, v248, v249
  v_cvt_pk_bf16_f32 v249, v250, v251
  v_cvt_pk_bf16_f32 v250, v252, v253
  v_cvt_pk_bf16_f32 v251, v254, v255
  s_add_u32 s32, s34, 9216
  buffer_store_dwordx4 v[248:251], v17, s[20:23], s32 offen
  s_waitcnt lgkmcnt(0)
  s_barrier
  v_lshlrev_b32 v17, 3, v0
  v_min_u32 v18, 31, v0
  v_lshlrev_b32 v18, 3, v18
  v_add_u32 v17, 28672, v17
  v_add_u32 v18, 28672, v18
  ds_read_b64 v[76:77], v17
  ds_read_b64 v[82:83], v17 offset:512
  ds_read_b64 v[78:79], v18 offset:1024
  v_mov_b32 v17, 30976
  ds_read_b32 v80, v17
  v_lshlrev_b32 v84, 4, v0
  v_mfma_f32_16x16x32_bf16 v[96:99], v[24:27], v[56:59], v[96:99]
  v_mfma_f32_16x16x32_bf16 v[100:103], v[28:31], v[56:59], v[100:103]
  v_mfma_f32_16x16x32_bf16 v[104:107], v[32:35], v[56:59], v[104:107]
  v_mfma_f32_16x16x32_bf16 v[108:111], v[36:39], v[56:59], v[108:111]
  v_mfma_f32_16x16x32_bf16 v[112:115], v[24:27], v[60:63], v[112:115]
  v_mfma_f32_16x16x32_bf16 v[116:119], v[28:31], v[60:63], v[116:119]
  v_mfma_f32_16x16x32_bf16 v[120:123], v[32:35], v[60:63], v[120:123]
  v_mfma_f32_16x16x32_bf16 v[124:127], v[36:39], v[60:63], v[124:127]
  s_waitcnt lgkmcnt(0)
  v_readfirstlane_b32 s67, v80
  v_add_f32 v76, v76, v77
  v_add_f32 v82, v82, v83
  v_add_f32 v78, v78, v79
  v_cmp_ge_f32 s[50:51], s48, v76
  v_cmp_ge_f32 s[52:53], s48, v82
  v_cmp_ge_f32 s[54:55], s48, v78
  s_nop 0
  s_and_b64 s[50:51], s[50:51], s[52:53]
  s_and_b64 s[50:51], s[50:51], s[54:55]
  s_cmp_eq_u64 s[50:51], -1
  s_cbranch_scc1 L_PV_ok
  s_cmp_eq_u32 s31, 0
  s_cbranch_scc1 L_PV_fallback
L_PV_ok:
  v_lshlrev_b32 v9, 4, v0
  v_and_b32 v16, 15, v0
  v_lshlrev_b32 v8, 4, v16
  v_lshlrev_b32 v18, 3, v16
  v_lshlrev_b32 v16, 2, v16
  v_add_u32 v10, 28672, v18
  v_add_u32 v11, 29952, v16
  v_mfma_f32_16x16x32_bf16 v[128:131], v[24:27], v[64:67], v[128:131]
  v_mfma_f32_16x16x32_bf16 v[132:135], v[28:31], v[64:67], v[132:135]
  v_mfma_f32_16x16x32_bf16 v[136:139], v[32:35], v[64:67], v[136:139]
  v_mfma_f32_16x16x32_bf16 v[140:143], v[36:39], v[64:67], v[140:143]
  v_mfma_f32_16x16x32_bf16 v[144:147], v[24:27], v[68:71], v[144:147]
  v_mfma_f32_16x16x32_bf16 v[148:151], v[28:31], v[68:71], v[148:151]
  v_mfma_f32_16x16x32_bf16 v[152:155], v[32:35], v[68:71], v[152:155]
  v_mfma_f32_16x16x32_bf16 v[156:159], v[36:39], v[68:71], v[156:159]
  v_mfma_f32_16x16x32_bf16 v[160:163], v[24:27], v[72:75], v[160:163]
  v_mfma_f32_16x16x32_bf16 v[164:167], v[28:31], v[72:75], v[164:167]
  v_mfma_f32_16x16x32_bf16 v[168:171], v[32:35], v[72:75], v[168:171]
  v_mfma_f32_16x16x32_bf16 v[172:175], v[36:39], v[72:75], v[172:175]
  ds_read_b64 v[76:77], v10 offset:0
  ds_read_b32 v78, v11 offset:0
  ds_read_b64 v[80:81], v10 offset:128
  ds_read_b32 v82, v11 offset:64
  ds_read_b64 v[84:85], v10 offset:256
  ds_read_b32 v86, v11 offset:128
  ds_read_b64 v[88:89], v10 offset:384
  ds_read_b32 v90, v11 offset:192
  ds_read_b64 v[92:93], v10 offset:512
  ds_read_b32 v94, v11 offset:256
  s_waitcnt vmcnt(0) lgkmcnt(0)
  s_barrier
  v_and_b32 v16, 15, v0
  v_lshrrev_b32 v17, 4, v0
  v_lshrrev_b32 v18, 2, v16
  v_lshl_add_u32 v20, v17, 3, v18
  v_lshlrev_b32 v20, 7, v20
  v_and_b32 v21, 3, v0
  v_lshl_add_u32 v20, v21, 3, v20
  v_lshrrev_b32 v18, 1, v18
  v_and_b32 v21, 1, v17
  v_lshl_add_u32 v18, v21, 1, v18
  v_xor_b32 v18, s46, v18
  v_lshl_add_u32 v1, v18, 5, v20
  v_add_u32 v2, 0x10000, v1
  v_add_u32 v3, 0x20000, v1
  s_lshl_b32 s33, s46, 9
  s_cmp_eq_u32 s67, 1
  s_cselect_b32 s50, s65, s43
  s_add_u32 s50, s50, s33
  s_lshl_b32 s33, s27, 11
  s_add_u32 s51, s50, s33
  s_sub_u32 s52, s50, s33
  v_lshrrev_b32 v18, 1, v17
  v_lshlrev_b32 v18, 8, v18
  v_lshl_add_u32 v18, v16, 4, v18
  v_mul_u32_u24 v22, 14336, v21
  v_xor_b32 v13, 64, v19
  v_add_u32 v14, v22, v18
  v_lshl_add_u32 v15, v21, 3, v18
  s_lshl_b32 s32, s24, 6
  v_add_u32 v12, s32, v0
  s_cmp_lg_u32 s24, 4
  s_cbranch_scc1 L_px_done
  v_mov_b32 v28, 1
  s_lshl_b32 s33, s26, 2
  s_add_u32 s33, s33, 64
  v_mov_b32 v27, s33
  v_mov_b32 v29, v27
  s_xor_b32 s34, s66, 128
  s_mov_b32 s30, 0x40000
  s_mov_b64 exec, 1
  s_cmp_eq_u32 s67, 1
  s_cbranch_scc1 L_px_loc
  buffer_wbl2 sc1
  s_waitcnt vmcnt(0)
  buffer_store_dword v28, v27, s[20:23], s66 offen sc1
  s_branch L_px_sent
L_px_loc:
  buffer_store_dword v28, v27, s[20:23], s66 offen
L_px_sent:
  s_mov_b64 exec, 0x1
L_px_poll:
  buffer_load_dword v30, v29, s[20:23], s34 offen sc1
  s_waitcnt vmcnt(0)
  v_cmp_ne_u32 vcc, 1, v30
  s_sub_u32 s30, s30, 1
  s_cmp_eq_u32 s30, 0
  s_cbranch_scc1 L_px_got
  s_cmp_eq_u64 vcc, 0
  s_cbranch_scc1 L_px_got
  s_sleep 2
  s_branch L_px_poll
L_px_got:
  s_mov_b64 exec, -1
  s_cmp_eq_u32 s67, 1
  s_cbranch_scc1 L_px_done
  buffer_inv sc1
  s_waitcnt vmcnt(0)
L_px_done:
  s_barrier
  s_add_u32 s32, s65, 71680
  s_add_u32 s34, s65, s35
  buffer_load_dwordx4 v[56:59], v8, s[20:23], s32 offen offset:0 sc1
  buffer_load_dwordx4 v[60:63], v8, s[20:23], s32 offen offset:256 sc1
  buffer_load_dwordx4 v[64:67], v8, s[20:23], s32 offen offset:512 sc1
  buffer_load_dwordx4 v[68:71], v8, s[20:23], s32 offen offset:768 sc1
  buffer_load_dwordx4 v[72:75], v8, s[20:23], s32 offen offset:1024 sc1
  s_add_u32 s32, s34, 0
  buffer_load_dwordx4 v[176:179], v9, s[20:23], s32 offen sc1
  s_add_u32 s32, s34, 1024
  buffer_load_dwordx4 v[180:183], v9, s[20:23], s32 offen sc1
  s_add_u32 s32, s34, 2048
  buffer_load_dwordx4 v[184:187], v9, s[20:23], s32 offen sc1
  s_add_u32 s32, s34, 3072
  buffer_load_dwordx4 v[188:191], v9, s[20:23], s32 offen sc1
  s_add_u32 s32, s34, 4096
  buffer_load_dwordx4 v[192:195], v9, s[20:23], s32 offen sc1
  s_add_u32 s32, s34, 5120
  buffer_load_dwordx4 v[196:199], v9, s[20:23], s32 offen sc1
  s_add_u32 s32, s34, 6144
  buffer_load_dwordx4 v[200:203], v9, s[20:23], s32 offen sc1
  s_add_u32 s32, s34, 7168
  buffer_load_dwordx4 v[204:207], v9, s[20:23], s32 offen sc1
  s_add_u32 s32, s34, 8192
  buffer_load_dwordx4 v[208:211], v9, s[20:23], s32 offen sc1
  s_add_u32 s32, s34, 9216
  buffer_load_dwordx4 v[212:215], v9, s[20:23], s32 offen sc1
  s_barrier
  s_waitcnt vmcnt(10) lgkmcnt(0)
  v_add_f32 v57, v57, v59
  v_add_f32 v61, v61, v63
  v_add_f32 v65, v65, v67
  v_add_f32 v69, v69, v71
  v_add_f32 v73, v73, v75
  v_add_f32 v76, v76, v77
  v_add_f32 v80, v80, v81
  v_add_f32 v84, v84, v85
  v_add_f32 v88, v88, v89
  v_add_f32 v92, v92, v93
  v_sub_f32 v77, v78, v56
  v_sub_f32 v81, v82, v60
  v_sub_f32 v85, v86, v64
  v_sub_f32 v89, v90, v68
  v_sub_f32 v93, v94, v72
  v_sub_f32 v78, v56, v78
  v_sub_f32 v82, v60, v82
  v_sub_f32 v86, v64, v86
  v_sub_f32 v90, v68, v90
  v_sub_f32 v94, v72, v94
  v_exp_f32 v77, v77
  v_exp_f32 v81, v81
  v_exp_f32 v85, v85
  v_exp_f32 v89, v89
  v_exp_f32 v93, v93
  v_exp_f32 v78, v78
  v_exp_f32 v82, v82
  v_exp_f32 v86, v86
  v_exp_f32 v90, v90
  v_exp_f32 v94, v94
  v_fma_f32 v77, v77, v57, v76
  v_fma_f32 v81, v81, v61, v80
  v_fma_f32 v85, v85, v65, v84
  v_fma_f32 v89, v89, v69, v88
  v_fma_f32 v93, v93, v73, v92
  v_fma_f32 v78, v78, v76, v57
  v_fma_f32 v82, v82, v80, v61
  v_fma_f32 v86, v86, v84, v65
  v_fma_f32 v90, v90, v88, v69
  v_fma_f32 v94, v94, v92, v73
  v_rcp_f32 v76, v77
  v_rcp_f32 v80, v81
  v_rcp_f32 v84, v85
  v_rcp_f32 v88, v89
  v_rcp_f32 v92, v93
  v_rcp_f32 v78, v78
  v_rcp_f32 v82, v82
  v_rcp_f32 v86, v86
  v_rcp_f32 v90, v90
  v_rcp_f32 v94, v94
  v_pk_mul_f32 v[96:97], v[76:77], v[96:97] op_sel_hi:[0,1]
  v_pk_mul_f32 v[98:99], v[76:77], v[98:99] op_sel_hi:[0,1]
  v_pk_mul_f32 v[100:101], v[76:77], v[100:101] op_sel_hi:[0,1]
  v_pk_mul_f32 v[102:103], v[76:77], v[102:103] op_sel_hi:[0,1]
  v_pk_mul_f32 v[104:105], v[76:77], v[104:105] op_sel_hi:[0,1]
  v_pk_mul_f32 v[106:107], v[76:77], v[106:107] op_sel_hi:[0,1]
  v_pk_mul_f32 v[108:109], v[76:77], v[108:109] op_sel_hi:[0,1]
  v_pk_mul_f32 v[110:111], v[76:77], v[110:111] op_sel_hi:[0,1]
  s_waitcnt vmcnt(8)
  v_lshlrev_b32 v24, 16, v176
  v_and_b32 v25, 0xffff0000, v176
  v_lshlrev_b32 v26, 16, v177
  v_and_b32 v27, 0xffff0000, v177
  v_lshlrev_b32 v28, 16, v178
  v_and_b32 v29, 0xffff0000, v178
  v_lshlrev_b32 v30, 16, v179
  v_and_b32 v31, 0xffff0000, v179
  v_lshlrev_b32 v32, 16, v180
  v_and_b32 v33, 0xffff0000, v180
  v_lshlrev_b32 v34, 16, v181
  v_and_b32 v35, 0xffff0000, v181
  v_lshlrev_b32 v36, 16, v182
  v_and_b32 v37, 0xffff0000, v182
  v_lshlrev_b32 v38, 16, v183
  v_and_b32 v39, 0xffff0000, v183
  v_pk_fma_f32 v[96:97], v[78:79], v[24:25], v[96:97] op_sel_hi:[0,1,1]
  v_pk_fma_f32 v[98:99], v[78:79], v[26:27], v[98:99] op_sel_hi:[0,1,1]
  v_pk_fma_f32 v[100:101], v[78:79], v[28:29], v[100:101] op_sel_hi:[0,1,1]
  v_pk_fma_f32 v[102:103], v[78:79], v[30:31], v[102:103] op_sel_hi:[0,1,1]
  v_pk_fma_f32 v[104:105], v[78:79], v[32:33], v[104:105] op_sel_hi:[0,1,1]
  v_pk_fma_f32 v[106:107], v[78:79], v[34:35], v[106:107] op_sel_hi:[0,1,1]
  v_pk_fma_f32 v[108:109], v[78:79], v[36:37], v[108:109] op_sel_hi:[0,1,1]
  v_pk_fma_f32 v[110:111], v[78:79], v[38:39], v[110:111] op_sel_hi:[0,1,1]
  v_cvt_pk_bf16_f32 v24, v96, v97
  v_cvt_pk_bf16_f32 v25, v98, v99
  v_cvt_pk_bf16_f32 v26, v100, v101
  v_cvt_pk_bf16_f32 v27, v102, v103
  v_cvt_pk_bf16_f32 v28, v104, v105
  v_cvt_pk_bf16_f32 v29, v106, v107
  v_cvt_pk_bf16_f32 v30, v108, v109
  v_cvt_pk_bf16_f32 v31, v110, v111
  ds_write_b64 v4, v[24:25] offset:0
  ds_write_b64 v5, v[26:27] offset:0
  ds_write_b64 v6, v[28:29] offset:0
  ds_write_b64 v7, v[30:31] offset:0
  v_pk_mul_f32 v[112:113], v[80:81], v[112:113] op_sel_hi:[0,1]
  v_pk_mul_f32 v[114:115], v[80:81], v[114:115] op_sel_hi:[0,1]
  v_pk_mul_f32 v[116:117], v[80:81], v[116:117] op_sel_hi:[0,1]
  v_pk_mul_f32 v[118:119], v[80:81], v[118:119] op_sel_hi:[0,1]
  v_pk_mul_f32 v[120:121], v[80:81], v[120:121] op_sel_hi:[0,1]
  v_pk_mul_f32 v[122:123], v[80:81], v[122:123] op_sel_hi:[0,1]
  v_pk_mul_f32 v[124:125], v[80:81], v[124:125] op_sel_hi:[0,1]
  v_pk_mul_f32 v[126:127], v[80:81], v[126:127] op_sel_hi:[0,1]
  s_waitcnt vmcnt(6)
  v_lshlrev_b32 v40, 16, v184
  v_and_b32 v41, 0xffff0000, v184
  v_lshlrev_b32 v42, 16, v185
  v_and_b32 v43, 0xffff0000, v185
  v_lshlrev_b32 v44, 16, v186
  v_and_b32 v45, 0xffff0000, v186
  v_lshlrev_b32 v46, 16, v187
  v_and_b32 v47, 0xffff0000, v187
  v_lshlrev_b32 v48, 16, v188
  v_and_b32 v49, 0xffff0000, v188
  v_lshlrev_b32 v50, 16, v189
  v_and_b32 v51, 0xffff0000, v189
  v_lshlrev_b32 v52, 16, v190
  v_and_b32 v53, 0xffff0000, v190
  v_lshlrev_b32 v54, 16, v191
  v_and_b32 v55, 0xffff0000, v191
  v_pk_fma_f32 v[112:113], v[82:83], v[40:41], v[112:113] op_sel_hi:[0,1,1]
  v_pk_fma_f32 v[114:115], v[82:83], v[42:43], v[114:115] op_sel_hi:[0,1,1]
  v_pk_fma_f32 v[116:117], v[82:83], v[44:45], v[116:117] op_sel_hi:[0,1,1]
  v_pk_fma_f32 v[118:119], v[82:83], v[46:47], v[118:119] op_sel_hi:[0,1,1]
  v_pk_fma_f32 v[120:121], v[82:83], v[48:49], v[120:121] op_sel_hi:[0,1,1]
  v_pk_fma_f32 v[122:123], v[82:83], v[50:51], v[122:123] op_sel_hi:[0,1,1]
  v_pk_fma_f32 v[124:125], v[82:83], v[52:53], v[124:125] op_sel_hi:[0,1,1]
  v_pk_fma_f32 v[126:127], v[82:83], v[54:55], v[126:127] op_sel_hi:[0,1,1]
  v_cvt_pk_bf16_f32 v40, v112, v113
  v_cvt_pk_bf16_f32 v41, v114, v115
  v_cvt_pk_bf16_f32 v42, v116, v117
  v_cvt_pk_bf16_f32 v43, v118, v119
  v_cvt_pk_bf16_f32 v44, v120, v121
  v_cvt_pk_bf16_f32 v45, v122, v123
  v_cvt_pk_bf16_f32 v46, v124, v125
  v_cvt_pk_bf16_f32 v47, v126, v127
  ds_write_b64 v4, v[40:41] offset:8192
  ds_write_b64 v5, v[42:43] offset:8192
  ds_write_b64 v6, v[44:45] offset:8192
  ds_write_b64 v7, v[46:47] offset:8192
  v_pk_mul_f32 v[128:129], v[84:85], v[128:129] op_sel_hi:[0,1]
  v_pk_mul_f32 v[130:131], v[84:85], v[130:131] op_sel_hi:[0,1]
  v_pk_mul_f32 v[132:133], v[84:85], v[132:133] op_sel_hi:[0,1]
  v_pk_mul_f32 v[134:135], v[84:85], v[134:135] op_sel_hi:[0,1]
  v_pk_mul_f32 v[136:137], v[84:85], v[136:137] op_sel_hi:[0,1]
  v_pk_mul_f32 v[138:139], v[84:85], v[138:139] op_sel_hi:[0,1]
  v_pk_mul_f32 v[140:141], v[84:85], v[140:141] op_sel_hi:[0,1]
  v_pk_mul_f32 v[142:143], v[84:85], v[142:143] op_sel_hi:[0,1]
  s_waitcnt vmcnt(4)
  v_lshlrev_b32 v24, 16, v192
  v_and_b32 v25, 0xffff0000, v192
  v_lshlrev_b32 v26, 16, v193
  v_and_b32 v27, 0xffff0000, v193
  v_lshlrev_b32 v28, 16, v194
  v_and_b32 v29, 0xffff0000, v194
  v_lshlrev_b32 v30, 16, v195
  v_and_b32 v31, 0xffff0000, v195
  v_lshlrev_b32 v32, 16, v196
  v_and_b32 v33, 0xffff0000, v196
  v_lshlrev_b32 v34, 16, v197
  v_and_b32 v35, 0xffff0000, v197
  v_lshlrev_b32 v36, 16, v198
  v_and_b32 v37, 0xffff0000, v198
  v_lshlrev_b32 v38, 16, v199
  v_and_b32 v39, 0xffff0000, v199
  v_pk_fma_f32 v[128:129], v[86:87], v[24:25], v[128:129] op_sel_hi:[0,1,1]
  v_pk_fma_f32 v[130:131], v[86:87], v[26:27], v[130:131] op_sel_hi:[0,1,1]
  v_pk_fma_f32 v[132:133], v[86:87], v[28:29], v[132:133] op_sel_hi:[0,1,1]
  v_pk_fma_f32 v[134:135], v[86:87], v[30:31], v[134:135] op_sel_hi:[0,1,1]
  v_pk_fma_f32 v[136:137], v[86:87], v[32:33], v[136:137] op_sel_hi:[0,1,1]
  v_pk_fma_f32 v[138:139], v[86:87], v[34:35], v[138:139] op_sel_hi:[0,1,1]
  v_pk_fma_f32 v[140:141], v[86:87], v[36:37], v[140:141] op_sel_hi:[0,1,1]
  v_pk_fma_f32 v[142:143], v[86:87], v[38:39], v[142:143] op_sel_hi:[0,1,1]
  v_cvt_pk_bf16_f32 v24, v128, v129
  v_cvt_pk_bf16_f32 v25, v130, v131
  v_cvt_pk_bf16_f32 v26, v132, v133
  v_cvt_pk_bf16_f32 v27, v134, v135
  v_cvt_pk_bf16_f32 v28, v136, v137
  v_cvt_pk_bf16_f32 v29, v138, v139
  v_cvt_pk_bf16_f32 v30, v140, v141
  v_cvt_pk_bf16_f32 v31, v142, v143
  ds_write_b64 v4, v[24:25] offset:16384
  ds_write_b64 v5, v[26:27] offset:16384
  ds_write_b64 v6, v[28:29] offset:16384
  ds_write_b64 v7, v[30:31] offset:16384
  v_pk_mul_f32 v[144:145], v[88:89], v[144:145] op_sel_hi:[0,1]
  v_pk_mul_f32 v[146:147], v[88:89], v[146:147] op_sel_hi:[0,1]
  v_pk_mul_f32 v[148:149], v[88:89], v[148:149] op_sel_hi:[0,1]
  v_pk_mul_f32 v[150:151], v[88:89], v[150:151] op_sel_hi:[0,1]
  v_pk_mul_f32 v[152:153], v[88:89], v[152:153] op_sel_hi:[0,1]
  v_pk_mul_f32 v[154:155], v[88:89], v[154:155] op_sel_hi:[0,1]
  v_pk_mul_f32 v[156:157], v[88:89], v[156:157] op_sel_hi:[0,1]
  v_pk_mul_f32 v[158:159], v[88:89], v[158:159] op_sel_hi:[0,1]
  s_waitcnt vmcnt(2)
  v_lshlrev_b32 v40, 16, v200
  v_and_b32 v41, 0xffff0000, v200
  v_lshlrev_b32 v42, 16, v201
  v_and_b32 v43, 0xffff0000, v201
  v_lshlrev_b32 v44, 16, v202
  v_and_b32 v45, 0xffff0000, v202
  v_lshlrev_b32 v46, 16, v203
  v_and_b32 v47, 0xffff0000, v203
  v_lshlrev_b32 v48, 16, v204
  v_and_b32 v49, 0xffff0000, v204
  v_lshlrev_b32 v50, 16, v205
  v_and_b32 v51, 0xffff0000, v205
  v_lshlrev_b32 v52, 16, v206
  v_and_b32 v53, 0xffff0000, v206
  v_lshlrev_b32 v54, 16, v207
  v_and_b32 v55, 0xffff0000, v207
  v_pk_fma_f32 v[144:145], v[90:91], v[40:41], v[144:145] op_sel_hi:[0,1,1]
  v_pk_fma_f32 v[146:147], v[90:91], v[42:43], v[146:147] op_sel_hi:[0,1,1]
  v_pk_fma_f32 v[148:149], v[90:91], v[44:45], v[148:149] op_sel_hi:[0,1,1]
  v_pk_fma_f32 v[150:151], v[90:91], v[46:47], v[150:151] op_sel_hi:[0,1,1]
  v_pk_fma_f32 v[152:153], v[90:91], v[48:49], v[152:153] op_sel_hi:[0,1,1]
  v_pk_fma_f32 v[154:155], v[90:91], v[50:51], v[154:155] op_sel_hi:[0,1,1]
  v_pk_fma_f32 v[156:157], v[90:91], v[52:53], v[156:157] op_sel_hi:[0,1,1]
  v_pk_fma_f32 v[158:159], v[90:91], v[54:55], v[158:159] op_sel_hi:[0,1,1]
  v_cvt_pk_bf16_f32 v40, v144, v145
  v_cvt_pk_bf16_f32 v41, v146, v147
  v_cvt_pk_bf16_f32 v42, v148, v149
  v_cvt_pk_bf16_f32 v43, v150, v151
  v_cvt_pk_bf16_f32 v44, v152, v153
  v_cvt_pk_bf16_f32 v45, v154, v155
  v_cvt_pk_bf16_f32 v46, v156, v157
  v_cvt_pk_bf16_f32 v47, v158, v159
  ds_write_b64 v4, v[40:41] offset:24576
  ds_write_b64 v5, v[42:43] offset:24576
  ds_write_b64 v6, v[44:45] offset:24576
  ds_write_b64 v7, v[46:47] offset:24576
  v_pk_mul_f32 v[160:161], v[92:93], v[160:161] op_sel_hi:[0,1]
  v_pk_mul_f32 v[162:163], v[92:93], v[162:163] op_sel_hi:[0,1]
  v_pk_mul_f32 v[164:165], v[92:93], v[164:165] op_sel_hi:[0,1]
  v_pk_mul_f32 v[166:167], v[92:93], v[166:167] op_sel_hi:[0,1]
  v_pk_mul_f32 v[168:169], v[92:93], v[168:169] op_sel_hi:[0,1]
  v_pk_mul_f32 v[170:171], v[92:93], v[170:171] op_sel_hi:[0,1]
  v_pk_mul_f32 v[172:173], v[92:93], v[172:173] op_sel_hi:[0,1]
  v_pk_mul_f32 v[174:175], v[92:93], v[174:175] op_sel_hi:[0,1]
  s_waitcnt vmcnt(0)
  v_lshlrev_b32 v24, 16, v208
  v_and_b32 v25, 0xffff0000, v208
  v_lshlrev_b32 v26, 16, v209
  v_and_b32 v27, 0xffff0000, v209
  v_lshlrev_b32 v28, 16, v210
  v_and_b32 v29, 0xffff0000, v210
  v_lshlrev_b32 v30, 16, v211
  v_and_b32 v31, 0xffff0000, v211
  v_lshlrev_b32 v32, 16, v212
  v_and_b32 v33, 0xffff0000, v212
  v_lshlrev_b32 v34, 16, v213
  v_and_b32 v35, 0xffff0000, v213
  v_lshlrev_b32 v36, 16, v214
  v_and_b32 v37, 0xffff0000, v214
  v_lshlrev_b32 v38, 16, v215
  v_and_b32 v39, 0xffff0000, v215
  v_pk_fma_f32 v[160:161], v[94:95], v[24:25], v[160:161] op_sel_hi:[0,1,1]
  v_pk_fma_f32 v[162:163], v[94:95], v[26:27], v[162:163] op_sel_hi:[0,1,1]
  v_pk_fma_f32 v[164:165], v[94:95], v[28:29], v[164:165] op_sel_hi:[0,1,1]
  v_pk_fma_f32 v[166:167], v[94:95], v[30:31], v[166:167] op_sel_hi:[0,1,1]
  v_pk_fma_f32 v[168:169], v[94:95], v[32:33], v[168:169] op_sel_hi:[0,1,1]
  v_pk_fma_f32 v[170:171], v[94:95], v[34:35], v[170:171] op_sel_hi:[0,1,1]
  v_pk_fma_f32 v[172:173], v[94:95], v[36:37], v[172:173] op_sel_hi:[0,1,1]
  v_pk_fma_f32 v[174:175], v[94:95], v[38:39], v[174:175] op_sel_hi:[0,1,1]
  v_cvt_pk_bf16_f32 v24, v160, v161
  v_cvt_pk_bf16_f32 v25, v162, v163
  v_cvt_pk_bf16_f32 v26, v164, v165
  v_cvt_pk_bf16_f32 v27, v166, v167
  v_cvt_pk_bf16_f32 v28, v168, v169
  v_cvt_pk_bf16_f32 v29, v170, v171
  v_cvt_pk_bf16_f32 v30, v172, v173
  v_cvt_pk_bf16_f32 v31, v174, v175
  ds_write_b64 v4, v[24:25] offset:32768
  ds_write_b64 v5, v[26:27] offset:32768
  ds_write_b64 v6, v[28:29] offset:32768
  ds_write_b64 v7, v[30:31] offset:32768
  s_waitcnt lgkmcnt(0)
  s_barrier
  ds_read_b128 v[96:99], v19 offset:0
  ds_read_b128 v[128:131], v19 offset:8192
  ds_read_b128 v[160:163], v19 offset:16384
  ds_read_b128 v[192:195], v19 offset:24576
  ds_read_b128 v[224:227], v19 offset:32768
  ds_read_b64_tr_b16 v[36:37], v2 offset:32768
  ds_read_b64_tr_b16 v[38:39], v2 offset:33280
  ds_read_b128 v[100:103], v13 offset:0
  ds_read_b128 v[132:135], v13 offset:8192
  ds_read_b128 v[164:167], v13 offset:16384
  ds_read_b128 v[196:199], v13 offset:24576
  ds_read_b128 v[228:231], v13 offset:32768
  ds_read_b64_tr_b16 v[40:41], v2 offset:36864
  ds_read_b64_tr_b16 v[42:43], v2 offset:37376
  s_waitcnt lgkmcnt(7)
  v_mfma_f32_16x16x32_bf16 v[56:59], v[36:39], v[96:99], 0
  ds_read_b128 v[104:107], v19 offset:2048
  ds_read_b128 v[136:139], v19 offset:10240
  v_mfma_f32_16x16x32_bf16 v[60:63], v[36:39], v[128:131], 0
  ds_read_b128 v[168:171], v19 offset:18432
  ds_read_b128 v[200:203], v19 offset:26624
  v_mfma_f32_16x16x32_bf16 v[64:67], v[36:39], v[160:163], 0
  ds_read_b128 v[232:235], v19 offset:34816
  ds_read_b64_tr_b16 v[44:45], v2 offset:40960
  v_mfma_f32_16x16x32_bf16 v[68:71], v[36:39], v[192:195], 0
  ds_read_b64_tr_b16 v[46:47], v2 offset:41472
  v_mfma_f32_16x16x32_bf16 v[72:75], v[36:39], v[224:227], 0
  s_waitcnt lgkmcnt(7)
  v_mfma_f32_16x16x32_bf16 v[56:59], v[40:43], v[100:103], v[56:59]
  ds_read_b128 v[108:111], v13 offset:2048
  ds_read_b128 v[140:143], v13 offset:10240
  v_mfma_f32_16x16x32_bf16 v[60:63], v[40:43], v[132:135], v[60:63]
  ds_read_b128 v[172:175], v13 offset:18432
  ds_read_b128 v[204:207], v13 offset:26624
  v_mfma_f32_16x16x32_bf16 v[64:67], v[40:43], v[164:167], v[64:67]
  ds_read_b128 v[236:239], v13 offset:34816
  ds_read_b64_tr_b16 v[48:49], v2 offset:45056
  v_mfma_f32_16x16x32_bf16 v[68:71], v[40:43], v[196:199], v[68:71]
  ds_read_b64_tr_b16 v[50:51], v2 offset:45568
  v_mfma_f32_16x16x32_bf16 v[72:75], v[40:43], v[228:231], v[72:75]
  s_waitcnt lgkmcnt(7)
  v_mfma_f32_16x16x32_bf16 v[56:59], v[44:47], v[104:107], v[56:59]
  ds_read_b128 v[112:115], v19 offset:4096
  ds_read_b128 v[144:147], v19 offset:12288
  v_mfma_f32_16x16x32_bf16 v[60:63], v[44:47], v[136:139], v[60:63]
  ds_read_b128 v[176:179], v19 offset:20480
  ds_read_b128 v[208:211], v19 offset:28672
  v_mfma_f32_16x16x32_bf16 v[64:67], v[44:47], v[168:171], v[64:67]
  ds_read_b128 v[240:243], v19 offset:36864
  ds_read_b64_tr_b16 v[36:37], v2 offset:49152
  v_mfma_f32_16x16x32_bf16 v[68:71], v[44:47], v[200:203], v[68:71]
  ds_read_b64_tr_b16 v[38:39], v2 offset:49664
  v_mfma_f32_16x16x32_bf16 v[72:75], v[44:47], v[232:235], v[72:75]
  s_waitcnt lgkmcnt(7)
  v_mfma_f32_16x16x32_bf16 v[56:59], v[48:51], v[108:111], v[56:59]
  ds_read_b128 v[116:119], v13 offset:4096
  ds_read_b128 v[148:151], v13 offset:12288
  v_mfma_f32_16x16x32_bf16 v[60:63], v[48:51], v[140:143], v[60:63]
  ds_read_b128 v[180:183], v13 offset:20480
  ds_read_b128 v[212:215], v13 offset:28672
  v_mfma_f32_16x16x32_bf16 v[64:67], v[48:51], v[172:175], v[64:67]
  ds_read_b128 v[244:247], v13 offset:36864
  ds_read_b64_tr_b16 v[40:41], v2 offset:53248
  v_mfma_f32_16x16x32_bf16 v[68:71], v[48:51], v[204:207], v[68:71]
  ds_read_b64_tr_b16 v[42:43], v2 offset:53760
  v_mfma_f32_16x16x32_bf16 v[72:75], v[48:51], v[236:239], v[72:75]
  s_waitcnt lgkmcnt(7)
  v_mfma_f32_16x16x32_bf16 v[56:59], v[36:39], v[112:115], v[56:59]
  ds_read_b128 v[120:123], v19 offset:6144
  ds_read_b128 v[152:155], v19 offset:14336
  v_mfma_f32_16x16x32_bf16 v[60:63], v[36:39], v[144:147], v[60:63]
  ds_read_b128 v[184:187], v19 offset:22528
  ds_read_b128 v[216:219], v19 offset:30720
  v_mfma_f32_16x16x32_bf16 v[64:67], v[36:39], v[176:179], v[64:67]
  ds_read_b128 v[248:251], v19 offset:38912
  ds_read_b64_tr_b16 v[44:45], v2 offset:57344
  v_mfma_f32_16x16x32_bf16 v[68:71], v[36:39], v[208:211], v[68:71]
  ds_read_b64_tr_b16 v[46:47], v2 offset:57856
  v_mfma_f32_16x16x32_bf16 v[72:75], v[36:39], v[240:243], v[72:75]
  s_waitcnt lgkmcnt(7)
  v_mfma_f32_16x16x32_bf16 v[56:59], v[40:43], v[116:119], v[56:59]
  ds_read_b128 v[124:127], v13 offset:6144
  ds_read_b128 v[156:159], v13 offset:14336
  v_mfma_f32_16x16x32_bf16 v[60:63], v[40:43], v[148:151], v[60:63]
  ds_read_b128 v[188:191], v13 offset:22528
  ds_read_b128 v[220:223], v13 offset:30720
  v_mfma_f32_16x16x32_bf16 v[64:67], v[40:43], v[180:183], v[64:67]
  ds_read_b128 v[252:255], v13 offset:38912
  ds_read_b64_tr_b16 v[48:49], v2 offset:61440
  v_mfma_f32_16x16x32_bf16 v[68:71], v[40:43], v[212:215], v[68:71]
  ds_read_b64_tr_b16 v[50:51], v2 offset:61952
  v_mfma_f32_16x16x32_bf16 v[72:75], v[40:43], v[244:247], v[72:75]
  s_barrier
  s_waitcnt lgkmcnt(7)
  v_mfma_f32_16x16x32_bf16 v[56:59], v[44:47], v[120:123], v[56:59]
  ds_read_b64_tr_b16 v[36:37], v3 offset:0
  v_mfma_f32_16x16x32_bf16 v[60:63], v[44:47], v[152:155], v[60:63]
  ds_read_b64_tr_b16 v[38:39], v3 offset:512
  v_mfma_f32_16x16x32_bf16 v[64:67], v[44:47], v[184:187], v[64:67]
  v_mfma_f32_16x16x32_bf16 v[68:71], v[44:47], v[216:219], v[68:71]
  v_mfma_f32_16x16x32_bf16 v[72:75], v[44:47], v[248:251], v[72:75]
  s_waitcnt lgkmcnt(2)
  v_mfma_f32_16x16x32_bf16 v[56:59], v[48:51], v[124:127], v[56:59]
  ds_read_b64_tr_b16 v[40:41], v3 offset:4096
  v_mfma_f32_16x16x32_bf16 v[60:63], v[48:51], v[156:159], v[60:63]
  ds_read_b64_tr_b16 v[42:43], v3 offset:4608
  v_mfma_f32_16x16x32_bf16 v[64:67], v[48:51], v[188:191], v[64:67]
  v_mfma_f32_16x16x32_bf16 v[68:71], v[48:51], v[220:223], v[68:71]
  v_mfma_f32_16x16x32_bf16 v[72:75], v[48:51], v[252:255], v[72:75]
  s_waitcnt lgkmcnt(2)
  v_mfma_f32_16x16x32_bf16 v[76:79], v[36:39], v[96:99], 0
  ds_read_b64_tr_b16 v[44:45], v3 offset:8192
  v_mfma_f32_16x16x32_bf16 v[80:83], v[36:39], v[128:131], 0
  ds_read_b64_tr_b16 v[46:47], v3 offset:8704
  v_mfma_f32_16x16x32_bf16 v[84:87], v[36:39], v[160:163], 0
  v_mfma_f32_16x16x32_bf16 v[88:91], v[36:39], v[192:195], 0
  v_mfma_f32_16x16x32_bf16 v[92:95], v[36:39], v[224:227], 0
  s_waitcnt lgkmcnt(2)
  v_mfma_f32_16x16x32_bf16 v[76:79], v[40:43], v[100:103], v[76:79]
  ds_read_b64_tr_b16 v[48:49], v3 offset:12288
  v_mfma_f32_16x16x32_bf16 v[80:83], v[40:43], v[132:135], v[80:83]
  ds_read_b64_tr_b16 v[50:51], v3 offset:12800
  v_mfma_f32_16x16x32_bf16 v[84:87], v[40:43], v[164:167], v[84:87]
  v_cvt_pk_bf16_f32 v56, v56, v57
  v_cvt_pk_bf16_f32 v57, v58, v59
  v_mfma_f32_16x16x32_bf16 v[88:91], v[40:43], v[196:199], v[88:91]
  v_cvt_pk_bf16_f32 v58, v60, v61
  v_cvt_pk_bf16_f32 v59, v62, v63
  v_mfma_f32_16x16x32_bf16 v[92:95], v[40:43], v[228:231], v[92:95]
  s_add_u32 s33, s51, 8192
  s_waitcnt lgkmcnt(2)
  v_mfma_f32_16x16x32_bf16 v[76:79], v[44:47], v[104:107], v[76:79]
  ds_read_b64_tr_b16 v[36:37], v3 offset:16384
  v_mfma_f32_16x16x32_bf16 v[80:83], v[44:47], v[136:139], v[80:83]
  ds_read_b64_tr_b16 v[38:39], v3 offset:16896
  v_mfma_f32_16x16x32_bf16 v[84:87], v[44:47], v[168:171], v[84:87]
  v_permlane16_swap_b32 v56, v58
  v_permlane16_swap_b32 v57, v59
  v_mfma_f32_16x16x32_bf16 v[88:91], v[44:47], v[200:203], v[88:91]
  buffer_store_dwordx4 v[56:59], v14, s[20:23], s33 offen
  v_mfma_f32_16x16x32_bf16 v[92:95], v[44:47], v[232:235], v[92:95]
  v_cvt_pk_bf16_f32 v64, v64, v65
  v_cvt_pk_bf16_f32 v65, v66, v67
  s_waitcnt lgkmcnt(2)
  v_mfma_f32_16x16x32_bf16 v[76:79], v[48:51], v[108:111], v[76:79]
  ds_read_b64_tr_b16 v[40:41], v3 offset:20480
  v_mfma_f32_16x16x32_bf16 v[80:83], v[48:51], v[140:143], v[80:83]
  ds_read_b64_tr_b16 v[42:43], v3 offset:20992
  v_mfma_f32_16x16x32_bf16 v[84:87], v[48:51], v[172:175], v[84:87]
  v_cvt_pk_bf16_f32 v66, v68, v69
  v_cvt_pk_bf16_f32 v67, v70, v71
  v_mfma_f32_16x16x32_bf16 v[88:91], v[48:51], v[204:207], v[88:91]
  s_add_u32 s33, s51, 36864
  v_mfma_f32_16x16x32_bf16 v[92:95], v[48:51], v[236:239], v[92:95]
  v_permlane16_swap_b32 v64, v66
  v_permlane16_swap_b32 v65, v67
  s_waitcnt lgkmcnt(2)
  v_mfma_f32_16x16x32_bf16 v[76:79], v[36:39], v[112:115], v[76:79]
  ds_read_b64_tr_b16 v[44:45], v3 offset:24576
  v_mfma_f32_16x16x32_bf16 v[80:83], v[36:39], v[144:147], v[80:83]
  ds_read_b64_tr_b16 v[46:47], v3 offset:25088
  v_mfma_f32_16x16x32_bf16 v[84:87], v[36:39], v[176:179], v[84:87]
  buffer_store_dwordx4 v[64:67], v14, s[20:23], s33 offen
  v_mfma_f32_16x16x32_bf16 v[88:91], v[36:39], v[208:211], v[88:91]
  v_cvt_pk_bf16_f32 v72, v72, v73
  v_cvt_pk_bf16_f32 v73, v74, v75
  v_mfma_f32_16x16x32_bf16 v[92:95], v[36:39], v[240:243], v[92:95]
  s_add_u32 s33, s51, 65536
  buffer_store_dwordx2 v[72:73], v15, s[20:23], s33 offen
  s_waitcnt lgkmcnt(2)
  v_mfma_f32_16x16x32_bf16 v[76:79], v[40:43], v[116:119], v[76:79]
  ds_read_b64_tr_b16 v[48:49], v3 offset:28672
  v_mfma_f32_16x16x32_bf16 v[80:83], v[40:43], v[148:151], v[80:83]
  ds_read_b64_tr_b16 v[50:51], v3 offset:29184
  v_mfma_f32_16x16x32_bf16 v[84:87], v[40:43], v[180:183], v[84:87]
  v_mfma_f32_16x16x32_bf16 v[88:91], v[40:43], v[212:215], v[88:91]
  v_mfma_f32_16x16x32_bf16 v[92:95], v[40:43], v[244:247], v[92:95]
  s_waitcnt lgkmcnt(2)
  v_mfma_f32_16x16x32_bf16 v[76:79], v[44:47], v[120:123], v[76:79]
  ds_read_b64_tr_b16 v[36:37], v2 offset:0
  v_mfma_f32_16x16x32_bf16 v[80:83], v[44:47], v[152:155], v[80:83]
  ds_read_b64_tr_b16 v[38:39], v2 offset:512
  v_mfma_f32_16x16x32_bf16 v[84:87], v[44:47], v[184:187], v[84:87]
  v_mfma_f32_16x16x32_bf16 v[88:91], v[44:47], v[216:219], v[88:91]
  v_mfma_f32_16x16x32_bf16 v[92:95], v[44:47], v[248:251], v[92:95]
  s_waitcnt lgkmcnt(2)
  v_mfma_f32_16x16x32_bf16 v[76:79], v[48:51], v[124:127], v[76:79]
  ds_read_b64_tr_b16 v[40:41], v2 offset:4096
  v_mfma_f32_16x16x32_bf16 v[80:83], v[48:51], v[156:159], v[80:83]
  ds_read_b64_tr_b16 v[42:43], v2 offset:4608
  v_mfma_f32_16x16x32_bf16 v[84:87], v[48:51], v[188:191], v[84:87]
  v_mfma_f32_16x16x32_bf16 v[88:91], v[48:51], v[220:223], v[88:91]
  v_mfma_f32_16x16x32_bf16 v[92:95], v[48:51], v[252:255], v[92:95]
  s_waitcnt lgkmcnt(2)
  v_mfma_f32_16x16x32_bf16 v[56:59], v[36:39], v[96:99], 0
  ds_read_b64_tr_b16 v[44:45], v2 offset:8192
  v_mfma_f32_16x16x32_bf16 v[60:63], v[36:39], v[128:131], 0
  ds_read_b64_tr_b16 v[46:47], v2 offset:8704
  v_mfma_f32_16x16x32_bf16 v[64:67], v[36:39], v[160:163], 0
  v_mfma_f32_16x16x32_bf16 v[68:71], v[36:39], v[192:195], 0
  v_mfma_f32_16x16x32_bf16 v[72:75], v[36:39], v[224:227], 0
  s_waitcnt lgkmcnt(2)
  v_mfma_f32_16x16x32_bf16 v[56:59], v[40:43], v[100:103], v[56:59]
  ds_read_b64_tr_b16 v[48:49], v2 offset:12288
  v_mfma_f32_16x16x32_bf16 v[60:63], v[40:43], v[132:135], v[60:63]
  ds_read_b64_tr_b16 v[50:51], v2 offset:12800
  v_mfma_f32_16x16x32_bf16 v[64:67], v[40:43], v[164:167], v[64:67]
  v_cvt_pk_bf16_f32 v76, v76, v77
  v_cvt_pk_bf16_f32 v77, v78, v79
  v_mfma_f32_16x16x32_bf16 v[68:71], v[40:43], v[196:199], v[68:71]
  v_cvt_pk_bf16_f32 v78, v80, v81
  v_cvt_pk_bf16_f32 v79, v82, v83
  v_mfma_f32_16x16x32_bf16 v[72:75], v[40:43], v[228:231], v[72:75]
  s_add_u32 s33, s52, 10240
  s_waitcnt lgkmcnt(2)
  v_mfma_f32_16x16x32_bf16 v[56:59], v[44:47], v[104:107], v[56:59]
  ds_read_b64_tr_b16 v[36:37], v2 offset:16384
  v_mfma_f32_16x16x32_bf16 v[60:63], v[44:47], v[136:139], v[60:63]
  ds_read_b64_tr_b16 v[38:39], v2 offset:16896
  v_mfma_f32_16x16x32_bf16 v[64:67], v[44:47], v[168:171], v[64:67]
  v_permlane16_swap_b32 v76, v78
  v_permlane16_swap_b32 v77, v79
  v_mfma_f32_16x16x32_bf16 v[68:71], v[44:47], v[200:203], v[68:71]
  buffer_store_dwordx4 v[76:79], v14, s[20:23], s33 offen
  v_mfma_f32_16x16x32_bf16 v[72:75], v[44:47], v[232:235], v[72:75]
  v_cvt_pk_bf16_f32 v84, v84, v85
  v_cvt_pk_bf16_f32 v85, v86, v87
  s_waitcnt lgkmcnt(2)
  v_mfma_f32_16x16x32_bf16 v[56:59], v[48:51], v[108:111], v[56:59]
  ds_read_b64_tr_b16 v[40:41], v2 offset:20480
  v_mfma_f32_16x16x32_bf16 v[60:63], v[48:51], v[140:143], v[60:63]
  ds_read_b64_tr_b16 v[42:43], v2 offset:20992
  v_mfma_f32_16x16x32_bf16 v[64:67], v[48:51], v[172:175], v[64:67]
  v_cvt_pk_bf16_f32 v86, v88, v89
  v_cvt_pk_bf16_f32 v87, v90, v91
  v_mfma_f32_16x16x32_bf16 v[68:71], v[48:51], v[204:207], v[68:71]
  s_add_u32 s33, s52, 38912
  v_mfma_f32_16x16x32_bf16 v[72:75], v[48:51], v[236:239], v[72:75]
  v_permlane16_swap_b32 v84, v86
  v_permlane16_swap_b32 v85, v87
  s_waitcnt lgkmcnt(2)
  v_mfma_f32_16x16x32_bf16 v[56:59], v[36:39], v[112:115], v[56:59]
  ds_read_b64_tr_b16 v[44:45], v2 offset:24576
  v_mfma_f32_16x16x32_bf16 v[60:63], v[36:39], v[144:147], v[60:63]
  ds_read_b64_tr_b16 v[46:47], v2 offset:25088
  v_mfma_f32_16x16x32_bf16 v[64:67], v[36:39], v[176:179], v[64:67]
  buffer_store_dwordx4 v[84:87], v14, s[20:23], s33 offen
  v_mfma_f32_16x16x32_bf16 v[68:71], v[36:39], v[208:211], v[68:71]
  v_cvt_pk_bf16_f32 v92, v92, v93
  v_cvt_pk_bf16_f32 v93, v94, v95
  v_mfma_f32_16x16x32_bf16 v[72:75], v[36:39], v[240:243], v[72:75]
  s_add_u32 s33, s52, 67584
  buffer_store_dwordx2 v[92:93], v15, s[20:23], s33 offen
  s_waitcnt lgkmcnt(2)
  v_mfma_f32_16x16x32_bf16 v[56:59], v[40:43], v[116:119], v[56:59]
  ds_read_b64_tr_b16 v[48:49], v2 offset:28672
  v_mfma_f32_16x16x32_bf16 v[60:63], v[40:43], v[148:151], v[60:63]
  ds_read_b64_tr_b16 v[50:51], v2 offset:29184
  v_mfma_f32_16x16x32_bf16 v[64:67], v[40:43], v[180:183], v[64:67]
  v_mfma_f32_16x16x32_bf16 v[68:71], v[40:43], v[212:215], v[68:71]
  v_mfma_f32_16x16x32_bf16 v[72:75], v[40:43], v[244:247], v[72:75]
  s_waitcnt lgkmcnt(2)
  v_mfma_f32_16x16x32_bf16 v[56:59], v[44:47], v[120:123], v[56:59]
  v_mfma_f32_16x16x32_bf16 v[60:63], v[44:47], v[152:155], v[60:63]
  v_mfma_f32_16x16x32_bf16 v[64:67], v[44:47], v[184:187], v[64:67]
  v_mfma_f32_16x16x32_bf16 v[68:71], v[44:47], v[216:219], v[68:71]
  v_mfma_f32_16x16x32_bf16 v[72:75], v[44:47], v[248:251], v[72:75]
  s_waitcnt lgkmcnt(0)
  v_mfma_f32_16x16x32_bf16 v[56:59], v[48:51], v[124:127], v[56:59]
  v_mfma_f32_16x16x32_bf16 v[60:63], v[48:51], v[156:159], v[60:63]
  v_mfma_f32_16x16x32_bf16 v[64:67], v[48:51], v[188:191], v[64:67]
  v_mfma_f32_16x16x32_bf16 v[68:71], v[48:51], v[220:223], v[68:71]
  v_mfma_f32_16x16x32_bf16 v[72:75], v[48:51], v[252:255], v[72:75]
  s_nop 3
  v_cvt_pk_bf16_f32 v56, v56, v57
  v_cvt_pk_bf16_f32 v57, v58, v59
  v_cvt_pk_bf16_f32 v58, v60, v61
  v_cvt_pk_bf16_f32 v59, v62, v63
  s_add_u32 s33, s50, 12288
  v_permlane16_swap_b32 v56, v58
  v_permlane16_swap_b32 v57, v59
  buffer_store_dwordx4 v[56:59], v14, s[20:23], s33 offen
  v_cvt_pk_bf16_f32 v64, v64, v65
  v_cvt_pk_bf16_f32 v65, v66, v67
  v_cvt_pk_bf16_f32 v66, v68, v69
  v_cvt_pk_bf16_f32 v67, v70, v71
  s_add_u32 s33, s50, 40960
  v_permlane16_swap_b32 v64, v66
  v_permlane16_swap_b32 v65, v67
  buffer_store_dwordx4 v[64:67], v14, s[20:23], s33 offen
  v_cvt_pk_bf16_f32 v72, v72, v73
  v_cvt_pk_bf16_f32 v73, v74, v75
  s_add_u32 s33, s50, 69632
  buffer_store_dwordx2 v[72:73], v15, s[20:23], s33 offen
  s_mul_i32 s32, s26, 280
  v_add_u32 v1, s32, v12
  v_lshrrev_b32 v2, 5, v1
  v_mul_u32_u24 v3, 2341, v2
  v_lshrrev_b32 v3, 16, v3
  v_mul_u32_u24 v4, 28, v3
  v_sub_u32 v4, v2, v4
  v_and_b32 v5, 15, v1
  v_lshl_add_u32 v5, v3, 4, v5
  v_bfe_u32 v6, v1, 4, 1
  v_lshlrev_b32 v6, 4, v6
  v_lshl_add_u32 v6, v4, 5, v6
  v_mul_u32_u24 v7, 896, v5
  v_add_u32 v6, v6, v7
  v_lshlrev_b32 v1, 4, v1
  v_mov_b32 v13, 0x7fffff00
  v_cmp_gt_u32 vcc, 280, v12
  s_nop 1
  v_cndmask_b32 v1, v13, v1, vcc
  v_cndmask_b32 v6, v13, v6, vcc
  s_waitcnt vmcnt(0)
  s_barrier
L_red:
  s_barrier
  s_cmp_ge_u32 s24, 5
  s_cbranch_scc1 L_fin
  s_lshl_b32 s34, s25, 1
  s_add_u32 s34, s34, s27
  s_xor_b32 s35, s34, 1
  s_mul_i32 s34, s34, 1146880
  s_mul_i32 s35, s35, 1179648
  s_add_u32 s35, s35, 18350080
  s_mov_b32 s32, 71680
  s_cmp_eq_u32 s67, 1
  s_cselect_b32 s34, s35, s34
  s_cselect_b32 s32, 73728, s32
  s_mul_i32 s33, s27, 71680
  s_add_u32 s33, s33, s37
  buffer_load_dwordx4 v[96:99], v1, s[20:23], s34 offen sc1
  s_add_u32 s34, s34, s32
  buffer_load_dwordx4 v[100:103], v1, s[20:23], s34 offen sc1
  s_add_u32 s34, s34, s32
  buffer_load_dwordx4 v[104:107], v1, s[20:23], s34 offen sc1
  s_add_u32 s34, s34, s32
  buffer_load_dwordx4 v[108:111], v1, s[20:23], s34 offen sc1
  s_add_u32 s34, s34, s32
  buffer_load_dwordx4 v[112:115], v1, s[20:23], s34 offen sc1
  s_add_u32 s34, s34, s32
  buffer_load_dwordx4 v[116:119], v1, s[20:23], s34 offen sc1
  s_add_u32 s34, s34, s32
  buffer_load_dwordx4 v[120:123], v1, s[20:23], s34 offen sc1
  s_add_u32 s34, s34, s32
  buffer_load_dwordx4 v[124:127], v1, s[20:23], s34 offen sc1
  s_add_u32 s34, s34, s32
  buffer_load_dwordx4 v[128:131], v1, s[20:23], s34 offen sc1
  s_add_u32 s34, s34, s32
  buffer_load_dwordx4 v[132:135], v1, s[20:23], s34 offen sc1
  s_add_u32 s34, s34, s32
  buffer_load_dwordx4 v[136:139], v1, s[20:23], s34 offen sc1
  s_add_u32 s34, s34, s32
  buffer_load_dwordx4 v[140:143], v1, s[20:23], s34 offen sc1
  s_add_u32 s34, s34, s32
  buffer_load_dwordx4 v[144:147], v1, s[20:23], s34 offen sc1
  s_add_u32 s34, s34, s32
  buffer_load_dwordx4 v[148:151], v1, s[20:23], s34 offen sc1
  s_add_u32 s34, s34, s32
  buffer_load_dwordx4 v[152:155], v1, s[20:23], s34 offen sc1
  s_add_u32 s34, s34, s32
  buffer_load_dwordx4 v[156:159], v1, s[20:23], s34 offen sc1
  s_add_u32 s34, s34, s32
  s_waitcnt vmcnt(15)
  v_lshlrev_b32 v40, 16, v96
  v_and_b32 v41, 0xffff0000, v96
  v_lshlrev_b32 v42, 16, v97
  v_and_b32 v43, 0xffff0000, v97
  v_lshlrev_b32 v44, 16, v98
  v_and_b32 v45, 0xffff0000, v98
  v_lshlrev_b32 v46, 16, v99
  v_and_b32 v47, 0xffff0000, v99
  s_waitcnt vmcnt(14)
  v_lshlrev_b32 v48, 16, v100
  v_and_b32 v49, 0xffff0000, v100
  v_lshlrev_b32 v50, 16, v101
  v_and_b32 v51, 0xffff0000, v101
  v_lshlrev_b32 v52, 16, v102
  v_and_b32 v53, 0xffff0000, v102
  v_lshlrev_b32 v54, 16, v103
  v_and_b32 v55, 0xffff0000, v103
  s_waitcnt vmcnt(13)
  v_lshlrev_b32 v24, 16, v104
  v_and_b32 v25, 0xffff0000, v104
  v_lshlrev_b32 v26, 16, v105
  v_and_b32 v27, 0xffff0000, v105
  v_lshlrev_b32 v28, 16, v106
  v_and_b32 v29, 0xffff0000, v106
  v_lshlrev_b32 v30, 16, v107
  v_and_b32 v31, 0xffff0000, v107
  s_waitcnt vmcnt(12)
  v_lshlrev_b32 v32, 16, v108
  v_and_b32 v33, 0xffff0000, v108
  v_lshlrev_b32 v34, 16, v109
  v_and_b32 v35, 0xffff0000, v109
  v_lshlrev_b32 v36, 16, v110
  v_and_b32 v37, 0xffff0000, v110
  v_lshlrev_b32 v38, 16, v111
  v_and_b32 v39, 0xffff0000, v111
  v_pk_add_f32 v[40:41], v[40:41], v[24:25]
  v_pk_add_f32 v[42:43], v[42:43], v[26:27]
  v_pk_add_f32 v[44:45], v[44:45], v[28:29]
  v_pk_add_f32 v[46:47], v[46:47], v[30:31]
  s_waitcnt vmcnt(11)
  v_lshlrev_b32 v24, 16, v112
  v_and_b32 v25, 0xffff0000, v112
  v_lshlrev_b32 v26, 16, v113
  v_and_b32 v27, 0xffff0000, v113
  v_lshlrev_b32 v28, 16, v114
  v_and_b32 v29, 0xffff0000, v114
  v_lshlrev_b32 v30, 16, v115
  v_and_b32 v31, 0xffff0000, v115
  v_pk_add_f32 v[48:49], v[48:49], v[32:33]
  v_pk_add_f32 v[50:51], v[50:51], v[34:35]
  v_pk_add_f32 v[52:53], v[52:53], v[36:37]
  v_pk_add_f32 v[54:55], v[54:55], v[38:39]
  s_waitcnt vmcnt(10)
  v_lshlrev_b32 v32, 16, v116
  v_and_b32 v33, 0xffff0000, v116
  v_lshlrev_b32 v34, 16, v117
  v_and_b32 v35, 0xffff0000, v117
  v_lshlrev_b32 v36, 16, v118
  v_and_b32 v37, 0xffff0000, v118
  v_lshlrev_b32 v38, 16, v119
  v_and_b32 v39, 0xffff0000, v119
  v_pk_add_f32 v[40:41], v[40:41], v[24:25]
  v_pk_add_f32 v[42:43], v[42:43], v[26:27]
  v_pk_add_f32 v[44:45], v[44:45], v[28:29]
  v_pk_add_f32 v[46:47], v[46:47], v[30:31]
  s_waitcnt vmcnt(9)
  v_lshlrev_b32 v24, 16, v120
  v_and_b32 v25, 0xffff0000, v120
  v_lshlrev_b32 v26, 16, v121
  v_and_b32 v27, 0xffff0000, v121
  v_lshlrev_b32 v28, 16, v122
  v_and_b32 v29, 0xffff0000, v122
  v_lshlrev_b32 v30, 16, v123
  v_and_b32 v31, 0xffff0000, v123
  v_pk_add_f32 v[48:49], v[48:49], v[32:33]
  v_pk_add_f32 v[50:51], v[50:51], v[34:35]
  v_pk_add_f32 v[52:53], v[52:53], v[36:37]
  v_pk_add_f32 v[54:55], v[54:55], v[38:39]
  s_waitcnt vmcnt(8)
  v_lshlrev_b32 v32, 16, v124
  v_and_b32 v33, 0xffff0000, v124
  v_lshlrev_b32 v34, 16, v125
  v_and_b32 v35, 0xffff0000, v125
  v_lshlrev_b32 v36, 16, v126
  v_and_b32 v37, 0xffff0000, v126
  v_lshlrev_b32 v38, 16, v127
  v_and_b32 v39, 0xffff0000, v127
  v_pk_add_f32 v[40:41], v[40:41], v[24:25]
  v_pk_add_f32 v[42:43], v[42:43], v[26:27]
  v_pk_add_f32 v[44:45], v[44:45], v[28:29]
  v_pk_add_f32 v[46:47], v[46:47], v[30:31]
  s_waitcnt vmcnt(7)
  v_lshlrev_b32 v24, 16, v128
  v_and_b32 v25, 0xffff0000, v128
  v_lshlrev_b32 v26, 16, v129
  v_and_b32 v27, 0xffff0000, v129
  v_lshlrev_b32 v28, 16, v130
  v_and_b32 v29, 0xffff0000, v130
  v_lshlrev_b32 v30, 16, v131
  v_and_b32 v31, 0xffff0000, v131
  v_pk_add_f32 v[48:49], v[48:49], v[32:33]
  v_pk_add_f32 v[50:51], v[50:51], v[34:35]
  v_pk_add_f32 v[52:53], v[52:53], v[36:37]
  v_pk_add_f32 v[54:55], v[54:55], v[38:39]
  s_waitcnt vmcnt(6)
  v_lshlrev_b32 v32, 16, v132
  v_and_b32 v33, 0xffff0000, v132
  v_lshlrev_b32 v34, 16, v133
  v_and_b32 v35, 0xffff0000, v133
  v_lshlrev_b32 v36, 16, v134
  v_and_b32 v37, 0xffff0000, v134
  v_lshlrev_b32 v38, 16, v135
  v_and_b32 v39, 0xffff0000, v135
  v_pk_add_f32 v[40:41], v[40:41], v[24:25]
  v_pk_add_f32 v[42:43], v[42:43], v[26:27]
  v_pk_add_f32 v[44:45], v[44:45], v[28:29]
  v_pk_add_f32 v[46:47], v[46:47], v[30:31]
  s_waitcnt vmcnt(5)
  v_lshlrev_b32 v24, 16, v136
  v_and_b32 v25, 0xffff0000, v136
  v_lshlrev_b32 v26, 16, v137
  v_and_b32 v27, 0xffff0000, v137
  v_lshlrev_b32 v28, 16, v138
  v_and_b32 v29, 0xffff0000, v138
  v_lshlrev_b32 v30, 16, v139
  v_and_b32 v31, 0xffff0000, v139
  v_pk_add_f32 v[48:49], v[48:49], v[32:33]
  v_pk_add_f32 v[50:51], v[50:51], v[34:35]
  v_pk_add_f32 v[52:53], v[52:53], v[36:37]
  v_pk_add_f32 v[54:55], v[54:55], v[38:39]
  s_waitcnt vmcnt(4)
  v_lshlrev_b32 v32, 16, v140
  v_and_b32 v33, 0xffff0000, v140
  v_lshlrev_b32 v34, 16, v141
  v_and_b32 v35, 0xffff0000, v141
  v_lshlrev_b32 v36, 16, v142
  v_and_b32 v37, 0xffff0000, v142
  v_lshlrev_b32 v38, 16, v143
  v_and_b32 v39, 0xffff0000, v143
  v_pk_add_f32 v[40:41], v[40:41], v[24:25]
  v_pk_add_f32 v[42:43], v[42:43], v[26:27]
  v_pk_add_f32 v[44:45], v[44:45], v[28:29]
  v_pk_add_f32 v[46:47], v[46:47], v[30:31]
  s_waitcnt vmcnt(3)
  v_lshlrev_b32 v24, 16, v144
  v_and_b32 v25, 0xffff0000, v144
  v_lshlrev_b32 v26, 16, v145
  v_and_b32 v27, 0xffff0000, v145
  v_lshlrev_b32 v28, 16, v146
  v_and_b32 v29, 0xffff0000, v146
  v_lshlrev_b32 v30, 16, v147
  v_and_b32 v31, 0xffff0000, v147
  v_pk_add_f32 v[48:49], v[48:49], v[32:33]
  v_pk_add_f32 v[50:51], v[50:51], v[34:35]
  v_pk_add_f32 v[52:53], v[52:53], v[36:37]
  v_pk_add_f32 v[54:55], v[54:55], v[38:39]
  s_waitcnt vmcnt(2)
  v_lshlrev_b32 v32, 16, v148
  v_and_b32 v33, 0xffff0000, v148
  v_lshlrev_b32 v34, 16, v149
  v_and_b32 v35, 0xffff0000, v149
  v_lshlrev_b32 v36, 16, v150
  v_and_b32 v37, 0xffff0000, v150
  v_lshlrev_b32 v38, 16, v151
  v_and_b32 v39, 0xffff0000, v151
  v_pk_add_f32 v[40:41], v[40:41], v[24:25]
  v_pk_add_f32 v[42:43], v[42:43], v[26:27]
  v_pk_add_f32 v[44:45], v[44:45], v[28:29]
  v_pk_add_f32 v[46:47], v[46:47], v[30:31]
  s_waitcnt vmcnt(1)
  v_lshlrev_b32 v24, 16, v152
  v_and_b32 v25, 0xffff0000, v152
  v_lshlrev_b32 v26, 16, v153
  v_and_b32 v27, 0xffff0000, v153
  v_lshlrev_b32 v28, 16, v154
  v_and_b32 v29, 0xffff0000, v154
  v_lshlrev_b32 v30, 16, v155
  v_and_b32 v31, 0xffff0000, v155
  v_pk_add_f32 v[48:49], v[48:49], v[32:33]
  v_pk_add_f32 v[50:51], v[50:51], v[34:35]
  v_pk_add_f32 v[52:53], v[52:53], v[36:37]
  v_pk_add_f32 v[54:55], v[54:55], v[38:39]
  s_waitcnt vmcnt(0)
  v_lshlrev_b32 v32, 16, v156
  v_and_b32 v33, 0xffff0000, v156
  v_lshlrev_b32 v34, 16, v157
  v_and_b32 v35, 0xffff0000, v157
  v_lshlrev_b32 v36, 16, v158
  v_and_b32 v37, 0xffff0000, v158
  v_lshlrev_b32 v38, 16, v159
  v_and_b32 v39, 0xffff0000, v159
  v_pk_add_f32 v[40:41], v[40:41], v[24:25]
  v_pk_add_f32 v[42:43], v[42:43], v[26:27]
  v_pk_add_f32 v[44:45], v[44:45], v[28:29]
  v_pk_add_f32 v[46:47], v[46:47], v[30:31]
  v_pk_add_f32 v[48:49], v[48:49], v[32:33]
  v_pk_add_f32 v[50:51], v[50:51], v[34:35]
  v_pk_add_f32 v[52:53], v[52:53], v[36:37]
  v_pk_add_f32 v[54:55], v[54:55], v[38:39]
  v_pk_add_f32 v[40:41], v[40:41], v[48:49]
  v_pk_add_f32 v[42:43], v[42:43], v[50:51]
  v_pk_add_f32 v[44:45], v[44:45], v[52:53]
  v_pk_add_f32 v[46:47], v[46:47], v[54:55]
  v_cvt_pk_bf16_f32 v20, v40, v41
  v_cvt_pk_bf16_f32 v21, v42, v43
  v_cvt_pk_bf16_f32 v22, v44, v45
  v_cvt_pk_bf16_f32 v23, v46, v47
  buffer_store_dwordx4 v[20:23], v6, s[72:75], s33 offen
L_fin:
L_end:
  s_endpgm
L_PV_fallback:
  s_mov_b32 s31, 1
  s_waitcnt vmcnt(0) lgkmcnt(0)
  s_barrier
  s_mov_b32 s29, s40
  s_mov_b32 s30, 32
L_PV_fbl:
  s_barrier
  s_barrier
  s_sub_u32 s30, s30, 1
  s_cmp_lg_u32 s30, 0
  s_cbranch_scc1 L_PV_fbl
  s_barrier
  s_branch L_PV_join
L_codeend:
.section .rodata,"a"
.p2align 6
.amdhsa_kernel standalone__gqa_block_cached__near_ridge_kernel
.amdhsa_next_free_vgpr 256
.amdhsa_next_free_sgpr 102
.amdhsa_accum_offset 256
.amdhsa_group_segment_fixed_size 0
.amdhsa_kernarg_size 64
.amdhsa_user_sgpr_count 2
.amdhsa_user_sgpr_kernarg_segment_ptr 1
.amdhsa_system_sgpr_workgroup_id_x 1
.end_amdhsa_kernel
```
